```python
import torch

def _softmax(x, axis=-1):
    return torch.softmax(x, dim=axis)
def _gelu(x):
    return torch.nn.functional.gelu(x, approximate="tanh")
def _silu(x):
    return torch.nn.functional.silu(x)
def _sigmoid(x):
    return torch.sigmoid(x)
def _layernorm(x, axis=-1, eps=1e-5):
    m = x.mean(dim=axis, keepdim=True)
    v = x.var(dim=axis, keepdim=True, unbiased=False)
    return (x - m) / torch.sqrt(v + eps)
def _scatter_add(tgt, idx, src, axis=0):
    return tgt.clone().index_add_(axis, idx, src)
def _segment_sum(src, seg, n):
    out = torch.zeros((n,) + src.shape[1:], dtype=src.dtype)
    return out.index_add_(0, seg, src)
def _pad(x, pw):
    flat = tuple(v for pair in reversed(pw) for v in pair)
    return torch.nn.functional.pad(x, flat)

kernel_name = 'concat_heads__grouped_kv_mqa__ssm_conv_s4__prompt'

def setup_inputs():

    _w = (lambda a: (lambda t: t.to(torch.bfloat16) if t.is_floating_point() else t)(torch.as_tensor(a)))
    def _A_setup():
        B, S, D, H = 1, 2048, 640, 32
        Dh = D // H
        return {
            "x": _w((lambda *s: torch.randn(*s, dtype=torch.bfloat16) * 0.05)(B, S, D)),
            "wq": _w((lambda *s: torch.randn(*s, dtype=torch.bfloat16) * 0.8)(D, H * Dh)),
            "wk": _w((lambda *s: torch.randn(*s, dtype=torch.bfloat16) * 0.8)(D, Dh)),
            "wv": _w((lambda *s: torch.randn(*s, dtype=torch.bfloat16) * 0.05)(D, Dh)),
            "wo": _w((lambda *s: torch.randn(*s, dtype=torch.bfloat16) * 0.05)(H * Dh, D)),
        }
    _A_in = _A_setup()

    def _B_setup():
        B, L, D, N = 1, 2048, 640, 128
        A_re = -(lambda _x: torch.exp(torch.as_tensor(_x)))((lambda *s: torch.randn(*s, dtype=torch.bfloat16) * 6.4)(D, N))
        A_im = torch.pi * (lambda *s: torch.randn(*s, dtype=torch.bfloat16) * 0.1)(D, N)
        B_re = (lambda *s: torch.randn(*s, dtype=torch.bfloat16) * 0.1)(D, N)
        B_im = (lambda *s: torch.randn(*s, dtype=torch.bfloat16) * 0.1)(D, N)
        C_re = (lambda *s: torch.randn(*s, dtype=torch.bfloat16) * 0.1)(D, N)
        C_im = (lambda *s: torch.randn(*s, dtype=torch.bfloat16) * 0.1)(D, N)
        log_dt = (lambda *s: torch.randn(*s, dtype=torch.bfloat16) * 0.1)(D) * 0.5 - 4.0
        Dskip = (lambda *s: torch.randn(*s, dtype=torch.bfloat16) * 0.05)(D)
        return {
            "u": _w((lambda *s: torch.randn(*s, dtype=torch.bfloat16) * 0.05)(B, L, D)),
            "A_re": _w(A_re),
            "A_im": _w(A_im),
            "B_re": _w(B_re),
            "B_im": _w(B_im),
            "C_re": _w(C_re),
            "C_im": _w(C_im),
            "log_dt": _w(log_dt),
            "Dskip": _w(Dskip),
        }
    _B_in = _B_setup()

    return {
        "A_x": _A_in["x"],
        "A_wq": _A_in["wq"],
        "A_wk": _A_in["wk"],
        "A_wv": _A_in["wv"],
        "A_wo": _A_in["wo"],
        "B_u": _B_in["u"],
        "B_A_re": _B_in["A_re"],
        "B_A_im": _B_in["A_im"],
        "B_B_re": _B_in["B_re"],
        "B_B_im": _B_in["B_im"],
        "B_C_re": _B_in["C_re"],
        "B_C_im": _B_in["C_im"],
        "B_log_dt": _B_in["log_dt"],
        "B_Dskip": _B_in["Dskip"],
    }

def reference(A_x, A_wq, A_wk, A_wv, A_wo, B_u, B_A_re, B_A_im, B_B_re, B_B_im, B_C_re, B_C_im, B_log_dt, B_Dskip):
    def _A_ref(x, wq, wk, wv, wo):
        B, S, D = x.shape
        H = 32
        Dh = D // H
        q = (lambda x, *d: x.permute(*d))((x @ wq).reshape(B, S, H, Dh), 0, 2, 1, 3)
        k = x @ wk
        v = x @ wv
        scores = torch.einsum("bhqd,bkd->bhqk", q, k) * (Dh ** -0.5)
        p = _softmax(scores, axis=-1)
        o = torch.einsum("bhqk,bkd->bhqd", p, v)
        return (lambda x, *d: x.permute(*d))(o, 0, 2, 1, 3).reshape(B, S, H * Dh) @ wo

    def _B_ref(u, A_re, A_im, B_re, B_im, C_re, C_im, log_dt, Dskip):
        Bsz, L, D = u.shape
        dt = torch.exp(log_dt)[:, None]
        A = A_re + 1j * A_im
        Bc = B_re + 1j * B_im
        Cc = C_re + 1j * C_im
        logdA = dt * A
        dB = dt * Bc
        l = (lambda x, dt: x.to(dt))(torch.arange(L), A_re.dtype)
        P = torch.exp(logdA[:, :, None] * l[None, None, :])
        K = torch.einsum("dn,dnl,dn->dl", Cc, P, dB).real
        L2 = 2 * L
        Kp = _pad(K, ((0, 0), (0, L)))
        up = (lambda x, *d: x.permute(*d))(u, 0, 2, 1)
        up = _pad(up, ((0, 0), (0, 0), (0, L)))
        Kf = (lambda x, axes=(-2,-1): torch.fft.rfft2(x.float(), dim=axes))(Kp[:, None, :], axes=(-2, -1))
        Uf = (lambda x, axes=(-2,-1): torch.fft.rfft2(x.float(), dim=axes))(up[:, :, None, :], axes=(-2, -1))
        Yf = Uf * Kf[None, :, :, :]
        y = (lambda x, s, axes=(-2,-1): torch.fft.irfft2(x, s=s, dim=axes).to(torch.bfloat16))(Yf, (1, L2), axes=(-2, -1))[:, :, 0, :L]
        y = (lambda x, *d: x.permute(*d))(y, 0, 2, 1) + u * Dskip[None, None, :]
        return y

    a = _A_ref(A_x, A_wq, A_wk, A_wv, A_wo)
    b = _B_ref(B_u, B_A_re, B_A_im, B_B_re, B_B_im, B_C_re, B_C_im, B_log_dt, B_Dskip)
    return torch.concatenate([a, b], axis=-1)
```

```asm
; @launch grid=(256,1,1) block=(512,1,1) lds=163840
.amdgcn_target "amdgcn-amd-amdhsa--gfx950"
.text
.globl concat_heads__grouped_kv_mqa__ssm_conv_s4__prompt_kernel
.p2align 8
.type concat_heads__grouped_kv_mqa__ssm_conv_s4__prompt_kernel,@function
concat_heads__grouped_kv_mqa__ssm_conv_s4__prompt_kernel:
    s_cmp_ge_u32 s2, 0x100
    s_cbranch_scc1 L_end
    s_load_dwordx16 s[16:31], s[0:1], 0
    s_load_dwordx16 s[32:47], s[0:1], 64
    s_load_dwordx2 s[48:49], s[0:1], 128
    s_getpc_b64 s[6:7]
L_pc:
    s_lshr_b32 s9, s2, 3
    v_lshlrev_b32 v1, 12, v0
    s_lshl_b32 s8, s9, 7
    v_add_u32 v1, s8, v1
    v_cmp_gt_u32 vcc, L_tabA-L_pc+7164, v1
    v_min_u32 v1, L_tabA-L_pc+7164, v1
    s_cbranch_vccz L_nt
    global_load_dword v255, v1, s[6:7]
L_nt:
    v_lshrrev_b32 v1, 6, v0
    v_and_b32 v0, 63, v0
    s_and_b32 s8, s2, 7
    v_readfirstlane_b32 s3, v1
    s_and_b32 s4, s9, 3
    s_lshl2_add_u32 s4, s8, s4
    s_lshr_b32 s5, s9, 2
    v_lshlrev_b32 v8, 4, v0
    s_cmp_lt_u32 s3, 4
        s_cbranch_scc1 L_A0
    s_setprio 3
    v_mov_b64 v[4:5], 0
    v_and_b32 v2, 3, v0
    v_mov_b32 v3, 163808
    v_lshl_add_u32 v2, v2, 3, v3
    ds_write_b64 v2, v[4:5]
    s_mul_i32 s50, s8, 80
    s_min_u32 s11, s9, 9
    s_lshl3_add_u32 s11, s11, s50
    s_lshl2_add_u32 s50, s9, s50
    s_sub_u32 s50, s50, 48
    s_cmp_lt_u32 s5, 3
    s_cselect_b32 s50, s11, s50
    s_and_b32 s10, s3, 3
    s_cmp_lt_u32 s5, 2
    s_cbranch_scc0 L_b_C
    s_and_b32 s13, s9, 3
    s_add_u32 s13, s13, s5
    s_cmp_ge_u32 s13, 5
    s_cselect_b32 s12, 5, 0
    s_sub_u32 s13, s13, s12
    s_cmp_ge_u32 s13, 5
    s_cselect_b32 s12, 5, 0
    s_sub_u32 s13, s13, s12
    s_mul_i32 s13, s13, 5
    s_add_u32 s13, s13, s10
    s_waitcnt lgkmcnt(0)
    s_cmp_eq_u32 s5, 0
    s_cselect_b32 s60, s20, s22
    s_cselect_b32 s61, s21, s23
    s_mov_b32 s62, 25600
    s_mov_b32 s63, 0x20000
    s_lshl_b32 s12, s10, 10
    s_add_u32 m0, s12, 110592
    s_lshl_b32 s12, s13, 10
    buffer_load_dwordx4 v8, s[60:63], s12 offen lds
    s_add_u32 m0, m0, 4096
    s_cmp_ge_u32 s13, 21
    s_cselect_b32 s12, -21, 4
    s_add_u32 s13, s13, s12
    s_lshl_b32 s12, s13, 10
    buffer_load_dwordx4 v8, s[60:63], s12 offen lds
    s_add_u32 m0, m0, 4096
    s_cmp_ge_u32 s13, 21
    s_cselect_b32 s12, -21, 4
    s_add_u32 s13, s13, s12
    s_lshl_b32 s12, s13, 10
    buffer_load_dwordx4 v8, s[60:63], s12 offen lds
    s_add_u32 m0, m0, 4096
    s_cmp_ge_u32 s13, 21
    s_cselect_b32 s12, -21, 4
    s_add_u32 s13, s13, s12
    s_lshl_b32 s12, s13, 10
    buffer_load_dwordx4 v8, s[60:63], s12 offen lds
    s_add_u32 m0, m0, 4096
    s_cmp_ge_u32 s13, 21
    s_cselect_b32 s12, -21, 4
    s_add_u32 s13, s13, s12
    s_lshl_b32 s12, s13, 10
    buffer_load_dwordx4 v8, s[60:63], s12 offen lds
    s_add_u32 m0, m0, 4096
    s_cmp_ge_u32 s13, 21
    s_cselect_b32 s12, -21, 4
    s_add_u32 s13, s13, s12
    s_lshl_b32 s12, s13, 10
    buffer_load_dwordx4 v8, s[60:63], s12 offen lds
    s_add_u32 m0, m0, 4096
    s_cmp_ge_u32 s13, 21
    s_cselect_b32 s12, -21, 4
    s_add_u32 s13, s13, s12
    s_lshl_b32 s12, s13, 10
    s_cmp_eq_u32 s3, 4
    s_cbranch_scc0 L_pro_kv
    buffer_load_dwordx4 v8, s[60:63], s12 offen lds
    s_cmp_eq_u32 s2, 0
    s_cbranch_scc0 L_pro_kv
    s_memrealtime s[84:85]
    v_mov_b32 v10, 0
    s_waitcnt lgkmcnt(0)
    s_or_b32 s84, s84, 1
    v_mov_b32 v12, s84
    v_mov_b32 v13, s85
    s_mov_b64 exec, 1
    global_store_dwordx2 v10, v[12:13], s[46:47] sc1
    s_mov_b64 exec, -1
    s_branch L_pro_kv
L_b_C:
    s_add_u32 s12, s50, s10
    s_lshl_b32 s82, s12, 8
    v_lshl_add_u32 v9, v0, 2, s82
    s_lshl_b32 s12, s12, 1
    v_mov_b32 v17, s12
    v_mov_b32 v16, 0
    s_mul_i32 s12, s10, 1536
    s_add_u32 s12, s12, s9
    s_sub_u32 s12, s12, 8
    s_lshl_b32 s12, s12, 7
    s_movk_i32 s83, 3072
    v_mov_b32 v18, s12
    v_mad_u32_u24 v18, v0, s83, v18
    s_waitcnt lgkmcnt(0)
    s_mov_b32 s56, s18
    s_mov_b32 s57, s19
    s_mov_b32 s58, 819200
    s_mov_b32 s59, 0x20000
    s_cmp_eq_u32 s5, 2
    s_cbranch_scc1 L_b_G2
    global_load_short_d16_hi v16, v17, s[40:41]
    global_load_dword v160, v9, s[28:29]
    global_load_dword v161, v9, s[30:31]
    global_load_dword v162, v9, s[32:33]
    global_load_dword v163, v9, s[34:35]
    global_load_dword v164, v9, s[36:37]
    global_load_dword v165, v9, s[38:39]
    s_cmp_lt_u32 s3, 0
    s_cselect_b32 s12, 0, 0x80000000
    buffer_load_dword v255, v18, s[56:59], s12 offen
    s_branch L_kg
L_A0:
    s_add_u32 s10, s6, L_tabA-L_pc
    s_addc_u32 s11, s7, 0
    global_load_dwordx4 v[240:243], v8, s[10:11] offset:0
    global_load_dwordx4 v[244:247], v8, s[10:11] offset:1024
    global_load_dwordx4 v[248:251], v8, s[10:11] offset:2048
    global_load_dwordx4 v[148:151], v8, s[10:11] offset:3072
    v_lshrrev_b32 v2, 4, v0
    s_lshl_b32 s13, s3, 2
    v_add_u32 v3, s13, v2
    v_and_b32 v4, 15, v0
    v_xor_b32 v3, v3, v4
    v_lshlrev_b32 v3, 4, v3
    s_movk_i32 s12, 1280
    v_mad_u32_u24 v26, v2, s12, v3
    v_add_u32 v27, 20480, v26
    v_add_u32 v28, 40960, v26
    v_add_u32 v29, 61440, v26
    s_mul_i32 s92, s4, 81920
    s_mul_i32 s85, s3, 5120
    s_add_u32 s92, s92, s85
    s_lshl_b32 s51, s3, 10
    s_and_b32 s94, s9, 3
    s_add_u32 s94, s94, s5
    s_cmp_ge_u32 s94, 5
    s_cselect_b32 s12, 5, 0
    s_sub_u32 s94, s94, s12
    s_cmp_ge_u32 s94, 5
    s_cselect_b32 s12, 5, 0
    s_sub_u32 s94, s94, s12
    s_mul_i32 s84, s5, 160
    s_mul_i32 s12, s3, 40960
    s_add_u32 s84, s84, s12
    s_add_u32 s91, s85, 1024
    s_add_u32 s85, s85, 81920
    s_mov_b32 s90, s84
    s_mov_b32 s82, 0xcccd
    s_movk_i32 s83, 1280
    v_add_u32 v20, 0, v0
    v_mul_u32_u24 v21, s82, v20
    v_lshrrev_b32 v21, 19, v21
    v_mul_u32_u24 v22, 10, v21
    v_sub_u32 v22, v20, v22
    v_lshlrev_b32 v22, 4, v22
    v_mad_u32_u24 v155, v21, s83, v22
    v_and_b32 v23, 1, v21
    v_bfe_u32 v20, v21, 1, 2
    v_lshl_add_u32 v23, v23, 2, v20
    v_and_b32 v21, 24, v21
    v_add_u32 v21, v21, v23
    v_mad_u32_u24 v2, v21, s83, v22
    v_add_u32 v20, 64, v0
    v_mul_u32_u24 v21, s82, v20
    v_lshrrev_b32 v21, 19, v21
    v_mul_u32_u24 v22, 10, v21
    v_sub_u32 v22, v20, v22
    v_lshlrev_b32 v22, 4, v22
    v_mad_u32_u24 v156, v21, s83, v22
    v_and_b32 v23, 1, v21
    v_bfe_u32 v20, v21, 1, 2
    v_lshl_add_u32 v23, v23, 2, v20
    v_and_b32 v21, 24, v21
    v_add_u32 v21, v21, v23
    v_mad_u32_u24 v3, v21, s83, v22
    v_add_u32 v20, 128, v0
    v_mul_u32_u24 v21, s82, v20
    v_lshrrev_b32 v21, 19, v21
    v_mul_u32_u24 v22, 10, v21
    v_sub_u32 v22, v20, v22
    v_lshlrev_b32 v22, 4, v22
    v_mad_u32_u24 v157, v21, s83, v22
    v_and_b32 v23, 1, v21
    v_bfe_u32 v20, v21, 1, 2
    v_lshl_add_u32 v23, v23, 2, v20
    v_and_b32 v21, 24, v21
    v_add_u32 v21, v21, v23
    v_mad_u32_u24 v4, v21, s83, v22
    s_waitcnt lgkmcnt(0)
    s_mov_b32 s52, s16
    s_mov_b32 s53, s17
    s_mov_b32 s54, 2621440
    s_mov_b32 s55, 0x20000
    s_lshl_b32 s28, s94, 8
    s_add_u32 s28, s28, s92
    s_mul_i32 s33, s94, 163840
    s_add_u32 s33, s33, s84
    s_add_u32 s94, s94, 1
    s_cmp_eq_u32 s94, 5
    s_cselect_b32 s94, 0, s94
    s_add_u32 m0, s51, 0
    s_nop 0
    buffer_load_dwordx4 v26, s[52:55], s28 offen lds
    s_add_u32 m0, s51, 4096
    s_nop 0
    buffer_load_dwordx4 v27, s[52:55], s28 offen lds
    s_add_u32 m0, s51, 8192
    s_nop 0
    buffer_load_dwordx4 v28, s[52:55], s28 offen lds
    s_add_u32 m0, s51, 12288
    s_nop 0
    buffer_load_dwordx4 v29, s[52:55], s28 offen lds
    s_mov_b32 s56, s18
    s_mov_b32 s57, s19
    s_mov_b32 s58, 819200
    s_mov_b32 s59, 0x20000
    s_cmp_lt_u32 s5, 2
    s_cbranch_scc0 L_a_C
    s_lshl_b32 s29, s94, 8
    s_add_u32 s29, s29, s92
    s_mul_i32 s34, s94, 163840
    s_add_u32 s34, s34, s84
    s_add_u32 s94, s94, 1
    s_cmp_eq_u32 s94, 5
    s_cselect_b32 s94, 0, s94
    s_add_u32 m0, s51, 16384
    s_nop 0
    buffer_load_dwordx4 v26, s[52:55], s29 offen lds
    s_add_u32 m0, s51, 20480
    s_nop 0
    buffer_load_dwordx4 v27, s[52:55], s29 offen lds
    s_add_u32 m0, s51, 24576
    s_nop 0
    buffer_load_dwordx4 v28, s[52:55], s29 offen lds
    s_add_u32 m0, s51, 28672
    s_nop 0
    buffer_load_dwordx4 v29, s[52:55], s29 offen lds
    s_mov_b32 s82, 0xcccd
    s_movk_i32 s83, 1280
    v_add_u32 v20, 192, v0
    v_mul_u32_u24 v21, s82, v20
    v_lshrrev_b32 v21, 19, v21
    v_mul_u32_u24 v22, 10, v21
    v_sub_u32 v22, v20, v22
    v_lshlrev_b32 v22, 4, v22
    v_mad_u32_u24 v158, v21, s83, v22
    v_and_b32 v23, 1, v21
    v_bfe_u32 v20, v21, 1, 2
    v_lshl_add_u32 v23, v23, 2, v20
    v_and_b32 v21, 24, v21
    v_add_u32 v21, v21, v23
    v_mad_u32_u24 v5, v21, s83, v22
    v_add_u32 v20, 256, v0
    v_mul_u32_u24 v21, s82, v20
    v_lshrrev_b32 v21, 19, v21
    v_mul_u32_u24 v22, 10, v21
    v_sub_u32 v22, v20, v22
    v_lshlrev_b32 v22, 4, v22
    v_mad_u32_u24 v159, v21, s83, v22
    v_and_b32 v23, 1, v21
    v_bfe_u32 v20, v21, 1, 2
    v_lshl_add_u32 v23, v23, 2, v20
    v_and_b32 v21, 24, v21
    v_add_u32 v21, v21, v23
    v_mad_u32_u24 v6, v21, s83, v22
    s_lshl_b32 s30, s94, 8
    s_add_u32 s30, s30, s92
    s_mul_i32 s35, s94, 163840
    s_add_u32 s35, s35, s84
    s_add_u32 s94, s94, 1
    s_cmp_eq_u32 s94, 5
    s_cselect_b32 s94, 0, s94
    s_add_u32 m0, s51, 32768
    s_nop 0
    buffer_load_dwordx4 v26, s[52:55], s30 offen lds
    s_add_u32 m0, s51, 36864
    s_nop 0
    buffer_load_dwordx4 v27, s[52:55], s30 offen lds
    s_add_u32 m0, s51, 40960
    s_nop 0
    buffer_load_dwordx4 v28, s[52:55], s30 offen lds
    s_add_u32 m0, s51, 45056
    s_nop 0
    buffer_load_dwordx4 v29, s[52:55], s30 offen lds
    s_lshl_b32 s31, s94, 8
    s_add_u32 s31, s31, s92
    s_mul_i32 s36, s94, 163840
    s_add_u32 s36, s36, s84
    s_add_u32 s94, s94, 1
    s_cmp_eq_u32 s94, 5
    s_cselect_b32 s94, 0, s94
    s_add_u32 m0, s51, 49152
    s_nop 0
    buffer_load_dwordx4 v26, s[52:55], s31 offen lds
    s_add_u32 m0, s51, 53248
    s_nop 0
    buffer_load_dwordx4 v27, s[52:55], s31 offen lds
    s_add_u32 m0, s51, 57344
    s_nop 0
    buffer_load_dwordx4 v28, s[52:55], s31 offen lds
    s_add_u32 m0, s51, 61440
    s_nop 0
    buffer_load_dwordx4 v29, s[52:55], s31 offen lds
    s_lshl_b32 s32, s94, 8
    s_add_u32 s32, s32, s92
    s_mul_i32 s37, s94, 163840
    s_add_u32 s37, s37, s84
    s_add_u32 m0, s51, 65536
    s_nop 0
    buffer_load_dwordx4 v26, s[52:55], s32 offen lds
    s_add_u32 m0, s51, 69632
    s_nop 0
    buffer_load_dwordx4 v27, s[52:55], s32 offen lds
    s_add_u32 m0, s51, 73728
    s_nop 0
    buffer_load_dwordx4 v28, s[52:55], s32 offen lds
    s_add_u32 m0, s51, 77824
    s_nop 0
    buffer_load_dwordx4 v29, s[52:55], s32 offen lds
    s_branch L_a_P2
L_a_C:
    s_add_u32 m0, s85, 0
    s_nop 0
    buffer_load_dwordx4 v2, s[56:59], s33 offen lds
    s_add_u32 m0, s85, 1024
    s_nop 0
    buffer_load_dwordx4 v3, s[56:59], s33 offen lds
    s_add_u32 m0, s85, 2048
    s_nop 0
    buffer_load_dwordx4 v4, s[56:59], s33 offen lds
    s_mov_b32 s82, 0xcccd
    s_movk_i32 s83, 1280
    v_add_u32 v20, 192, v0
    v_mul_u32_u24 v21, s82, v20
    v_lshrrev_b32 v21, 19, v21
    v_mul_u32_u24 v22, 10, v21
    v_sub_u32 v22, v20, v22
    v_lshlrev_b32 v22, 4, v22
    v_mad_u32_u24 v158, v21, s83, v22
    v_and_b32 v23, 1, v21
    v_bfe_u32 v20, v21, 1, 2
    v_lshl_add_u32 v23, v23, 2, v20
    v_and_b32 v21, 24, v21
    v_add_u32 v21, v21, v23
    v_mad_u32_u24 v5, v21, s83, v22
    v_add_u32 v20, 256, v0
    v_mul_u32_u24 v21, s82, v20
    v_lshrrev_b32 v21, 19, v21
    v_mul_u32_u24 v22, 10, v21
    v_sub_u32 v22, v20, v22
    v_lshlrev_b32 v22, 4, v22
    v_mad_u32_u24 v159, v21, s83, v22
    v_and_b32 v23, 1, v21
    v_bfe_u32 v20, v21, 1, 2
    v_lshl_add_u32 v23, v23, 2, v20
    v_and_b32 v21, 24, v21
    v_add_u32 v21, v21, v23
    v_mad_u32_u24 v6, v21, s83, v22
    s_add_u32 m0, s85, 3072
    s_nop 0
    buffer_load_dwordx4 v5, s[56:59], s33 offen lds
    s_add_u32 m0, s85, 4096
    s_nop 0
    buffer_load_dwordx4 v6, s[56:59], s33 offen lds
    s_lshl_b32 s29, s94, 8
    s_add_u32 s29, s29, s92
    s_mul_i32 s34, s94, 163840
    s_add_u32 s34, s34, s84
    s_add_u32 s94, s94, 1
    s_cmp_eq_u32 s94, 5
    s_cselect_b32 s94, 0, s94
    s_lshl_b32 s30, s94, 8
    s_add_u32 s30, s30, s92
    s_mul_i32 s35, s94, 163840
    s_add_u32 s35, s35, s84
    s_add_u32 s94, s94, 1
    s_cmp_eq_u32 s94, 5
    s_cselect_b32 s94, 0, s94
    s_lshl_b32 s31, s94, 8
    s_add_u32 s31, s31, s92
    s_mul_i32 s36, s94, 163840
    s_add_u32 s36, s36, s84
    s_add_u32 s94, s94, 1
    s_cmp_eq_u32 s94, 5
    s_cselect_b32 s94, 0, s94
    s_lshl_b32 s32, s94, 8
    s_add_u32 s32, s32, s92
    s_mul_i32 s37, s94, 163840
    s_add_u32 s37, s37, s84
    v_and_b32 v20, 31, v0
    v_lshrrev_b32 v21, 5, v0
    v_and_b32 v22, 15, v20
    v_xor_b32 v22, v22, v21
    v_lshlrev_b32 v22, 4, v22
    v_lshl_or_b32 v64, v20, 8, v22
    v_xor_b32 v65, 32, v64
    v_xor_b32 v66, 64, v64
    v_xor_b32 v67, 96, v64
    v_xor_b32 v68, 128, v64
    v_xor_b32 v69, 160, v64
    v_xor_b32 v70, 192, v64
    v_xor_b32 v71, 224, v64
    v_bfe_u32 v22, v0, 2, 2
    v_lshlrev_b32 v22, 1, v22
    v_lshl_add_u32 v22, v21, 3, v22
    v_mul_u32_u24 v22, 0xa0, v22
    v_bfe_u32 v23, v0, 4, 1
    v_and_b32 v24, 3, v0
    v_lshl_add_u32 v23, v23, 2, v24
    v_cmp_lt_u32 vcc, 4, v23
    v_mov_b32 v24, 0x30000
    v_lshl_add_u32 v22, v23, 3, v22
    s_mul_i32 s12, s3, 40
    s_add_u32 s12, s12, 81920
    v_cndmask_b32 v22, v22, v24, vcc
    v_add_u32 v72, s12, v22
    v_add_u32 v73, 58368, v72
    v_mov_b32 v74, 163824
    v_mov_b32 v76, 1
    v_mov_b32 v77, 0x100
    v_min_u32 v78, 1, v0
    v_lshl_add_u32 v78, v78, 15, v74
    v_mov_b32 v1, 0
    s_mov_b32 s64, s48
    s_mov_b32 s65, s49
    s_mov_b32 s66, 6291456
    s_mov_b32 s67, 0x20000
    s_mov_b32 s68, s44
    s_mov_b32 s69, s45
    s_mov_b32 s70, 5242880
    s_mov_b32 s71, 0x20000
    s_mov_b32 s72, s24
    s_mov_b32 s73, s25
    s_mov_b32 s74, 819200
    s_mov_b32 s75, 0x20000
    s_mov_b32 s76, s26
    s_mov_b32 s77, s27
    s_mov_b32 s78, 2621440
    s_mov_b32 s79, 0x20000
    s_lshl_b32 s11, s3, 11
    s_lshr_b32 s12, s2, 3
    s_add_u32 s11, s11, s12
    s_lshl_b32 s11, s11, 7
    v_lshl_add_u32 v154, v0, 12, s11
    s_mul_i32 s11, s3, 6144
    s_add_u32 s11, s11, 41984
    v_add_u32 v9, s11, v8
    s_mul_i32 s14, s4, 81920
    s_add_u32 s14, s14, 262144
    s_mul_i32 s15, s5, 2560
    s_add_u32 s15, s15, s14
    v_mov_b32 v144, 0xdddddddd
    v_mov_b32 v145, v8
    v_add_u32 v146, 41984, v8
    v_add_u32 v147, 83968, v8
    v_mov_b64 v[80:81], 0
    v_mov_b64 v[82:83], 0
    v_mov_b64 v[84:85], 0
    v_mov_b64 v[86:87], 0
    v_mov_b64 v[88:89], 0
    v_mov_b64 v[90:91], 0
    v_mov_b64 v[92:93], 0
    v_mov_b64 v[94:95], 0
    v_mov_b64 v[96:97], 0
    v_mov_b64 v[98:99], 0
    v_mov_b64 v[100:101], 0
    v_mov_b64 v[102:103], 0
    v_mov_b64 v[104:105], 0
    v_mov_b64 v[106:107], 0
    v_mov_b64 v[108:109], 0
    v_mov_b64 v[110:111], 0
    s_barrier
    s_add_u32 m0, s51, 16384
    s_nop 0
    buffer_load_dwordx4 v26, s[52:55], s29 offen lds
    s_add_u32 m0, s51, 20480
    s_nop 0
    buffer_load_dwordx4 v27, s[52:55], s29 offen lds
    s_add_u32 m0, s51, 24576
    s_nop 0
    buffer_load_dwordx4 v28, s[52:55], s29 offen lds
    s_add_u32 m0, s51, 28672
    s_nop 0
    buffer_load_dwordx4 v29, s[52:55], s29 offen lds
    s_add_u32 m0, s85, 58368
    s_nop 0
    buffer_load_dwordx4 v2, s[56:59], s34 offen lds
    s_add_u32 m0, s85, 59392
    s_nop 0
    buffer_load_dwordx4 v3, s[56:59], s34 offen lds
    s_add_u32 m0, s85, 60416
    s_nop 0
    buffer_load_dwordx4 v4, s[56:59], s34 offen lds
    s_add_u32 m0, s85, 61440
    s_nop 0
    buffer_load_dwordx4 v5, s[56:59], s34 offen lds
    s_add_u32 m0, s85, 62464
    s_nop 0
    buffer_load_dwordx4 v6, s[56:59], s34 offen lds
    s_setprio 3
    s_waitcnt vmcnt(18)
    v_mov_b32 v10, v149
    v_mov_b32 v11, v150
    v_add_u32 v149, 41984, v148
    v_add_u32 v150, 83968, v148
    v_add_u32 v152, 41984, v151
    v_add_u32 v153, 83968, v151
    s_and_b32 s13, s3, 1
    s_mul_i32 s10, s13, 15360
    s_sub_u32 s10, s10, 10240
    s_mul_i32 s11, s13, 10240
    s_add_u32 s11, s11, 5120
    v_add_u32 v240, s10, v240
    v_add_u32 v241, s10, v241
    v_add_u32 v242, s10, v242
    v_add_u32 v243, s10, v243
    v_add_u32 v244, s10, v244
    v_add_u32 v245, s10, v245
    v_add_u32 v246, s11, v246
    v_add_u32 v247, s11, v247
    v_add_u32 v248, s11, v248
    v_add_u32 v249, s11, v249
    s_lshl_b32 s13, s3, 3
    s_mul_i32 s10, s5, 160
    s_lshr_b32 s11, 0xf0c0b0a, s13
    s_and_b32 s11, s11, 0xff
    s_mul_i32 s11, s11, 40960
    s_add_u32 s93, s11, s10
    s_lshr_b32 s11, 0xe0d1110, s13
    s_and_b32 s11, s11, 0xff
    s_mul_i32 s11, s11, 40960
    s_add_u32 s94, s11, s10
    s_lshr_b32 s11, 0x9081312, s13
    s_and_b32 s11, s11, 0xff
    s_mul_i32 s11, s11, 40960
    s_add_u32 s95, s11, s10
    v_lshlrev_b32 v252, 24, v0
    s_mov_b32 s10, 0x3ea52b5c
    s_mul_i32 s13, s3, 2560
    s_add_u32 s13, s13, 90112
    v_add_u32 v12, s13, v8
    v_lshl_add_u32 v13, v0, 3, s13
    v_lshlrev_b32 v18, 8, v0
    s_and_b32 s13, s2, 7
    s_lshl_b32 s13, s13, 14
    s_cmp_eq_u32 s3, 0
    s_cselect_b32 s13, s13, 0x80000000
    s_add_u32 s13, s13, 5767168
    s_getreg_b32 s97, hwreg(HW_REG_XCC_ID, 0, 4)
    s_lshl_b32 s97, s97, 28
    s_waitcnt vmcnt(9)
    ds_add_u32 v78, v76
    s_mov_b32 s82, 0
    ds_read_b32 v75, v74
Lq_1:
    s_waitcnt lgkmcnt(0)
    v_readfirstlane_b32 s83, v75
    s_add_u32 s82, s82, 1
    s_and_b32 s83, s83, 63
    s_cmp_ge_u32 s83, 4
    s_cbranch_scc1 Lqd_2
    ds_read_b32 v75, v74
    s_cmp_lt_u32 s82, 0x40000
    s_cbranch_scc1 Lq_1
    s_waitcnt lgkmcnt(0)
Lqd_2:
    s_mov_b32 s82, 0
    ds_read_b64_tr_b16 v[168:169], v72 offset:0
    ds_read_b128 v[172:175], v64 offset:0
    ds_read_b64_tr_b16 v[170:171], v72 offset:160
    ds_read_b128 v[176:179], v64 offset:8192
    ds_read_b64_tr_b16 v[180:181], v72 offset:2560
    ds_read_b128 v[184:187], v65 offset:0
    ds_read_b64_tr_b16 v[182:183], v72 offset:2720
    ds_read_b128 v[188:191], v65 offset:8192
    ds_read_b64_tr_b16 v[192:193], v72 offset:5120
    ds_read_b128 v[196:199], v66 offset:0
    ds_read_b64_tr_b16 v[194:195], v72 offset:5280
    ds_read_b128 v[200:203], v66 offset:8192
    s_waitcnt lgkmcnt(8)
    v_mfma_f32_32x32x16_bf16 v[32:47], v[168:171], v[172:175], 0
    s_add_u32 m0, s51, 32768
    ds_read_b64_tr_b16 v[204:205], v72 offset:7680
    ds_read_b128 v[208:211], v67 offset:0
    buffer_load_dwordx4 v26, s[52:55], s30 offen lds
    v_mfma_f32_32x32x16_bf16 v[48:63], v[168:171], v[176:179], 0
    s_add_u32 m0, s51, 36864
    ds_read_b64_tr_b16 v[206:207], v72 offset:7840
    ds_read_b128 v[212:215], v67 offset:8192
    buffer_load_dwordx4 v27, s[52:55], s30 offen lds
    s_waitcnt lgkmcnt(8)
    v_mfma_f32_32x32x16_bf16 v[32:47], v[180:183], v[184:187], v[32:47]
    s_add_u32 m0, s51, 40960
    ds_read_b64_tr_b16 v[216:217], v72 offset:10240
    ds_read_b128 v[220:223], v68 offset:0
    buffer_load_dwordx4 v28, s[52:55], s30 offen lds
    v_mfma_f32_32x32x16_bf16 v[48:63], v[180:183], v[188:191], v[48:63]
    s_add_u32 m0, s51, 45056
    ds_read_b64_tr_b16 v[218:219], v72 offset:10400
    ds_read_b128 v[224:227], v68 offset:8192
    buffer_load_dwordx4 v29, s[52:55], s30 offen lds
    s_waitcnt lgkmcnt(8)
    v_mfma_f32_32x32x16_bf16 v[32:47], v[192:195], v[196:199], v[32:47]
    s_add_u32 m0, s85, 37888
    ds_read_b64_tr_b16 v[228:229], v72 offset:12800
    ds_read_b128 v[232:235], v69 offset:0
    buffer_load_dwordx4 v2, s[56:59], s35 offen lds
    v_mfma_f32_32x32x16_bf16 v[48:63], v[192:195], v[200:203], v[48:63]
    ds_read_b64_tr_b16 v[230:231], v72 offset:12960
    ds_read_b128 v[236:239], v69 offset:8192
    s_waitcnt vmcnt(5)
    ds_add_u32 v78, v76
    s_waitcnt lgkmcnt(9)
    v_mfma_f32_32x32x16_bf16 v[32:47], v[204:207], v[208:211], v[32:47]
    s_add_u32 m0, s85, 38912
    ds_read_b64_tr_b16 v[168:169], v72 offset:15360
    ds_read_b128 v[172:175], v70 offset:0
    buffer_load_dwordx4 v3, s[56:59], s35 offen lds
    v_mfma_f32_32x32x16_bf16 v[48:63], v[204:207], v[212:215], v[48:63]
    s_add_u32 m0, s85, 39936
    ds_read_b64_tr_b16 v[170:171], v72 offset:15520
    ds_read_b128 v[176:179], v70 offset:8192
    buffer_load_dwordx4 v4, s[56:59], s35 offen lds
    ds_read_b32 v75, v74
    s_waitcnt lgkmcnt(10)
    v_mfma_f32_32x32x16_bf16 v[32:47], v[216:219], v[220:223], v[32:47]
    s_add_u32 m0, s85, 40960
    ds_read_b64_tr_b16 v[180:181], v72 offset:17920
    ds_read_b128 v[184:187], v71 offset:0
    buffer_load_dwordx4 v5, s[56:59], s35 offen lds
    v_mfma_f32_32x32x16_bf16 v[48:63], v[216:219], v[224:227], v[48:63]
    ds_read_b64_tr_b16 v[182:183], v72 offset:18080
    ds_read_b128 v[188:191], v71 offset:8192
    ds_add_u32 v78, v77
    s_waitcnt lgkmcnt(11)
    v_mfma_f32_32x32x16_bf16 v[32:47], v[228:231], v[232:235], v[32:47]
    s_waitcnt lgkmcnt(5)
    v_cmp_gt_u32_sdwa vcc, 8, v75 src0_sel:DWORD src1_sel:BYTE_0
    s_cbranch_vccnz Lck_3s
Lck_3:
    ds_read_b64_tr_b16 v[192:193], v73 offset:0
    ds_read_b128 v[196:199], v64 offset:16384
    v_mfma_f32_32x32x16_bf16 v[48:63], v[228:231], v[236:239], v[48:63]
    s_add_u32 m0, s85, 41984
    ds_read_b64_tr_b16 v[194:195], v73 offset:160
    ds_read_b128 v[200:203], v64 offset:24576
    buffer_load_dwordx4 v6, s[56:59], s35 offen lds
    ds_read_b32 v75, v74
    v_mfma_f32_32x32x16_bf16 v[32:47], v[168:171], v[172:175], v[32:47]
    s_add_u32 m0, s51, 49152
    ds_read_b64_tr_b16 v[204:205], v73 offset:2560
    ds_read_b128 v[208:211], v65 offset:16384
    buffer_load_dwordx4 v26, s[52:55], s31 offen lds
    v_mfma_f32_32x32x16_bf16 v[48:63], v[168:171], v[176:179], v[48:63]
    s_add_u32 m0, s51, 53248
    ds_read_b64_tr_b16 v[206:207], v73 offset:2720
    ds_read_b128 v[212:215], v65 offset:24576
    buffer_load_dwordx4 v27, s[52:55], s31 offen lds
    s_waitcnt lgkmcnt(10)
    v_mfma_f32_32x32x16_bf16 v[32:47], v[180:183], v[184:187], v[32:47]
    s_add_u32 m0, s51, 57344
    ds_read_b64_tr_b16 v[216:217], v73 offset:5120
    ds_read_b128 v[220:223], v66 offset:16384
    buffer_load_dwordx4 v28, s[52:55], s31 offen lds
    v_mfma_f32_32x32x16_bf16 v[48:63], v[180:183], v[188:191], v[48:63]
    s_waitcnt lgkmcnt(6)
    v_cmp_gt_u32_sdwa vcc, 4, v75 src0_sel:DWORD src1_sel:BYTE_1
    s_cbranch_vccnz Lck_4s
Lck_4:
    ds_read_b64_tr_b16 v[218:219], v73 offset:5280
    ds_read_b128 v[224:227], v66 offset:24576
    v_mfma_f32_32x32x16_bf16 v[32:47], v[192:195], v[196:199], v[32:47]
    s_add_u32 m0, s51, 61440
    ds_read_b64_tr_b16 v[228:229], v73 offset:7680
    ds_read_b128 v[232:235], v67 offset:16384
    buffer_load_dwordx4 v29, s[52:55], s31 offen lds
    v_mfma_f32_32x32x16_bf16 v[48:63], v[192:195], v[200:203], v[48:63]
    s_add_u32 m0, s85, 0
    ds_read_b64_tr_b16 v[230:231], v73 offset:7840
    ds_read_b128 v[236:239], v67 offset:24576
    buffer_load_dwordx4 v2, s[56:59], s36 offen lds
    s_waitcnt lgkmcnt(8)
    v_mfma_f32_32x32x16_bf16 v[32:47], v[204:207], v[208:211], v[32:47]
    s_add_u32 m0, s85, 1024
    ds_read_b64_tr_b16 v[168:169], v73 offset:10240
    ds_read_b128 v[172:175], v68 offset:16384
    buffer_load_dwordx4 v3, s[56:59], s36 offen lds
    v_mfma_f32_32x32x16_bf16 v[48:63], v[204:207], v[212:215], v[48:63]
    s_add_u32 m0, s85, 2048
    ds_read_b64_tr_b16 v[170:171], v73 offset:10400
    ds_read_b128 v[176:179], v68 offset:24576
    buffer_load_dwordx4 v4, s[56:59], s36 offen lds
    s_waitcnt lgkmcnt(8)
    v_mfma_f32_32x32x16_bf16 v[32:47], v[216:219], v[220:223], v[32:47]
    s_add_u32 m0, s85, 3072
    ds_read_b64_tr_b16 v[180:181], v73 offset:12800
    ds_read_b128 v[184:187], v69 offset:16384
    buffer_load_dwordx4 v5, s[56:59], s36 offen lds
    v_mfma_f32_32x32x16_bf16 v[48:63], v[216:219], v[224:227], v[48:63]
    ds_read_b64_tr_b16 v[182:183], v73 offset:12960
    ds_read_b128 v[188:191], v69 offset:24576
    s_waitcnt vmcnt(8)
    ds_add_u32 v78, v76
    s_waitcnt lgkmcnt(9)
    v_mfma_f32_32x32x16_bf16 v[32:47], v[228:231], v[232:235], v[32:47]
    s_add_u32 m0, s85, 4096
    ds_read_b64_tr_b16 v[192:193], v73 offset:15360
    ds_read_b128 v[196:199], v70 offset:16384
    buffer_load_dwordx4 v6, s[56:59], s36 offen lds
    v_mfma_f32_32x32x16_bf16 v[48:63], v[228:231], v[236:239], v[48:63]
    s_add_u32 m0, s51, 65536
    ds_read_b64_tr_b16 v[194:195], v73 offset:15520
    ds_read_b128 v[200:203], v70 offset:24576
    buffer_load_dwordx4 v26, s[52:55], s32 offen lds
    ds_read_b32 v75, v74
    s_waitcnt lgkmcnt(10)
    v_mfma_f32_32x32x16_bf16 v[32:47], v[168:171], v[172:175], v[32:47]
    s_add_u32 m0, s51, 69632
    ds_read_b64_tr_b16 v[204:205], v73 offset:17920
    ds_read_b128 v[208:211], v71 offset:16384
    buffer_load_dwordx4 v27, s[52:55], s32 offen lds
    v_mfma_f32_32x32x16_bf16 v[48:63], v[168:171], v[176:179], v[48:63]
    ds_read_b64_tr_b16 v[206:207], v73 offset:18080
    ds_read_b128 v[212:215], v71 offset:24576
    ds_add_u32 v78, v77
    s_waitcnt lgkmcnt(11)
    v_mfma_f32_32x32x16_bf16 v[32:47], v[180:183], v[184:187], v[32:47]
    s_waitcnt lgkmcnt(5)
    v_cmp_gt_u32_sdwa vcc, 12, v75 src0_sel:DWORD src1_sel:BYTE_0
    s_cbranch_vccnz Lck_5s
Lck_5:
    ds_read_b64_tr_b16 v[216:217], v72 offset:37888
    ds_read_b128 v[220:223], v64 offset:32768
    v_mfma_f32_32x32x16_bf16 v[48:63], v[180:183], v[188:191], v[48:63]
    s_add_u32 m0, s51, 73728
    ds_read_b64_tr_b16 v[218:219], v72 offset:38048
    ds_read_b128 v[224:227], v64 offset:40960
    buffer_load_dwordx4 v28, s[52:55], s32 offen lds
    ds_read_b32 v75, v74
    v_mfma_f32_32x32x16_bf16 v[32:47], v[192:195], v[196:199], v[32:47]
    s_add_u32 m0, s51, 77824
    ds_read_b64_tr_b16 v[228:229], v72 offset:40448
    ds_read_b128 v[232:235], v65 offset:32768
    buffer_load_dwordx4 v29, s[52:55], s32 offen lds
    v_mfma_f32_32x32x16_bf16 v[48:63], v[192:195], v[200:203], v[48:63]
    ds_read_b64_tr_b16 v[230:231], v72 offset:40608
    ds_read_b128 v[236:239], v65 offset:40960
    s_waitcnt lgkmcnt(10)
    v_mfma_f32_32x32x16_bf16 v[32:47], v[204:207], v[208:211], v[32:47]
    ds_read_b64_tr_b16 v[168:169], v72 offset:43008
    ds_read_b128 v[172:175], v66 offset:32768
    v_mfma_f32_32x32x16_bf16 v[48:63], v[204:207], v[212:215], v[48:63]
    s_waitcnt lgkmcnt(6)
    v_cmp_gt_u32_sdwa vcc, 8, v75 src0_sel:DWORD src1_sel:BYTE_1
    s_cbranch_vccnz Lck_6s
Lck_6:
    ds_read_b64_tr_b16 v[170:171], v72 offset:43168
    ds_read_b128 v[176:179], v66 offset:40960
    v_mfma_f32_32x32x16_bf16 v[32:47], v[216:219], v[220:223], v[32:47]
    s_add_u32 m0, s85, 58368
    ds_read_b64_tr_b16 v[180:181], v72 offset:45568
    ds_read_b128 v[184:187], v67 offset:32768
    buffer_load_dwordx4 v2, s[56:59], s37 offen lds
    v_mfma_f32_32x32x16_bf16 v[48:63], v[216:219], v[224:227], v[48:63]
    s_add_u32 m0, s85, 59392
    ds_read_b64_tr_b16 v[182:183], v72 offset:45728
    ds_read_b128 v[188:191], v67 offset:40960
    buffer_load_dwordx4 v3, s[56:59], s37 offen lds
    s_waitcnt lgkmcnt(8)
    v_mfma_f32_32x32x16_bf16 v[32:47], v[228:231], v[232:235], v[32:47]
    s_add_u32 m0, s85, 60416
    ds_read_b64_tr_b16 v[192:193], v72 offset:48128
    ds_read_b128 v[196:199], v68 offset:32768
    buffer_load_dwordx4 v4, s[56:59], s37 offen lds
    v_mfma_f32_32x32x16_bf16 v[48:63], v[228:231], v[236:239], v[48:63]
    s_add_u32 m0, s85, 61440
    ds_read_b64_tr_b16 v[194:195], v72 offset:48288
    ds_read_b128 v[200:203], v68 offset:40960
    buffer_load_dwordx4 v5, s[56:59], s37 offen lds
    s_waitcnt lgkmcnt(8)
    v_mfma_f32_32x32x16_bf16 v[32:47], v[168:171], v[172:175], v[32:47]
    s_add_u32 m0, s85, 62464
    ds_read_b64_tr_b16 v[204:205], v72 offset:50688
    ds_read_b128 v[208:211], v69 offset:32768
    buffer_load_dwordx4 v6, s[56:59], s37 offen lds
    v_mfma_f32_32x32x16_bf16 v[48:63], v[168:171], v[176:179], v[48:63]
    ds_read_b64_tr_b16 v[206:207], v72 offset:50848
    ds_read_b128 v[212:215], v69 offset:40960
    s_waitcnt vmcnt(9)
    ds_add_u32 v78, v76
    s_waitcnt lgkmcnt(9)
    v_mfma_f32_32x32x16_bf16 v[32:47], v[180:183], v[184:187], v[32:47]
    ds_read_b64_tr_b16 v[216:217], v72 offset:53248
    ds_read_b128 v[220:223], v70 offset:32768
    global_load_dwordx2 v[16:17], v1, s[46:47] sc1
    v_mfma_f32_32x32x16_bf16 v[48:63], v[180:183], v[188:191], v[48:63]
    ds_read_b64_tr_b16 v[218:219], v72 offset:53408
    ds_read_b128 v[224:227], v70 offset:40960
    ds_read_b32 v75, v74
    s_waitcnt lgkmcnt(10)
    v_mfma_f32_32x32x16_bf16 v[32:47], v[192:195], v[196:199], v[32:47]
    ds_read_b64_tr_b16 v[228:229], v72 offset:55808
    ds_read_b128 v[232:235], v71 offset:32768
    v_mfma_f32_32x32x16_bf16 v[48:63], v[192:195], v[200:203], v[48:63]
    ds_read_b64_tr_b16 v[230:231], v72 offset:55968
    ds_read_b128 v[236:239], v71 offset:40960
    ds_add_u32 v78, v77
    s_waitcnt lgkmcnt(11)
    v_mfma_f32_32x32x16_bf16 v[32:47], v[204:207], v[208:211], v[32:47]
    s_waitcnt lgkmcnt(5)
    v_cmp_gt_u32_sdwa vcc, 16, v75 src0_sel:DWORD src1_sel:BYTE_0
    s_cbranch_vccnz Lck_7s
Lck_7:
    ds_read_b64_tr_b16 v[168:169], v72 offset:0
    ds_read_b128 v[172:175], v64 offset:49152
    v_mfma_f32_32x32x16_bf16 v[48:63], v[204:207], v[212:215], v[48:63]
    ds_read_b64_tr_b16 v[170:171], v72 offset:160
    ds_read_b128 v[176:179], v64 offset:57344
    v_mfma_f32_32x32x16_bf16 v[32:47], v[216:219], v[220:223], v[32:47]
    ds_read_b64_tr_b16 v[180:181], v72 offset:2560
    ds_read_b128 v[184:187], v65 offset:49152
    v_mfma_f32_32x32x16_bf16 v[48:63], v[216:219], v[224:227], v[48:63]
    ds_read_b64_tr_b16 v[182:183], v72 offset:2720
    ds_read_b128 v[188:191], v65 offset:57344
    s_waitcnt lgkmcnt(9)
    v_mfma_f32_32x32x16_bf16 v[32:47], v[228:231], v[232:235], v[32:47]
    ds_read_b64_tr_b16 v[192:193], v72 offset:5120
    ds_read_b128 v[196:199], v66 offset:49152
    v_mfma_f32_32x32x16_bf16 v[48:63], v[228:231], v[236:239], v[48:63]
    ds_read_b64_tr_b16 v[194:195], v72 offset:5280
    ds_read_b128 v[200:203], v66 offset:57344
    s_waitcnt lgkmcnt(8)
    v_mfma_f32_32x32x16_bf16 v[32:47], v[168:171], v[172:175], v[32:47]
    ds_read_b64_tr_b16 v[204:205], v72 offset:7680
    ds_read_b128 v[208:211], v67 offset:49152
    v_mfma_f32_32x32x16_bf16 v[48:63], v[168:171], v[176:179], v[48:63]
    ds_read_b64_tr_b16 v[206:207], v72 offset:7840
    ds_read_b128 v[212:215], v67 offset:57344
    s_waitcnt lgkmcnt(8)
    v_mfma_f32_32x32x16_bf16 v[32:47], v[180:183], v[184:187], v[32:47]
    ds_read_b64_tr_b16 v[216:217], v72 offset:10240
    ds_read_b128 v[220:223], v68 offset:49152
    v_mfma_f32_32x32x16_bf16 v[48:63], v[180:183], v[188:191], v[48:63]
    ds_read_b64_tr_b16 v[218:219], v72 offset:10400
    ds_read_b128 v[224:227], v68 offset:57344
    s_waitcnt lgkmcnt(8)
    v_mfma_f32_32x32x16_bf16 v[32:47], v[192:195], v[196:199], v[32:47]
    ds_read_b64_tr_b16 v[228:229], v72 offset:12800
    ds_read_b128 v[232:235], v69 offset:49152
    v_mfma_f32_32x32x16_bf16 v[48:63], v[192:195], v[200:203], v[48:63]
    ds_read_b64_tr_b16 v[230:231], v72 offset:12960
    ds_read_b128 v[236:239], v69 offset:57344
    s_waitcnt vmcnt(0)
    ds_add_u32 v78, v76
    s_waitcnt lgkmcnt(9)
    v_mfma_f32_32x32x16_bf16 v[32:47], v[204:207], v[208:211], v[32:47]
    ds_read_b64_tr_b16 v[168:169], v72 offset:15360
    ds_read_b128 v[172:175], v70 offset:49152
    v_mfma_f32_32x32x16_bf16 v[48:63], v[204:207], v[212:215], v[48:63]
    ds_read_b64_tr_b16 v[170:171], v72 offset:15520
    ds_read_b128 v[176:179], v70 offset:57344
    ds_read_b32 v75, v74
    s_waitcnt lgkmcnt(10)
    v_mfma_f32_32x32x16_bf16 v[32:47], v[216:219], v[220:223], v[32:47]
    ds_read_b64_tr_b16 v[180:181], v72 offset:17920
    ds_read_b128 v[184:187], v71 offset:49152
    v_mfma_f32_32x32x16_bf16 v[48:63], v[216:219], v[224:227], v[48:63]
    ds_read_b64_tr_b16 v[182:183], v72 offset:18080
    ds_read_b128 v[188:191], v71 offset:57344
    ds_add_u32 v78, v77
    s_waitcnt lgkmcnt(11)
    v_mfma_f32_32x32x16_bf16 v[32:47], v[228:231], v[232:235], v[32:47]
    s_waitcnt lgkmcnt(5)
    v_cmp_gt_u32_sdwa vcc, 20, v75 src0_sel:DWORD src1_sel:BYTE_0
    s_cbranch_vccnz Lck_8s
Lck_8:
    v_cmp_gt_u32_sdwa vcc, 12, v75 src0_sel:DWORD src1_sel:BYTE_1
    s_cbranch_vccnz Lck_9s
Lck_9:
    v_add_u32 v64, 0x10000, v64
    ds_read_b64_tr_b16 v[192:193], v73 offset:0
    ds_read_b128 v[196:199], v64 offset:0
    v_mfma_f32_32x32x16_bf16 v[48:63], v[228:231], v[236:239], v[48:63]
    ds_read_b64_tr_b16 v[194:195], v73 offset:160
    ds_read_b128 v[200:203], v64 offset:8192
    v_mfma_f32_32x32x16_bf16 v[32:47], v[168:171], v[172:175], v[32:47]
    v_add_u32 v65, 0x10000, v65
    ds_read_b64_tr_b16 v[204:205], v73 offset:2560
    ds_read_b128 v[208:211], v65 offset:0
    v_mfma_f32_32x32x16_bf16 v[48:63], v[168:171], v[176:179], v[48:63]
    ds_read_b64_tr_b16 v[206:207], v73 offset:2720
    ds_read_b128 v[212:215], v65 offset:8192
    s_waitcnt lgkmcnt(9)
    v_mfma_f32_32x32x16_bf16 v[32:47], v[180:183], v[184:187], v[32:47]
    v_add_u32 v66, 0x10000, v66
    ds_read_b64_tr_b16 v[216:217], v73 offset:5120
    ds_read_b128 v[220:223], v66 offset:0
    v_mfma_f32_32x32x16_bf16 v[48:63], v[180:183], v[188:191], v[48:63]
    ds_read_b64_tr_b16 v[218:219], v73 offset:5280
    ds_read_b128 v[224:227], v66 offset:8192
    s_waitcnt lgkmcnt(8)
    v_mfma_f32_32x32x16_bf16 v[32:47], v[192:195], v[196:199], v[32:47]
    v_add_u32 v67, 0x10000, v67
    ds_read_b64_tr_b16 v[228:229], v73 offset:7680
    ds_read_b128 v[232:235], v67 offset:0
    buffer_load_dwordx2 v[20:21], v18, s[64:67], s13 offen offset:0 sc1
    v_mfma_f32_32x32x16_bf16 v[48:63], v[192:195], v[200:203], v[48:63]
    ds_read_b64_tr_b16 v[230:231], v73 offset:7840
    ds_read_b128 v[236:239], v67 offset:8192
    buffer_load_dwordx2 v[22:23], v18, s[64:67], s13 offen offset:128 sc1
    s_waitcnt lgkmcnt(8)
    v_mfma_f32_32x32x16_bf16 v[32:47], v[204:207], v[208:211], v[32:47]
    v_add_u32 v68, 0x10000, v68
    ds_read_b64_tr_b16 v[168:169], v73 offset:10240
    ds_read_b128 v[172:175], v68 offset:0
    s_mov_b32 s82, 0
Lnon_10:
    v_readfirstlane_b32 s80, v16
    v_readfirstlane_b32 s81, v17
    s_add_u32 s82, s82, 1
    s_bitcmp1_b32 s80, 0
    s_cbranch_scc1 Lnond_11
    s_cmp_gt_u32 s82, 20000
    s_cbranch_scc1 Lnond_11
    s_sleep 4
    global_load_dwordx2 v[16:17], v1, s[46:47] sc1
    s_waitcnt vmcnt(0)
    s_branch Lnon_10
Lnond_11:
    s_cmp_eq_u32 s3, 0
    s_cbranch_scc0 Lpko_14
    v_mov_b32 v76, 64
    s_mov_b32 s82, 0
Lpk_12:
    s_waitcnt vmcnt(0)
    v_cmp_eq_u64 vcc, s[80:81], v[20:21]
    v_cmp_eq_u64 s[84:85], s[80:81], v[22:23]
    s_add_u32 s82, s82, 1
    s_and_b64 vcc, vcc, s[84:85]
    s_cmp_eq_u64 vcc, -1
    s_cbranch_scc1 Lpkd_13
    s_not_b64 exec, vcc
    buffer_load_dwordx2 v[20:21], v18, s[64:67], s13 offen offset:0 sc1
    buffer_load_dwordx2 v[22:23], v18, s[64:67], s13 offen offset:128 sc1
    s_mov_b64 exec, -1
    s_cmp_lt_u32 s82, 40000
    s_cbranch_scc1 Lpk_12
Lpkd_13:
    ds_add_u32 v78, v76
    s_mov_b32 m0, 40960
    s_mov_b32 s12, 40960
    buffer_load_dwordx4 v8, s[64:67], s12 offen sc1 lds
    s_waitcnt lgkmcnt(0)
    s_branch Lpkg_15
Lpko_14:
    s_mov_b32 s82, 0
    ds_read_b32 v75, v74
Lq_17:
    s_waitcnt lgkmcnt(0)
    v_readfirstlane_b32 s83, v75
    s_add_u32 s82, s82, 1
    s_and_b32 s83, s83, 255
    s_cmp_ge_u32 s83, 64
    s_cbranch_scc1 Lqd_18
    s_sleep 1
    ds_read_b32 v75, v74
    s_cmp_lt_u32 s82, 0x40000
    s_cbranch_scc1 Lq_17
    s_waitcnt lgkmcnt(0)
Lqd_18:
Lpkg_15:
    s_mov_b32 s82, 0
    v_mfma_f32_32x32x16_bf16 v[48:63], v[204:207], v[212:215], v[48:63]
    s_add_u32 m0, s51, 0
    ds_read_b64_tr_b16 v[170:171], v73 offset:10400
    ds_read_b128 v[176:179], v68 offset:8192
    buffer_load_dwordx4 v8, s[64:67], m0 offen sc1 lds
    v_mfma_f32_32x32x16_bf16 v[32:47], v[216:219], v[220:223], v[32:47]
    s_add_u32 m0, s51, 4096
    v_add_u32 v69, 0x10000, v69
    ds_read_b64_tr_b16 v[180:181], v73 offset:12800
    ds_read_b128 v[184:187], v69 offset:0
    buffer_load_dwordx4 v8, s[64:67], m0 offen sc1 lds
    ds_read_b32 v75, v74
    v_mfma_f32_32x32x16_bf16 v[48:63], v[216:219], v[224:227], v[48:63]
    s_add_u32 m0, s51, 8192
    ds_read_b64_tr_b16 v[182:183], v73 offset:12960
    ds_read_b128 v[188:191], v69 offset:8192
    buffer_load_dwordx4 v8, s[64:67], m0 offen sc1 lds
    v_mfma_f32_32x32x16_bf16 v[32:47], v[228:231], v[232:235], v[32:47]
    s_add_u32 m0, s51, 12288
    v_add_u32 v70, 0x10000, v70
    ds_read_b64_tr_b16 v[192:193], v73 offset:15360
    ds_read_b128 v[196:199], v70 offset:0
    buffer_load_dwordx4 v8, s[64:67], m0 offen sc1 lds
    v_mfma_f32_32x32x16_bf16 v[48:63], v[228:231], v[236:239], v[48:63]
    s_add_u32 m0, s51, 16384
    ds_read_b64_tr_b16 v[194:195], v73 offset:15520
    ds_read_b128 v[200:203], v70 offset:8192
    buffer_load_dwordx4 v8, s[64:67], m0 offen sc1 lds
    s_waitcnt lgkmcnt(9)
    v_mfma_f32_32x32x16_bf16 v[32:47], v[168:171], v[172:175], v[32:47]
    s_waitcnt lgkmcnt(6)
    v_cmp_gt_u32_sdwa vcc, 16, v75 src0_sel:DWORD src1_sel:BYTE_1
    s_cbranch_vccnz Lck_19s
Lck_19:
    v_add_u32 v71, 0x10000, v71
    ds_read_b64_tr_b16 v[204:205], v73 offset:17920
    ds_read_b128 v[208:211], v71 offset:0
    v_mfma_f32_32x32x16_bf16 v[48:63], v[168:171], v[176:179], v[48:63]
    s_add_u32 m0, s51, 20480
    ds_read_b64_tr_b16 v[206:207], v73 offset:18080
    ds_read_b128 v[212:215], v71 offset:8192
    buffer_load_dwordx4 v8, s[64:67], m0 offen sc1 lds
    s_waitcnt lgkmcnt(8)
    v_mfma_f32_32x32x16_bf16 v[32:47], v[180:183], v[184:187], v[32:47]
    s_add_u32 m0, s51, 24576
    s_nop 0
    buffer_load_dwordx4 v8, s[64:67], m0 offen sc1 lds
    v_mfma_f32_32x32x16_bf16 v[48:63], v[180:183], v[188:191], v[48:63]
    s_add_u32 m0, s51, 28672
    s_nop 0
    buffer_load_dwordx4 v8, s[64:67], m0 offen sc1 lds
    s_waitcnt lgkmcnt(4)
    v_mfma_f32_32x32x16_bf16 v[32:47], v[192:195], v[196:199], v[32:47]
    s_add_u32 m0, s51, 32768
    s_nop 0
    buffer_load_dwordx4 v8, s[64:67], m0 offen sc1 lds
    v_mfma_f32_32x32x16_bf16 v[48:63], v[192:195], v[200:203], v[48:63]
    s_add_u32 m0, s51, 36864
    s_nop 0
    buffer_load_dwordx4 v8, s[64:67], m0 offen sc1 lds
    s_waitcnt lgkmcnt(0)
    v_mfma_f32_32x32x16_bf16 v[32:47], v[204:207], v[208:211], v[32:47]
    v_mfma_f32_32x32x16_bf16 v[48:63], v[204:207], v[212:215], v[48:63]
    s_branch L_a_Q
Lck_3s:
    ds_read_b32 v75, v74
    s_add_u32 s82, s82, 1
    s_waitcnt lgkmcnt(0)
    v_cmp_gt_u32_sdwa vcc, 8, v75 src0_sel:DWORD src1_sel:BYTE_0
    s_cbranch_vccz Lck_3
    s_cmp_lt_u32 s82, 0x40000
    s_cbranch_scc1 Lck_3s
    s_branch Lck_3
Lck_4s:
    ds_read_b32 v75, v74
    s_add_u32 s82, s82, 1
    s_waitcnt lgkmcnt(0)
    v_cmp_gt_u32_sdwa vcc, 4, v75 src0_sel:DWORD src1_sel:BYTE_1
    s_cbranch_vccz Lck_4
    s_cmp_lt_u32 s82, 0x40000
    s_cbranch_scc1 Lck_4s
    s_branch Lck_4
Lck_5s:
    ds_read_b32 v75, v74
    s_add_u32 s82, s82, 1
    s_waitcnt lgkmcnt(0)
    v_cmp_gt_u32_sdwa vcc, 12, v75 src0_sel:DWORD src1_sel:BYTE_0
    s_cbranch_vccz Lck_5
    s_cmp_lt_u32 s82, 0x40000
    s_cbranch_scc1 Lck_5s
    s_branch Lck_5
Lck_6s:
    ds_read_b32 v75, v74
    s_add_u32 s82, s82, 1
    s_waitcnt lgkmcnt(0)
    v_cmp_gt_u32_sdwa vcc, 8, v75 src0_sel:DWORD src1_sel:BYTE_1
    s_cbranch_vccz Lck_6
    s_cmp_lt_u32 s82, 0x40000
    s_cbranch_scc1 Lck_6s
    s_branch Lck_6
Lck_7s:
    ds_read_b32 v75, v74
    s_add_u32 s82, s82, 1
    s_waitcnt lgkmcnt(0)
    v_cmp_gt_u32_sdwa vcc, 16, v75 src0_sel:DWORD src1_sel:BYTE_0
    s_cbranch_vccz Lck_7
    s_cmp_lt_u32 s82, 0x40000
    s_cbranch_scc1 Lck_7s
    s_branch Lck_7
Lck_8s:
    ds_read_b32 v75, v74
    s_add_u32 s82, s82, 1
    s_waitcnt lgkmcnt(0)
    v_cmp_gt_u32_sdwa vcc, 20, v75 src0_sel:DWORD src1_sel:BYTE_0
    s_cbranch_vccz Lck_8
    s_cmp_lt_u32 s82, 0x40000
    s_cbranch_scc1 Lck_8s
    s_branch Lck_8
Lck_9s:
    ds_read_b32 v75, v74
    s_add_u32 s82, s82, 1
    s_waitcnt lgkmcnt(0)
    v_cmp_gt_u32_sdwa vcc, 12, v75 src0_sel:DWORD src1_sel:BYTE_1
    s_cbranch_vccz Lck_9
    s_cmp_lt_u32 s82, 0x40000
    s_cbranch_scc1 Lck_9s
    s_branch Lck_9
Lck_19s:
    ds_read_b32 v75, v74
    s_add_u32 s82, s82, 1
    s_waitcnt lgkmcnt(0)
    v_cmp_gt_u32_sdwa vcc, 16, v75 src0_sel:DWORD src1_sel:BYTE_1
    s_cbranch_vccz Lck_19
    s_cmp_lt_u32 s82, 0x40000
    s_cbranch_scc1 Lck_19s
    s_branch Lck_19
L_a_P2:
    s_waitcnt vmcnt(8)
    s_barrier
    s_add_u32 m0, s85, 0
    s_nop 0
    buffer_load_dwordx4 v2, s[56:59], s33 offen lds
    s_add_u32 m0, s85, 1024
    s_nop 0
    buffer_load_dwordx4 v3, s[56:59], s33 offen lds
    s_add_u32 m0, s85, 2048
    s_nop 0
    buffer_load_dwordx4 v4, s[56:59], s33 offen lds
    s_add_u32 m0, s85, 3072
    s_nop 0
    buffer_load_dwordx4 v5, s[56:59], s33 offen lds
    s_add_u32 m0, s85, 4096
    s_nop 0
    buffer_load_dwordx4 v6, s[56:59], s33 offen lds
    v_and_b32 v20, 31, v0
    v_lshrrev_b32 v21, 5, v0
    v_and_b32 v22, 15, v20
    v_xor_b32 v22, v22, v21
    v_lshlrev_b32 v22, 4, v22
    v_lshl_or_b32 v64, v20, 8, v22
    v_xor_b32 v65, 32, v64
    v_xor_b32 v66, 64, v64
    v_xor_b32 v67, 96, v64
    v_xor_b32 v68, 128, v64
    v_xor_b32 v69, 160, v64
    v_xor_b32 v70, 192, v64
    v_xor_b32 v71, 224, v64
    v_bfe_u32 v22, v0, 2, 2
    v_lshlrev_b32 v22, 1, v22
    v_lshl_add_u32 v22, v21, 3, v22
    v_mul_u32_u24 v22, 0xa0, v22
    v_bfe_u32 v23, v0, 4, 1
    v_and_b32 v24, 3, v0
    v_lshl_add_u32 v23, v23, 2, v24
    v_cmp_lt_u32 vcc, 4, v23
    v_mov_b32 v24, 0x30000
    v_lshl_add_u32 v22, v23, 3, v22
    s_mul_i32 s12, s3, 40
    s_add_u32 s12, s12, 81920
    v_cndmask_b32 v22, v22, v24, vcc
    v_add_u32 v72, s12, v22
    v_add_u32 v73, 58368, v72
    v_mov_b32 v74, 163824
    v_mov_b32 v76, 1
    v_mov_b32 v77, 0x100
    v_min_u32 v78, 1, v0
    v_lshl_add_u32 v78, v78, 15, v74
    v_mov_b32 v1, 0
    s_mov_b32 s64, s48
    s_mov_b32 s65, s49
    s_mov_b32 s66, 6291456
    s_mov_b32 s67, 0x20000
    s_mov_b32 s68, s44
    s_mov_b32 s69, s45
    s_mov_b32 s70, 5242880
    s_mov_b32 s71, 0x20000
    s_mov_b32 s72, s24
    s_mov_b32 s73, s25
    s_mov_b32 s74, 819200
    s_mov_b32 s75, 0x20000
    s_mov_b32 s76, s26
    s_mov_b32 s77, s27
    s_mov_b32 s78, 2621440
    s_mov_b32 s79, 0x20000
    s_lshl_b32 s11, s3, 11
    s_lshr_b32 s12, s2, 3
    s_add_u32 s11, s11, s12
    s_lshl_b32 s11, s11, 7
    v_lshl_add_u32 v154, v0, 12, s11
    s_mul_i32 s11, s3, 6144
    s_add_u32 s11, s11, 41984
    v_add_u32 v9, s11, v8
    s_mul_i32 s14, s4, 81920
    s_add_u32 s14, s14, 262144
    s_mul_i32 s15, s5, 2560
    s_add_u32 s15, s15, s14
    v_mov_b32 v144, 0xdddddddd
    v_mov_b32 v145, v8
    v_add_u32 v146, 41984, v8
    v_add_u32 v147, 83968, v8
    v_mov_b64 v[80:81], 0
    v_mov_b64 v[82:83], 0
    v_mov_b64 v[84:85], 0
    v_mov_b64 v[86:87], 0
    v_mov_b64 v[88:89], 0
    v_mov_b64 v[90:91], 0
    v_mov_b64 v[92:93], 0
    v_mov_b64 v[94:95], 0
    v_mov_b64 v[96:97], 0
    v_mov_b64 v[98:99], 0
    v_mov_b64 v[100:101], 0
    v_mov_b64 v[102:103], 0
    v_mov_b64 v[104:105], 0
    v_mov_b64 v[106:107], 0
    v_mov_b64 v[108:109], 0
    v_mov_b64 v[110:111], 0
    s_waitcnt vmcnt(5)
    s_barrier
    s_add_u32 m0, s85, 58368
    s_nop 0
    buffer_load_dwordx4 v2, s[56:59], s34 offen lds
    s_add_u32 m0, s85, 59392
    s_nop 0
    buffer_load_dwordx4 v3, s[56:59], s34 offen lds
    s_add_u32 m0, s85, 60416
    s_nop 0
    buffer_load_dwordx4 v4, s[56:59], s34 offen lds
    s_add_u32 m0, s85, 61440
    s_nop 0
    buffer_load_dwordx4 v5, s[56:59], s34 offen lds
    s_add_u32 m0, s85, 62464
    s_nop 0
    buffer_load_dwordx4 v6, s[56:59], s34 offen lds
    v_mov_b32 v10, v149
    v_mov_b32 v11, v150
    v_add_u32 v149, 41984, v148
    v_add_u32 v150, 83968, v148
    v_add_u32 v152, 41984, v151
    v_add_u32 v153, 83968, v151
    s_and_b32 s13, s3, 1
    s_mul_i32 s10, s13, 15360
    s_sub_u32 s10, s10, 10240
    s_mul_i32 s11, s13, 10240
    s_add_u32 s11, s11, 5120
    v_add_u32 v240, s10, v240
    v_add_u32 v241, s10, v241
    v_add_u32 v242, s10, v242
    v_add_u32 v243, s10, v243
    v_add_u32 v244, s10, v244
    v_add_u32 v245, s10, v245
    v_add_u32 v246, s11, v246
    v_add_u32 v247, s11, v247
    v_add_u32 v248, s11, v248
    v_add_u32 v249, s11, v249
    s_lshl_b32 s13, s3, 3
    s_mul_i32 s10, s5, 160
    s_lshr_b32 s11, 0xf0c0b0a, s13
    s_and_b32 s11, s11, 0xff
    s_mul_i32 s11, s11, 40960
    s_add_u32 s93, s11, s10
    s_lshr_b32 s11, 0xe0d1110, s13
    s_and_b32 s11, s11, 0xff
    s_mul_i32 s11, s11, 40960
    s_add_u32 s94, s11, s10
    s_lshr_b32 s11, 0x9081312, s13
    s_and_b32 s11, s11, 0xff
    s_mul_i32 s11, s11, 40960
    s_add_u32 s95, s11, s10
    v_lshlrev_b32 v252, 24, v0
    s_mov_b32 s10, 0x3ea52b5c
    s_mul_i32 s13, s3, 2560
    s_add_u32 s13, s13, 90112
    v_add_u32 v12, s13, v8
    v_lshl_add_u32 v13, v0, 3, s13
    v_lshlrev_b32 v18, 8, v0
    s_and_b32 s13, s2, 7
    s_lshl_b32 s13, s13, 14
    s_cmp_eq_u32 s3, 0
    s_cselect_b32 s13, s13, 0x80000000
    s_add_u32 s13, s13, 5767168
    s_getreg_b32 s97, hwreg(HW_REG_XCC_ID, 0, 4)
    s_lshl_b32 s97, s97, 28
    s_barrier
    s_waitcnt vmcnt(5)
    ds_add_u32 v78, v76
    s_mov_b32 s82, 0
    ds_read_b32 v75, v74
Lq_20:
    s_waitcnt lgkmcnt(0)
    v_readfirstlane_b32 s83, v75
    s_add_u32 s82, s82, 1
    s_and_b32 s83, s83, 63
    s_cmp_ge_u32 s83, 4
    s_cbranch_scc1 Lqd_21
    ds_read_b32 v75, v74
    s_cmp_lt_u32 s82, 0x40000
    s_cbranch_scc1 Lq_20
    s_waitcnt lgkmcnt(0)
Lqd_21:
    s_mov_b32 s82, 0
    ds_read_b64_tr_b16 v[168:169], v72 offset:0
    ds_read_b128 v[172:175], v64 offset:0
    ds_read_b64_tr_b16 v[170:171], v72 offset:160
    ds_read_b128 v[176:179], v64 offset:8192
    ds_read_b64_tr_b16 v[180:181], v72 offset:2560
    ds_read_b128 v[184:187], v65 offset:0
    ds_read_b64_tr_b16 v[182:183], v72 offset:2720
    ds_read_b128 v[188:191], v65 offset:8192
    ds_read_b64_tr_b16 v[192:193], v72 offset:5120
    ds_read_b128 v[196:199], v66 offset:0
    ds_read_b64_tr_b16 v[194:195], v72 offset:5280
    ds_read_b128 v[200:203], v66 offset:8192
    s_waitcnt lgkmcnt(8)
    v_mfma_f32_32x32x16_bf16 v[32:47], v[168:171], v[172:175], 0
    s_add_u32 m0, s85, 37888
    ds_read_b64_tr_b16 v[204:205], v72 offset:7680
    ds_read_b128 v[208:211], v67 offset:0
    buffer_load_dwordx4 v2, s[56:59], s35 offen lds
    v_mfma_f32_32x32x16_bf16 v[48:63], v[168:171], v[176:179], 0
    s_add_u32 m0, s85, 38912
    ds_read_b64_tr_b16 v[206:207], v72 offset:7840
    ds_read_b128 v[212:215], v67 offset:8192
    buffer_load_dwordx4 v3, s[56:59], s35 offen lds
    s_waitcnt lgkmcnt(8)
    v_mfma_f32_32x32x16_bf16 v[32:47], v[180:183], v[184:187], v[32:47]
    s_add_u32 m0, s85, 39936
    ds_read_b64_tr_b16 v[216:217], v72 offset:10240
    ds_read_b128 v[220:223], v68 offset:0
    buffer_load_dwordx4 v4, s[56:59], s35 offen lds
    v_mfma_f32_32x32x16_bf16 v[48:63], v[180:183], v[188:191], v[48:63]
    s_add_u32 m0, s85, 40960
    ds_read_b64_tr_b16 v[218:219], v72 offset:10400
    ds_read_b128 v[224:227], v68 offset:8192
    buffer_load_dwordx4 v5, s[56:59], s35 offen lds
    s_waitcnt lgkmcnt(8)
    v_mfma_f32_32x32x16_bf16 v[32:47], v[192:195], v[196:199], v[32:47]
    s_add_u32 m0, s85, 41984
    ds_read_b64_tr_b16 v[228:229], v72 offset:12800
    ds_read_b128 v[232:235], v69 offset:0
    buffer_load_dwordx4 v6, s[56:59], s35 offen lds
    v_mfma_f32_32x32x16_bf16 v[48:63], v[192:195], v[200:203], v[48:63]
    ds_read_b64_tr_b16 v[230:231], v72 offset:12960
    ds_read_b128 v[236:239], v69 offset:8192
    s_waitcnt vmcnt(5)
    ds_add_u32 v78, v76
    s_waitcnt lgkmcnt(9)
    v_mfma_f32_32x32x16_bf16 v[32:47], v[204:207], v[208:211], v[32:47]
    ds_read_b64_tr_b16 v[168:169], v72 offset:15360
    ds_read_b128 v[172:175], v70 offset:0
    v_mfma_f32_32x32x16_bf16 v[48:63], v[204:207], v[212:215], v[48:63]
    ds_read_b64_tr_b16 v[170:171], v72 offset:15520
    ds_read_b128 v[176:179], v70 offset:8192
    ds_read_b32 v75, v74
    s_waitcnt lgkmcnt(10)
    v_mfma_f32_32x32x16_bf16 v[32:47], v[216:219], v[220:223], v[32:47]
    ds_read_b64_tr_b16 v[180:181], v72 offset:17920
    ds_read_b128 v[184:187], v71 offset:0
    v_mfma_f32_32x32x16_bf16 v[48:63], v[216:219], v[224:227], v[48:63]
    ds_read_b64_tr_b16 v[182:183], v72 offset:18080
    ds_read_b128 v[188:191], v71 offset:8192
    ds_add_u32 v78, v77
    s_waitcnt lgkmcnt(11)
    v_mfma_f32_32x32x16_bf16 v[32:47], v[228:231], v[232:235], v[32:47]
    s_waitcnt lgkmcnt(5)
    v_cmp_gt_u32_sdwa vcc, 8, v75 src0_sel:DWORD src1_sel:BYTE_0
    s_cbranch_vccnz Lck_22s
Lck_22:
    ds_read_b64_tr_b16 v[192:193], v73 offset:0
    ds_read_b128 v[196:199], v64 offset:16384
    v_mfma_f32_32x32x16_bf16 v[48:63], v[228:231], v[236:239], v[48:63]
    ds_read_b64_tr_b16 v[194:195], v73 offset:160
    ds_read_b128 v[200:203], v64 offset:24576
    ds_read_b32 v75, v74
    v_mfma_f32_32x32x16_bf16 v[32:47], v[168:171], v[172:175], v[32:47]
    ds_read_b64_tr_b16 v[204:205], v73 offset:2560
    ds_read_b128 v[208:211], v65 offset:16384
    v_mfma_f32_32x32x16_bf16 v[48:63], v[168:171], v[176:179], v[48:63]
    ds_read_b64_tr_b16 v[206:207], v73 offset:2720
    ds_read_b128 v[212:215], v65 offset:24576
    s_waitcnt lgkmcnt(10)
    v_mfma_f32_32x32x16_bf16 v[32:47], v[180:183], v[184:187], v[32:47]
    ds_read_b64_tr_b16 v[216:217], v73 offset:5120
    ds_read_b128 v[220:223], v66 offset:16384
    v_mfma_f32_32x32x16_bf16 v[48:63], v[180:183], v[188:191], v[48:63]
    s_waitcnt lgkmcnt(6)
    v_cmp_gt_u32_sdwa vcc, 4, v75 src0_sel:DWORD src1_sel:BYTE_1
    s_cbranch_vccnz Lck_23s
Lck_23:
    ds_read_b64_tr_b16 v[218:219], v73 offset:5280
    ds_read_b128 v[224:227], v66 offset:24576
    v_mfma_f32_32x32x16_bf16 v[32:47], v[192:195], v[196:199], v[32:47]
    s_add_u32 m0, s85, 0
    ds_read_b64_tr_b16 v[228:229], v73 offset:7680
    ds_read_b128 v[232:235], v67 offset:16384
    buffer_load_dwordx4 v2, s[56:59], s36 offen lds
    v_mfma_f32_32x32x16_bf16 v[48:63], v[192:195], v[200:203], v[48:63]
    s_add_u32 m0, s85, 1024
    ds_read_b64_tr_b16 v[230:231], v73 offset:7840
    ds_read_b128 v[236:239], v67 offset:24576
    buffer_load_dwordx4 v3, s[56:59], s36 offen lds
    s_waitcnt lgkmcnt(8)
    v_mfma_f32_32x32x16_bf16 v[32:47], v[204:207], v[208:211], v[32:47]
    s_add_u32 m0, s85, 2048
    ds_read_b64_tr_b16 v[168:169], v73 offset:10240
    ds_read_b128 v[172:175], v68 offset:16384
    buffer_load_dwordx4 v4, s[56:59], s36 offen lds
    v_mfma_f32_32x32x16_bf16 v[48:63], v[204:207], v[212:215], v[48:63]
    s_add_u32 m0, s85, 3072
    ds_read_b64_tr_b16 v[170:171], v73 offset:10400
    ds_read_b128 v[176:179], v68 offset:24576
    buffer_load_dwordx4 v5, s[56:59], s36 offen lds
    s_waitcnt lgkmcnt(8)
    v_mfma_f32_32x32x16_bf16 v[32:47], v[216:219], v[220:223], v[32:47]
    s_add_u32 m0, s85, 4096
    ds_read_b64_tr_b16 v[180:181], v73 offset:12800
    ds_read_b128 v[184:187], v69 offset:16384
    buffer_load_dwordx4 v6, s[56:59], s36 offen lds
    v_mfma_f32_32x32x16_bf16 v[48:63], v[216:219], v[224:227], v[48:63]
    ds_read_b64_tr_b16 v[182:183], v73 offset:12960
    ds_read_b128 v[188:191], v69 offset:24576
    s_waitcnt vmcnt(5)
    ds_add_u32 v78, v76
    s_waitcnt lgkmcnt(9)
    v_mfma_f32_32x32x16_bf16 v[32:47], v[228:231], v[232:235], v[32:47]
    ds_read_b64_tr_b16 v[192:193], v73 offset:15360
    ds_read_b128 v[196:199], v70 offset:16384
    v_mfma_f32_32x32x16_bf16 v[48:63], v[228:231], v[236:239], v[48:63]
    ds_read_b64_tr_b16 v[194:195], v73 offset:15520
    ds_read_b128 v[200:203], v70 offset:24576
    ds_read_b32 v75, v74
    s_waitcnt lgkmcnt(10)
    v_mfma_f32_32x32x16_bf16 v[32:47], v[168:171], v[172:175], v[32:47]
    ds_read_b64_tr_b16 v[204:205], v73 offset:17920
    ds_read_b128 v[208:211], v71 offset:16384
    v_mfma_f32_32x32x16_bf16 v[48:63], v[168:171], v[176:179], v[48:63]
    ds_read_b64_tr_b16 v[206:207], v73 offset:18080
    ds_read_b128 v[212:215], v71 offset:24576
    ds_add_u32 v78, v77
    s_waitcnt lgkmcnt(11)
    v_mfma_f32_32x32x16_bf16 v[32:47], v[180:183], v[184:187], v[32:47]
    s_waitcnt lgkmcnt(5)
    v_cmp_gt_u32_sdwa vcc, 12, v75 src0_sel:DWORD src1_sel:BYTE_0
    s_cbranch_vccnz Lck_24s
Lck_24:
    ds_read_b64_tr_b16 v[216:217], v72 offset:37888
    ds_read_b128 v[220:223], v64 offset:32768
    v_mfma_f32_32x32x16_bf16 v[48:63], v[180:183], v[188:191], v[48:63]
    ds_read_b64_tr_b16 v[218:219], v72 offset:38048
    ds_read_b128 v[224:227], v64 offset:40960
    ds_read_b32 v75, v74
    v_mfma_f32_32x32x16_bf16 v[32:47], v[192:195], v[196:199], v[32:47]
    ds_read_b64_tr_b16 v[228:229], v72 offset:40448
    ds_read_b128 v[232:235], v65 offset:32768
    v_mfma_f32_32x32x16_bf16 v[48:63], v[192:195], v[200:203], v[48:63]
    ds_read_b64_tr_b16 v[230:231], v72 offset:40608
    ds_read_b128 v[236:239], v65 offset:40960
    s_waitcnt lgkmcnt(10)
    v_mfma_f32_32x32x16_bf16 v[32:47], v[204:207], v[208:211], v[32:47]
    ds_read_b64_tr_b16 v[168:169], v72 offset:43008
    ds_read_b128 v[172:175], v66 offset:32768
    v_mfma_f32_32x32x16_bf16 v[48:63], v[204:207], v[212:215], v[48:63]
    s_waitcnt lgkmcnt(6)
    v_cmp_gt_u32_sdwa vcc, 8, v75 src0_sel:DWORD src1_sel:BYTE_1
    s_cbranch_vccnz Lck_25s
Lck_25:
    ds_read_b64_tr_b16 v[170:171], v72 offset:43168
    ds_read_b128 v[176:179], v66 offset:40960
    v_mfma_f32_32x32x16_bf16 v[32:47], v[216:219], v[220:223], v[32:47]
    s_add_u32 m0, s85, 58368
    ds_read_b64_tr_b16 v[180:181], v72 offset:45568
    ds_read_b128 v[184:187], v67 offset:32768
    buffer_load_dwordx4 v2, s[56:59], s37 offen lds
    v_mfma_f32_32x32x16_bf16 v[48:63], v[216:219], v[224:227], v[48:63]
    s_add_u32 m0, s85, 59392
    ds_read_b64_tr_b16 v[182:183], v72 offset:45728
    ds_read_b128 v[188:191], v67 offset:40960
    buffer_load_dwordx4 v3, s[56:59], s37 offen lds
    s_waitcnt lgkmcnt(8)
    v_mfma_f32_32x32x16_bf16 v[32:47], v[228:231], v[232:235], v[32:47]
    s_add_u32 m0, s85, 60416
    ds_read_b64_tr_b16 v[192:193], v72 offset:48128
    ds_read_b128 v[196:199], v68 offset:32768
    buffer_load_dwordx4 v4, s[56:59], s37 offen lds
    v_mfma_f32_32x32x16_bf16 v[48:63], v[228:231], v[236:239], v[48:63]
    s_add_u32 m0, s85, 61440
    ds_read_b64_tr_b16 v[194:195], v72 offset:48288
    ds_read_b128 v[200:203], v68 offset:40960
    buffer_load_dwordx4 v5, s[56:59], s37 offen lds
    s_waitcnt lgkmcnt(8)
    v_mfma_f32_32x32x16_bf16 v[32:47], v[168:171], v[172:175], v[32:47]
    s_add_u32 m0, s85, 62464
    ds_read_b64_tr_b16 v[204:205], v72 offset:50688
    ds_read_b128 v[208:211], v69 offset:32768
    buffer_load_dwordx4 v6, s[56:59], s37 offen lds
    v_mfma_f32_32x32x16_bf16 v[48:63], v[168:171], v[176:179], v[48:63]
    ds_read_b64_tr_b16 v[206:207], v72 offset:50848
    ds_read_b128 v[212:215], v69 offset:40960
    s_waitcnt vmcnt(5)
    ds_add_u32 v78, v76
    s_waitcnt lgkmcnt(9)
    v_mfma_f32_32x32x16_bf16 v[32:47], v[180:183], v[184:187], v[32:47]
    ds_read_b64_tr_b16 v[216:217], v72 offset:53248
    ds_read_b128 v[220:223], v70 offset:32768
    global_load_dwordx2 v[16:17], v1, s[46:47] sc1
    v_mfma_f32_32x32x16_bf16 v[48:63], v[180:183], v[188:191], v[48:63]
    ds_read_b64_tr_b16 v[218:219], v72 offset:53408
    ds_read_b128 v[224:227], v70 offset:40960
    ds_read_b32 v75, v74
    s_waitcnt lgkmcnt(10)
    v_mfma_f32_32x32x16_bf16 v[32:47], v[192:195], v[196:199], v[32:47]
    ds_read_b64_tr_b16 v[228:229], v72 offset:55808
    ds_read_b128 v[232:235], v71 offset:32768
    v_mfma_f32_32x32x16_bf16 v[48:63], v[192:195], v[200:203], v[48:63]
    ds_read_b64_tr_b16 v[230:231], v72 offset:55968
    ds_read_b128 v[236:239], v71 offset:40960
    ds_add_u32 v78, v77
    s_waitcnt lgkmcnt(11)
    v_mfma_f32_32x32x16_bf16 v[32:47], v[204:207], v[208:211], v[32:47]
    s_waitcnt lgkmcnt(5)
    v_cmp_gt_u32_sdwa vcc, 16, v75 src0_sel:DWORD src1_sel:BYTE_0
    s_cbranch_vccnz Lck_26s
Lck_26:
    ds_read_b64_tr_b16 v[168:169], v72 offset:0
    ds_read_b128 v[172:175], v64 offset:49152
    v_mfma_f32_32x32x16_bf16 v[48:63], v[204:207], v[212:215], v[48:63]
    ds_read_b64_tr_b16 v[170:171], v72 offset:160
    ds_read_b128 v[176:179], v64 offset:57344
    v_mfma_f32_32x32x16_bf16 v[32:47], v[216:219], v[220:223], v[32:47]
    ds_read_b64_tr_b16 v[180:181], v72 offset:2560
    ds_read_b128 v[184:187], v65 offset:49152
    v_mfma_f32_32x32x16_bf16 v[48:63], v[216:219], v[224:227], v[48:63]
    ds_read_b64_tr_b16 v[182:183], v72 offset:2720
    ds_read_b128 v[188:191], v65 offset:57344
    s_waitcnt lgkmcnt(9)
    v_mfma_f32_32x32x16_bf16 v[32:47], v[228:231], v[232:235], v[32:47]
    ds_read_b64_tr_b16 v[192:193], v72 offset:5120
    ds_read_b128 v[196:199], v66 offset:49152
    v_mfma_f32_32x32x16_bf16 v[48:63], v[228:231], v[236:239], v[48:63]
    ds_read_b64_tr_b16 v[194:195], v72 offset:5280
    ds_read_b128 v[200:203], v66 offset:57344
    s_waitcnt lgkmcnt(8)
    v_mfma_f32_32x32x16_bf16 v[32:47], v[168:171], v[172:175], v[32:47]
    ds_read_b64_tr_b16 v[204:205], v72 offset:7680
    ds_read_b128 v[208:211], v67 offset:49152
    v_mfma_f32_32x32x16_bf16 v[48:63], v[168:171], v[176:179], v[48:63]
    ds_read_b64_tr_b16 v[206:207], v72 offset:7840
    ds_read_b128 v[212:215], v67 offset:57344
    s_waitcnt lgkmcnt(8)
    v_mfma_f32_32x32x16_bf16 v[32:47], v[180:183], v[184:187], v[32:47]
    ds_read_b64_tr_b16 v[216:217], v72 offset:10240
    ds_read_b128 v[220:223], v68 offset:49152
    v_mfma_f32_32x32x16_bf16 v[48:63], v[180:183], v[188:191], v[48:63]
    ds_read_b64_tr_b16 v[218:219], v72 offset:10400
    ds_read_b128 v[224:227], v68 offset:57344
    s_waitcnt lgkmcnt(8)
    v_mfma_f32_32x32x16_bf16 v[32:47], v[192:195], v[196:199], v[32:47]
    ds_read_b64_tr_b16 v[228:229], v72 offset:12800
    ds_read_b128 v[232:235], v69 offset:49152
    v_mfma_f32_32x32x16_bf16 v[48:63], v[192:195], v[200:203], v[48:63]
    ds_read_b64_tr_b16 v[230:231], v72 offset:12960
    ds_read_b128 v[236:239], v69 offset:57344
    s_waitcnt vmcnt(0)
    ds_add_u32 v78, v76
    s_waitcnt lgkmcnt(9)
    v_mfma_f32_32x32x16_bf16 v[32:47], v[204:207], v[208:211], v[32:47]
    ds_read_b64_tr_b16 v[168:169], v72 offset:15360
    ds_read_b128 v[172:175], v70 offset:49152
    v_mfma_f32_32x32x16_bf16 v[48:63], v[204:207], v[212:215], v[48:63]
    ds_read_b64_tr_b16 v[170:171], v72 offset:15520
    ds_read_b128 v[176:179], v70 offset:57344
    ds_read_b32 v75, v74
    s_waitcnt lgkmcnt(10)
    v_mfma_f32_32x32x16_bf16 v[32:47], v[216:219], v[220:223], v[32:47]
    ds_read_b64_tr_b16 v[180:181], v72 offset:17920
    ds_read_b128 v[184:187], v71 offset:49152
    v_mfma_f32_32x32x16_bf16 v[48:63], v[216:219], v[224:227], v[48:63]
    ds_read_b64_tr_b16 v[182:183], v72 offset:18080
    ds_read_b128 v[188:191], v71 offset:57344
    ds_add_u32 v78, v77
    s_waitcnt lgkmcnt(11)
    v_mfma_f32_32x32x16_bf16 v[32:47], v[228:231], v[232:235], v[32:47]
    s_waitcnt lgkmcnt(5)
    v_cmp_gt_u32_sdwa vcc, 20, v75 src0_sel:DWORD src1_sel:BYTE_0
    s_cbranch_vccnz Lck_27s
Lck_27:
    v_cmp_gt_u32_sdwa vcc, 12, v75 src0_sel:DWORD src1_sel:BYTE_1
    s_cbranch_vccnz Lck_28s
Lck_28:
    v_add_u32 v64, 0x10000, v64
    ds_read_b64_tr_b16 v[192:193], v73 offset:0
    ds_read_b128 v[196:199], v64 offset:0
    v_mfma_f32_32x32x16_bf16 v[48:63], v[228:231], v[236:239], v[48:63]
    ds_read_b64_tr_b16 v[194:195], v73 offset:160
    ds_read_b128 v[200:203], v64 offset:8192
    v_mfma_f32_32x32x16_bf16 v[32:47], v[168:171], v[172:175], v[32:47]
    v_add_u32 v65, 0x10000, v65
    ds_read_b64_tr_b16 v[204:205], v73 offset:2560
    ds_read_b128 v[208:211], v65 offset:0
    v_mfma_f32_32x32x16_bf16 v[48:63], v[168:171], v[176:179], v[48:63]
    ds_read_b64_tr_b16 v[206:207], v73 offset:2720
    ds_read_b128 v[212:215], v65 offset:8192
    s_waitcnt lgkmcnt(9)
    v_mfma_f32_32x32x16_bf16 v[32:47], v[180:183], v[184:187], v[32:47]
    v_add_u32 v66, 0x10000, v66
    ds_read_b64_tr_b16 v[216:217], v73 offset:5120
    ds_read_b128 v[220:223], v66 offset:0
    v_mfma_f32_32x32x16_bf16 v[48:63], v[180:183], v[188:191], v[48:63]
    ds_read_b64_tr_b16 v[218:219], v73 offset:5280
    ds_read_b128 v[224:227], v66 offset:8192
    s_waitcnt lgkmcnt(8)
    v_mfma_f32_32x32x16_bf16 v[32:47], v[192:195], v[196:199], v[32:47]
    v_add_u32 v67, 0x10000, v67
    ds_read_b64_tr_b16 v[228:229], v73 offset:7680
    ds_read_b128 v[232:235], v67 offset:0
    buffer_load_dwordx2 v[20:21], v18, s[64:67], s13 offen offset:0 sc1
    v_mfma_f32_32x32x16_bf16 v[48:63], v[192:195], v[200:203], v[48:63]
    ds_read_b64_tr_b16 v[230:231], v73 offset:7840
    ds_read_b128 v[236:239], v67 offset:8192
    buffer_load_dwordx2 v[22:23], v18, s[64:67], s13 offen offset:128 sc1
    s_waitcnt lgkmcnt(8)
    v_mfma_f32_32x32x16_bf16 v[32:47], v[204:207], v[208:211], v[32:47]
    v_add_u32 v68, 0x10000, v68
    ds_read_b64_tr_b16 v[168:169], v73 offset:10240
    ds_read_b128 v[172:175], v68 offset:0
    s_mov_b32 s82, 0
Lnon_29:
    v_readfirstlane_b32 s80, v16
    v_readfirstlane_b32 s81, v17
    s_add_u32 s82, s82, 1
    s_bitcmp1_b32 s80, 0
    s_cbranch_scc1 Lnond_30
    s_cmp_gt_u32 s82, 20000
    s_cbranch_scc1 Lnond_30
    s_sleep 4
    global_load_dwordx2 v[16:17], v1, s[46:47] sc1
    s_waitcnt vmcnt(0)
    s_branch Lnon_29
Lnond_30:
    s_cmp_eq_u32 s3, 0
    s_cbranch_scc0 Lpko_33
    v_mov_b32 v76, 64
    s_mov_b32 s82, 0
Lpk_31:
    s_waitcnt vmcnt(0)
    v_cmp_eq_u64 vcc, s[80:81], v[20:21]
    v_cmp_eq_u64 s[84:85], s[80:81], v[22:23]
    s_add_u32 s82, s82, 1
    s_and_b64 vcc, vcc, s[84:85]
    s_cmp_eq_u64 vcc, -1
    s_cbranch_scc1 Lpkd_32
    s_not_b64 exec, vcc
    buffer_load_dwordx2 v[20:21], v18, s[64:67], s13 offen offset:0 sc1
    buffer_load_dwordx2 v[22:23], v18, s[64:67], s13 offen offset:128 sc1
    s_mov_b64 exec, -1
    s_cmp_lt_u32 s82, 40000
    s_cbranch_scc1 Lpk_31
Lpkd_32:
    ds_add_u32 v78, v76
    s_mov_b32 m0, 40960
    s_mov_b32 s12, 40960
    buffer_load_dwordx4 v8, s[64:67], s12 offen sc1 lds
    s_waitcnt lgkmcnt(0)
    s_branch Lpkg_34
Lpko_33:
    s_mov_b32 s82, 0
    ds_read_b32 v75, v74
Lq_36:
    s_waitcnt lgkmcnt(0)
    v_readfirstlane_b32 s83, v75
    s_add_u32 s82, s82, 1
    s_and_b32 s83, s83, 255
    s_cmp_ge_u32 s83, 64
    s_cbranch_scc1 Lqd_37
    s_sleep 1
    ds_read_b32 v75, v74
    s_cmp_lt_u32 s82, 0x40000
    s_cbranch_scc1 Lq_36
    s_waitcnt lgkmcnt(0)
Lqd_37:
Lpkg_34:
    s_mov_b32 s82, 0
    v_mfma_f32_32x32x16_bf16 v[48:63], v[204:207], v[212:215], v[48:63]
    s_add_u32 m0, s51, 0
    ds_read_b64_tr_b16 v[170:171], v73 offset:10400
    ds_read_b128 v[176:179], v68 offset:8192
    buffer_load_dwordx4 v8, s[64:67], m0 offen sc1 lds
    v_mfma_f32_32x32x16_bf16 v[32:47], v[216:219], v[220:223], v[32:47]
    s_add_u32 m0, s51, 4096
    v_add_u32 v69, 0x10000, v69
    ds_read_b64_tr_b16 v[180:181], v73 offset:12800
    ds_read_b128 v[184:187], v69 offset:0
    buffer_load_dwordx4 v8, s[64:67], m0 offen sc1 lds
    ds_read_b32 v75, v74
    v_mfma_f32_32x32x16_bf16 v[48:63], v[216:219], v[224:227], v[48:63]
    s_add_u32 m0, s51, 8192
    ds_read_b64_tr_b16 v[182:183], v73 offset:12960
    ds_read_b128 v[188:191], v69 offset:8192
    buffer_load_dwordx4 v8, s[64:67], m0 offen sc1 lds
    v_mfma_f32_32x32x16_bf16 v[32:47], v[228:231], v[232:235], v[32:47]
    s_add_u32 m0, s51, 12288
    v_add_u32 v70, 0x10000, v70
    ds_read_b64_tr_b16 v[192:193], v73 offset:15360
    ds_read_b128 v[196:199], v70 offset:0
    buffer_load_dwordx4 v8, s[64:67], m0 offen sc1 lds
    v_mfma_f32_32x32x16_bf16 v[48:63], v[228:231], v[236:239], v[48:63]
    s_add_u32 m0, s51, 16384
    ds_read_b64_tr_b16 v[194:195], v73 offset:15520
    ds_read_b128 v[200:203], v70 offset:8192
    buffer_load_dwordx4 v8, s[64:67], m0 offen sc1 lds
    s_waitcnt lgkmcnt(9)
    v_mfma_f32_32x32x16_bf16 v[32:47], v[168:171], v[172:175], v[32:47]
    s_waitcnt lgkmcnt(6)
    v_cmp_gt_u32_sdwa vcc, 16, v75 src0_sel:DWORD src1_sel:BYTE_1
    s_cbranch_vccnz Lck_38s
Lck_38:
    v_add_u32 v71, 0x10000, v71
    ds_read_b64_tr_b16 v[204:205], v73 offset:17920
    ds_read_b128 v[208:211], v71 offset:0
    v_mfma_f32_32x32x16_bf16 v[48:63], v[168:171], v[176:179], v[48:63]
    s_add_u32 m0, s51, 20480
    ds_read_b64_tr_b16 v[206:207], v73 offset:18080
    ds_read_b128 v[212:215], v71 offset:8192
    buffer_load_dwordx4 v8, s[64:67], m0 offen sc1 lds
    s_waitcnt lgkmcnt(8)
    v_mfma_f32_32x32x16_bf16 v[32:47], v[180:183], v[184:187], v[32:47]
    s_add_u32 m0, s51, 24576
    s_nop 0
    buffer_load_dwordx4 v8, s[64:67], m0 offen sc1 lds
    v_mfma_f32_32x32x16_bf16 v[48:63], v[180:183], v[188:191], v[48:63]
    s_add_u32 m0, s51, 28672
    s_nop 0
    buffer_load_dwordx4 v8, s[64:67], m0 offen sc1 lds
    s_waitcnt lgkmcnt(4)
    v_mfma_f32_32x32x16_bf16 v[32:47], v[192:195], v[196:199], v[32:47]
    s_add_u32 m0, s51, 32768
    s_nop 0
    buffer_load_dwordx4 v8, s[64:67], m0 offen sc1 lds
    v_mfma_f32_32x32x16_bf16 v[48:63], v[192:195], v[200:203], v[48:63]
    s_add_u32 m0, s51, 36864
    s_nop 0
    buffer_load_dwordx4 v8, s[64:67], m0 offen sc1 lds
    s_waitcnt lgkmcnt(0)
    v_mfma_f32_32x32x16_bf16 v[32:47], v[204:207], v[208:211], v[32:47]
    v_mfma_f32_32x32x16_bf16 v[48:63], v[204:207], v[212:215], v[48:63]
L_a_Q:
    s_xor_b32 s97, s97, s81
    s_mov_b32 s96, s80
    v_mov_b64 v[4:5], -1
    v_mov_b64 v[6:7], -1
    v_mov_b32 v14, s96
    v_mov_b32 v15, s97
    s_nop 0
    s_nop 3
    v_mul_f32 v32, s10, v32
    s_nop 2
    v_mul_f32 v33, s10, v33
    s_nop 1
    v_mul_f32 v34, s10, v34
    s_nop 0
    v_mul_f32 v35, s10, v35
    v_mul_f32 v36, s10, v36
    v_mul_f32 v37, s10, v37
    v_mul_f32 v38, s10, v38
    v_mul_f32 v39, s10, v39
    v_mul_f32 v40, s10, v40
    v_mul_f32 v41, s10, v41
    v_mul_f32 v42, s10, v42
    v_mul_f32 v43, s10, v43
    v_cvt_pk_bf16_f32 v112, v32, v33
    v_cvt_pk_bf16_f32 v113, v34, v35
    v_cvt_pk_bf16_f32 v114, v36, v37
    v_cvt_pk_bf16_f32 v115, v38, v39
    ds_write_b128 v12, v[112:115] offset:0
    v_cvt_pk_bf16_f32 v120, v40, v41
    v_cvt_pk_bf16_f32 v121, v42, v43
    v_mul_f32 v48, s10, v48
    v_mul_f32 v49, s10, v49
    v_mul_f32 v50, s10, v50
    v_mul_f32 v51, s10, v51
    v_mul_f32 v52, s10, v52
    v_mul_f32 v53, s10, v53
    v_mul_f32 v54, s10, v54
    v_mul_f32 v55, s10, v55
    v_mul_f32 v56, s10, v56
    v_mul_f32 v57, s10, v57
    v_mul_f32 v58, s10, v58
    v_mul_f32 v59, s10, v59
    v_cvt_pk_bf16_f32 v116, v48, v49
    v_cvt_pk_bf16_f32 v117, v50, v51
    v_cvt_pk_bf16_f32 v118, v52, v53
    v_cvt_pk_bf16_f32 v119, v54, v55
    ds_write_b128 v12, v[116:119] offset:1024
    v_cvt_pk_bf16_f32 v122, v56, v57
    v_cvt_pk_bf16_f32 v123, v58, v59
    s_nop 1
    v_permlane32_swap_b32 v120, v122
    v_permlane32_swap_b32 v121, v123
    ds_write_b64 v13, v[120:121] offset:2048
    s_waitcnt vmcnt(4) lgkmcnt(0)
    s_barrier
    ds_read_b64 v[122:123], v148 offset:0
    ds_read_b128 v[124:127], v145 offset:0
    ds_read_b128 v[128:131], v151 offset:0
    ds_read_b128 v[132:135], v151 offset:672
    s_waitcnt lgkmcnt(2)
    v_mfma_f32_32x32x4_2b_bf16 v[16:47], v[122:123], v[120:121], 0 cbsz:1 abid:0
    s_nop 15
    s_nop 1
    v_mfma_f32_32x32x16_bf16 v[16:31], v[124:127], v[112:115], v[16:31]
    v_mfma_f32_32x32x16_bf16 v[32:47], v[124:127], v[116:119], v[32:47]
    ds_read_b128 v[124:127], v145 offset:1024
    s_waitcnt lgkmcnt(1)
    s_nop 9
    s_setprio 3
    v_exp_f32 v16, v16
    v_exp_f32 v17, v17
    ds_read_b128 v[136:139], v151 offset:1344
    s_cmp_eq_u32 s3, 0
    s_cbranch_scc0 Lx_39
    s_mov_b32 m0, 82944
    s_mov_b32 s12, 82944
    buffer_load_dwordx4 v8, s[64:67], s12 offen sc1 lds
Lx_39:
    v_exp_f32 v18, v18
    v_exp_f32 v19, v19
    v_exp_f32 v20, v20
    v_exp_f32 v21, v21
    v_mfma_f32_32x32x4_2b_bf16 v[48:79], v[122:123], v[120:121], 0 cbsz:1 abid:1
    s_add_u32 m0, s51, 41984
    s_add_u32 s12, s51, 41984
    buffer_load_dwordx4 v8, s[64:67], s12 offen sc1 lds
    v_exp_f32 v22, v22
    v_exp_f32 v23, v23
    v_exp_f32 v24, v24
    v_exp_f32 v25, v25
    v_exp_f32 v26, v26
    v_exp_f32 v27, v27
    v_exp_f32 v28, v28
    v_exp_f32 v29, v29
    v_smfmac_f32_32x32x32_bf16 v[80:95], v[128:131], v[16:23], v144
    ds_read_b128 v[140:143], v151 offset:2016
    s_lshl_b32 s10, s3, 9
    s_add_u32 s10, s10, s15
    s_add_u32 s11, s10, 40960
    s_and_b32 s12, s3, 1
    s_lshl_b32 s12, s12, 8
    s_lshr_b32 s13, s3, 1
    s_lshl3_add_u32 s12, s13, s12
    s_add_u32 s15, s12, s15
    v_exp_f32 v30, v30
    v_exp_f32 v31, v31
    v_exp_f32 v32, v32
    v_exp_f32 v33, v33
    v_smfmac_f32_32x32x32_bf16 v[80:95], v[132:135], v[24:31], v144
    s_waitcnt lgkmcnt(2)
    ds_read_b64 v[122:123], v148 offset:10496
    v_exp_f32 v34, v34
    v_exp_f32 v35, v35
    v_exp_f32 v36, v36
    v_exp_f32 v37, v37
    v_mfma_f32_32x32x16_bf16 v[48:63], v[124:127], v[112:115], v[48:63]
    s_add_u32 m0, s51, 50176
    s_add_u32 s12, s51, 50176
    buffer_load_dwordx4 v8, s[64:67], s12 offen sc1 lds
    v_exp_f32 v38, v38
    v_exp_f32 v39, v39
    v_exp_f32 v40, v40
    v_exp_f32 v41, v41
    v_mfma_f32_32x32x16_bf16 v[64:79], v[124:127], v[116:119], v[64:79]
    ds_read_b128 v[124:127], v145 offset:10496
    s_setprio 2
    v_exp_f32 v42, v42
    v_exp_f32 v43, v43
    v_exp_f32 v44, v44
    v_exp_f32 v45, v45
    v_smfmac_f32_32x32x32_bf16 v[96:111], v[128:131], v[32:39], v144
    s_waitcnt lgkmcnt(1)
    v_exp_f32 v46, v46
    v_exp_f32 v47, v47
    v_exp_f32 v48, v48
    v_exp_f32 v49, v49
    v_smfmac_f32_32x32x32_bf16 v[96:111], v[132:135], v[40:47], v144
    ds_read_b128 v[128:131], v151 offset:10496
    s_add_u32 m0, s51, 58368
    s_add_u32 s12, s51, 58368
    buffer_load_dwordx4 v8, s[64:67], s12 offen sc1 lds
    v_exp_f32 v50, v50
    v_exp_f32 v51, v51
    v_exp_f32 v52, v52
    v_exp_f32 v53, v53
    v_mfma_f32_32x32x4_2b_bf16 v[16:47], v[122:123], v[120:121], 0 cbsz:1 abid:0
    s_add_u32 m0, s51, 66560
    s_add_u32 s12, s51, 66560
    buffer_load_dwordx4 v8, s[64:67], s12 offen sc1 lds
    v_exp_f32 v54, v54
    v_exp_f32 v55, v55
    v_exp_f32 v56, v56
    v_exp_f32 v57, v57
    v_exp_f32 v58, v58
    v_exp_f32 v59, v59
    v_exp_f32 v60, v60
    v_exp_f32 v61, v61
    v_smfmac_f32_32x32x32_bf16 v[80:95], v[136:139], v[48:55], v144
    ds_read_b128 v[132:135], v151 offset:11168
    v_exp_f32 v62, v62
    v_exp_f32 v63, v63
    v_exp_f32 v64, v64
    v_exp_f32 v65, v65
    v_smfmac_f32_32x32x32_bf16 v[80:95], v[140:143], v[56:63], v144
    s_waitcnt lgkmcnt(2)
    v_exp_f32 v66, v66
    v_exp_f32 v67, v67
    v_exp_f32 v68, v68
    v_exp_f32 v69, v69
    v_mfma_f32_32x32x16_bf16 v[16:31], v[124:127], v[112:115], v[16:31]
    s_add_u32 m0, s51, 74752
    s_add_u32 s12, s51, 74752
    buffer_load_dwordx4 v8, s[64:67], s12 offen sc1 lds
    v_exp_f32 v70, v70
    v_exp_f32 v71, v71
    v_exp_f32 v72, v72
    v_exp_f32 v73, v73
    v_mfma_f32_32x32x16_bf16 v[32:47], v[124:127], v[116:119], v[32:47]
    ds_read_b128 v[124:127], v145 offset:11520
    v_exp_f32 v74, v74
    v_exp_f32 v75, v75
    v_exp_f32 v76, v76
    v_exp_f32 v77, v77
    v_smfmac_f32_32x32x32_bf16 v[96:111], v[136:139], v[64:71], v144
    s_waitcnt vmcnt(5) lgkmcnt(1)
    s_barrier
    s_setprio 3
    v_exp_f32 v78, v78
    v_exp_f32 v79, v79
    v_exp_f32 v16, v16
    v_exp_f32 v17, v17
    v_smfmac_f32_32x32x32_bf16 v[96:111], v[140:143], v[72:79], v144
    ds_read_b128 v[136:139], v151 offset:11840
    s_cmp_eq_u32 s3, 0
    s_cbranch_scc0 Lx_40
    s_mov_b32 m0, 124928
    s_mov_b32 s12, 124928
    buffer_load_dwordx4 v8, s[64:67], s12 offen sc1 lds
Lx_40:
    v_exp_f32 v18, v18
    v_exp_f32 v19, v19
    v_exp_f32 v20, v20
    v_exp_f32 v21, v21
    v_mfma_f32_32x32x4_2b_bf16 v[48:79], v[122:123], v[120:121], 0 cbsz:1 abid:1
    s_add_u32 m0, s51, 83968
    s_add_u32 s12, s51, 83968
    buffer_load_dwordx4 v8, s[64:67], s12 offen sc1 lds
    v_exp_f32 v22, v22
    v_exp_f32 v23, v23
    v_exp_f32 v24, v24
    v_exp_f32 v25, v25
    v_exp_f32 v26, v26
    v_exp_f32 v27, v27
    v_exp_f32 v28, v28
    v_exp_f32 v29, v29
    v_smfmac_f32_32x32x32_bf16 v[80:95], v[128:131], v[16:23], v144
    ds_read_b128 v[140:143], v151 offset:12512
    v_exp_f32 v30, v30
    v_exp_f32 v31, v31
    v_exp_f32 v32, v32
    v_exp_f32 v33, v33
    v_smfmac_f32_32x32x32_bf16 v[80:95], v[132:135], v[24:31], v144
    s_waitcnt lgkmcnt(2)
    ds_read_b64 v[122:123], v148 offset:20992
    v_exp_f32 v34, v34
    v_exp_f32 v35, v35
    v_exp_f32 v36, v36
    v_exp_f32 v37, v37
    v_mfma_f32_32x32x16_bf16 v[48:63], v[124:127], v[112:115], v[48:63]
    s_add_u32 m0, s51, 92160
    s_add_u32 s12, s51, 92160
    buffer_load_dwordx4 v8, s[64:67], s12 offen sc1 lds
    v_exp_f32 v38, v38
    v_exp_f32 v39, v39
    v_exp_f32 v40, v40
    v_exp_f32 v41, v41
    v_mfma_f32_32x32x16_bf16 v[64:79], v[124:127], v[116:119], v[64:79]
    ds_read_b128 v[124:127], v145 offset:20992
    s_setprio 2
    v_exp_f32 v42, v42
    v_exp_f32 v43, v43
    v_exp_f32 v44, v44
    v_exp_f32 v45, v45
    v_smfmac_f32_32x32x32_bf16 v[96:111], v[128:131], v[32:39], v144
    s_waitcnt lgkmcnt(1)
    v_exp_f32 v46, v46
    v_exp_f32 v47, v47
    v_exp_f32 v48, v48
    v_exp_f32 v49, v49
    v_smfmac_f32_32x32x32_bf16 v[96:111], v[132:135], v[40:47], v144
    ds_read_b128 v[128:131], v151 offset:20992
    s_add_u32 m0, s51, 100352
    s_add_u32 s12, s51, 100352
    buffer_load_dwordx4 v8, s[64:67], s12 offen sc1 lds
    v_exp_f32 v50, v50
    v_exp_f32 v51, v51
    v_exp_f32 v52, v52
    v_exp_f32 v53, v53
    v_mfma_f32_32x32x4_2b_bf16 v[16:47], v[122:123], v[120:121], 0 cbsz:1 abid:0
    s_add_u32 m0, s51, 108544
    s_add_u32 s12, s51, 108544
    buffer_load_dwordx4 v8, s[64:67], s12 offen sc1 lds
    v_exp_f32 v54, v54
    v_exp_f32 v55, v55
    v_exp_f32 v56, v56
    v_exp_f32 v57, v57
    v_exp_f32 v58, v58
    v_exp_f32 v59, v59
    v_exp_f32 v60, v60
    v_exp_f32 v61, v61
    v_smfmac_f32_32x32x32_bf16 v[80:95], v[136:139], v[48:55], v144
    ds_read_b128 v[132:135], v151 offset:21664
    v_exp_f32 v62, v62
    v_exp_f32 v63, v63
    v_exp_f32 v64, v64
    v_exp_f32 v65, v65
    v_smfmac_f32_32x32x32_bf16 v[80:95], v[140:143], v[56:63], v144
    s_waitcnt lgkmcnt(2)
    v_exp_f32 v66, v66
    v_exp_f32 v67, v67
    v_exp_f32 v68, v68
    v_exp_f32 v69, v69
    v_mfma_f32_32x32x16_bf16 v[16:31], v[124:127], v[112:115], v[16:31]
    s_add_u32 m0, s51, 116736
    s_add_u32 s12, s51, 116736
    buffer_load_dwordx4 v8, s[64:67], s12 offen sc1 lds
    v_exp_f32 v70, v70
    v_exp_f32 v71, v71
    v_exp_f32 v72, v72
    v_exp_f32 v73, v73
    v_mfma_f32_32x32x16_bf16 v[32:47], v[124:127], v[116:119], v[32:47]
    ds_read_b128 v[124:127], v145 offset:22016
    s_setprio 1
    v_exp_f32 v74, v74
    v_exp_f32 v75, v75
    v_exp_f32 v76, v76
    v_exp_f32 v77, v77
    v_smfmac_f32_32x32x32_bf16 v[96:111], v[136:139], v[64:71], v144
    s_waitcnt lgkmcnt(1)
    v_exp_f32 v78, v78
    v_exp_f32 v79, v79
    v_exp_f32 v16, v16
    v_exp_f32 v17, v17
    v_smfmac_f32_32x32x32_bf16 v[96:111], v[140:143], v[72:79], v144
    ds_read_b128 v[136:139], v151 offset:22336
    buffer_store_dwordx4 v[4:7], v10, s[64:67], s10 offen sc1
    v_exp_f32 v18, v18
    v_exp_f32 v19, v19
    v_exp_f32 v20, v20
    v_exp_f32 v21, v21
    v_mfma_f32_32x32x4_2b_bf16 v[48:79], v[122:123], v[120:121], 0 cbsz:1 abid:1
    v_exp_f32 v22, v22
    v_exp_f32 v23, v23
    v_exp_f32 v24, v24
    v_exp_f32 v25, v25
    v_exp_f32 v26, v26
    v_exp_f32 v27, v27
    v_exp_f32 v28, v28
    v_exp_f32 v29, v29
    v_smfmac_f32_32x32x32_bf16 v[80:95], v[128:131], v[16:23], v144
    ds_read_b128 v[140:143], v151 offset:23008
    buffer_store_dwordx4 v[4:7], v10, s[64:67], s11 offen sc1
    v_exp_f32 v30, v30
    v_exp_f32 v31, v31
    v_exp_f32 v32, v32
    v_exp_f32 v33, v33
    v_smfmac_f32_32x32x32_bf16 v[80:95], v[132:135], v[24:31], v144
    s_waitcnt lgkmcnt(2)
    ds_read_b64 v[122:123], v148 offset:31488
    v_exp_f32 v34, v34
    v_exp_f32 v35, v35
    v_exp_f32 v36, v36
    v_exp_f32 v37, v37
    v_mfma_f32_32x32x16_bf16 v[48:63], v[124:127], v[112:115], v[48:63]
    v_exp_f32 v38, v38
    v_exp_f32 v39, v39
    v_exp_f32 v40, v40
    v_exp_f32 v41, v41
    v_mfma_f32_32x32x16_bf16 v[64:79], v[124:127], v[116:119], v[64:79]
    ds_read_b128 v[124:127], v145 offset:31488
    s_setprio 0
    v_exp_f32 v42, v42
    v_exp_f32 v43, v43
    v_exp_f32 v44, v44
    v_exp_f32 v45, v45
    v_smfmac_f32_32x32x32_bf16 v[96:111], v[128:131], v[32:39], v144
    s_waitcnt lgkmcnt(1)
    v_exp_f32 v46, v46
    v_exp_f32 v47, v47
    v_exp_f32 v48, v48
    v_exp_f32 v49, v49
    v_smfmac_f32_32x32x32_bf16 v[96:111], v[132:135], v[40:47], v144
    ds_read_b128 v[128:131], v151 offset:31488
    buffer_store_dwordx2 v[4:5], v11, s[64:67], s15 offen offset:2048 sc1
    v_exp_f32 v50, v50
    v_exp_f32 v51, v51
    v_exp_f32 v52, v52
    v_exp_f32 v53, v53
    v_mfma_f32_32x32x4_2b_bf16 v[16:47], v[122:123], v[120:121], 0 cbsz:1 abid:0
    v_exp_f32 v54, v54
    v_exp_f32 v55, v55
    v_exp_f32 v56, v56
    v_exp_f32 v57, v57
    v_exp_f32 v58, v58
    v_exp_f32 v59, v59
    v_exp_f32 v60, v60
    v_exp_f32 v61, v61
    v_smfmac_f32_32x32x32_bf16 v[80:95], v[136:139], v[48:55], v144
    ds_read_b128 v[132:135], v151 offset:32160
    v_exp_f32 v62, v62
    v_exp_f32 v63, v63
    v_exp_f32 v64, v64
    v_exp_f32 v65, v65
    v_smfmac_f32_32x32x32_bf16 v[80:95], v[140:143], v[56:63], v144
    s_waitcnt lgkmcnt(2)
    v_exp_f32 v66, v66
    v_exp_f32 v67, v67
    v_exp_f32 v68, v68
    v_exp_f32 v69, v69
    v_mfma_f32_32x32x16_bf16 v[16:31], v[124:127], v[112:115], v[16:31]
    v_exp_f32 v70, v70
    v_exp_f32 v71, v71
    v_exp_f32 v72, v72
    v_exp_f32 v73, v73
    v_mfma_f32_32x32x16_bf16 v[32:47], v[124:127], v[116:119], v[32:47]
    ds_read_b128 v[124:127], v145 offset:32512
    v_exp_f32 v74, v74
    v_exp_f32 v75, v75
    v_exp_f32 v76, v76
    v_exp_f32 v77, v77
    v_smfmac_f32_32x32x32_bf16 v[96:111], v[136:139], v[64:71], v144
    s_waitcnt vmcnt(3) lgkmcnt(0)
    s_barrier
    s_setprio 3
    v_exp_f32 v78, v78
    v_exp_f32 v79, v79
    v_exp_f32 v16, v16
    v_exp_f32 v17, v17
    v_smfmac_f32_32x32x32_bf16 v[96:111], v[140:143], v[72:79], v144
    ds_read_b128 v[136:139], v151 offset:32832
    v_exp_f32 v18, v18
    v_exp_f32 v19, v19
    v_exp_f32 v20, v20
    v_exp_f32 v21, v21
    v_mfma_f32_32x32x4_2b_bf16 v[48:79], v[122:123], v[120:121], 0 cbsz:1 abid:1
    v_exp_f32 v22, v22
    v_exp_f32 v23, v23
    v_exp_f32 v24, v24
    v_exp_f32 v25, v25
    v_exp_f32 v26, v26
    v_exp_f32 v27, v27
    v_exp_f32 v28, v28
    v_exp_f32 v29, v29
    v_smfmac_f32_32x32x32_bf16 v[80:95], v[128:131], v[16:23], v144
    ds_read_b128 v[140:143], v151 offset:33504
    v_exp_f32 v30, v30
    v_exp_f32 v31, v31
    v_exp_f32 v32, v32
    v_exp_f32 v33, v33
    v_smfmac_f32_32x32x32_bf16 v[80:95], v[132:135], v[24:31], v144
    s_waitcnt lgkmcnt(2)
    ds_read_b64 v[122:123], v149 offset:0
    v_exp_f32 v34, v34
    v_exp_f32 v35, v35
    v_exp_f32 v36, v36
    v_exp_f32 v37, v37
    v_mfma_f32_32x32x16_bf16 v[48:63], v[124:127], v[112:115], v[48:63]
    s_add_u32 m0, s51, 0
    s_add_u32 s12, s51, 125952
    buffer_load_dwordx4 v8, s[64:67], s12 offen sc1 lds
    v_exp_f32 v38, v38
    v_exp_f32 v39, v39
    v_exp_f32 v40, v40
    v_exp_f32 v41, v41
    v_mfma_f32_32x32x16_bf16 v[64:79], v[124:127], v[116:119], v[64:79]
    ds_read_b128 v[124:127], v146 offset:0
    v_exp_f32 v42, v42
    v_exp_f32 v43, v43
    v_exp_f32 v44, v44
    v_exp_f32 v45, v45
    v_smfmac_f32_32x32x32_bf16 v[96:111], v[128:131], v[32:39], v144
    s_waitcnt lgkmcnt(1)
    v_exp_f32 v46, v46
    v_exp_f32 v47, v47
    v_exp_f32 v48, v48
    v_exp_f32 v49, v49
    v_smfmac_f32_32x32x32_bf16 v[96:111], v[132:135], v[40:47], v144
    ds_read_b128 v[128:131], v152 offset:0
    v_exp_f32 v50, v50
    v_exp_f32 v51, v51
    v_exp_f32 v52, v52
    v_exp_f32 v53, v53
    v_mfma_f32_32x32x4_2b_bf16 v[16:47], v[122:123], v[120:121], 0 cbsz:1 abid:0
    v_exp_f32 v54, v54
    v_exp_f32 v55, v55
    v_exp_f32 v56, v56
    v_exp_f32 v57, v57
    v_exp_f32 v58, v58
    v_exp_f32 v59, v59
    v_exp_f32 v60, v60
    v_exp_f32 v61, v61
    v_smfmac_f32_32x32x32_bf16 v[80:95], v[136:139], v[48:55], v144
    ds_read_b128 v[132:135], v152 offset:672
    v_exp_f32 v62, v62
    v_exp_f32 v63, v63
    v_exp_f32 v64, v64
    v_exp_f32 v65, v65
    v_smfmac_f32_32x32x32_bf16 v[80:95], v[140:143], v[56:63], v144
    s_waitcnt lgkmcnt(2)
    v_exp_f32 v66, v66
    v_exp_f32 v67, v67
    v_exp_f32 v68, v68
    v_exp_f32 v69, v69
    v_mfma_f32_32x32x16_bf16 v[16:31], v[124:127], v[112:115], v[16:31]
    s_add_u32 m0, s51, 8192
    s_add_u32 s12, s51, 134144
    buffer_load_dwordx4 v8, s[64:67], s12 offen sc1 lds
    v_exp_f32 v70, v70
    v_exp_f32 v71, v71
    v_exp_f32 v72, v72
    v_exp_f32 v73, v73
    v_mfma_f32_32x32x16_bf16 v[32:47], v[124:127], v[116:119], v[32:47]
    ds_read_b128 v[124:127], v146 offset:1024
    v_exp_f32 v74, v74
    v_exp_f32 v75, v75
    v_exp_f32 v76, v76
    v_exp_f32 v77, v77
    v_smfmac_f32_32x32x32_bf16 v[96:111], v[136:139], v[64:71], v144
    s_waitcnt lgkmcnt(1)
    v_exp_f32 v78, v78
    v_exp_f32 v79, v79
    v_exp_f32 v16, v16
    v_exp_f32 v17, v17
    v_smfmac_f32_32x32x32_bf16 v[96:111], v[140:143], v[72:79], v144
    ds_read_b128 v[136:139], v152 offset:1344
    v_exp_f32 v18, v18
    v_exp_f32 v19, v19
    v_exp_f32 v20, v20
    v_exp_f32 v21, v21
    v_mfma_f32_32x32x4_2b_bf16 v[48:79], v[122:123], v[120:121], 0 cbsz:1 abid:1
    v_exp_f32 v22, v22
    v_exp_f32 v23, v23
    v_exp_f32 v24, v24
    v_exp_f32 v25, v25
    v_exp_f32 v26, v26
    v_exp_f32 v27, v27
    v_exp_f32 v28, v28
    v_exp_f32 v29, v29
    v_smfmac_f32_32x32x32_bf16 v[80:95], v[128:131], v[16:23], v144
    ds_read_b128 v[140:143], v152 offset:2016
    s_lshl_b32 s92, s4, 8
    s_add_u32 s92, s92, 196608
    s_lshl2_add_u32 s13, s5, s3
    s_lshl3_add_u32 s13, s13, s92
    v_exp_f32 v30, v30
    v_exp_f32 v31, v31
    v_exp_f32 v32, v32
    v_exp_f32 v33, v33
    v_smfmac_f32_32x32x32_bf16 v[80:95], v[132:135], v[24:31], v144
    s_waitcnt lgkmcnt(2)
    ds_read_b64 v[122:123], v149 offset:10496
    v_exp_f32 v34, v34
    v_exp_f32 v35, v35
    v_exp_f32 v36, v36
    v_exp_f32 v37, v37
    v_mfma_f32_32x32x16_bf16 v[48:63], v[124:127], v[112:115], v[48:63]
    s_add_u32 m0, s51, 16384
    s_add_u32 s12, s51, 142336
    buffer_load_dwordx4 v8, s[64:67], s12 offen sc1 lds
    v_exp_f32 v38, v38
    v_exp_f32 v39, v39
    v_exp_f32 v40, v40
    v_exp_f32 v41, v41
    v_mfma_f32_32x32x16_bf16 v[64:79], v[124:127], v[116:119], v[64:79]
    ds_read_b128 v[124:127], v146 offset:10496
    s_setprio 2
    v_exp_f32 v42, v42
    v_exp_f32 v43, v43
    v_exp_f32 v44, v44
    v_exp_f32 v45, v45
    v_smfmac_f32_32x32x32_bf16 v[96:111], v[128:131], v[32:39], v144
    s_waitcnt lgkmcnt(1)
    v_exp_f32 v46, v46
    v_exp_f32 v47, v47
    v_exp_f32 v48, v48
    v_exp_f32 v49, v49
    v_smfmac_f32_32x32x32_bf16 v[96:111], v[132:135], v[40:47], v144
    ds_read_b128 v[128:131], v152 offset:10496
    s_waitcnt vmcnt(3)
    buffer_store_dwordx2 v[14:15], v252, s[64:67], s13 offen sc1
    v_exp_f32 v50, v50
    v_exp_f32 v51, v51
    v_exp_f32 v52, v52
    v_exp_f32 v53, v53
    v_mfma_f32_32x32x4_2b_bf16 v[16:47], v[122:123], v[120:121], 0 cbsz:1 abid:0
    v_exp_f32 v54, v54
    v_exp_f32 v55, v55
    v_exp_f32 v56, v56
    v_exp_f32 v57, v57
    v_exp_f32 v58, v58
    v_exp_f32 v59, v59
    v_exp_f32 v60, v60
    v_exp_f32 v61, v61
    v_smfmac_f32_32x32x32_bf16 v[80:95], v[136:139], v[48:55], v144
    ds_read_b128 v[132:135], v152 offset:11168
    v_exp_f32 v62, v62
    v_exp_f32 v63, v63
    v_exp_f32 v64, v64
    v_exp_f32 v65, v65
    v_smfmac_f32_32x32x32_bf16 v[80:95], v[140:143], v[56:63], v144
    s_waitcnt lgkmcnt(2)
    v_exp_f32 v66, v66
    v_exp_f32 v67, v67
    v_exp_f32 v68, v68
    v_exp_f32 v69, v69
    v_mfma_f32_32x32x16_bf16 v[16:31], v[124:127], v[112:115], v[16:31]
    s_add_u32 m0, s51, 24576
    s_add_u32 s12, s51, 150528
    buffer_load_dwordx4 v8, s[64:67], s12 offen sc1 lds
    v_exp_f32 v70, v70
    v_exp_f32 v71, v71
    v_exp_f32 v72, v72
    v_exp_f32 v73, v73
    v_mfma_f32_32x32x16_bf16 v[32:47], v[124:127], v[116:119], v[32:47]
    ds_read_b128 v[124:127], v146 offset:11520
    v_exp_f32 v74, v74
    v_exp_f32 v75, v75
    v_exp_f32 v76, v76
    v_exp_f32 v77, v77
    v_smfmac_f32_32x32x32_bf16 v[96:111], v[136:139], v[64:71], v144
    s_waitcnt lgkmcnt(1)
    v_exp_f32 v78, v78
    v_exp_f32 v79, v79
    v_exp_f32 v16, v16
    v_exp_f32 v17, v17
    v_smfmac_f32_32x32x32_bf16 v[96:111], v[140:143], v[72:79], v144
    ds_read_b128 v[136:139], v152 offset:11840
    v_exp_f32 v18, v18
    v_exp_f32 v19, v19
    v_exp_f32 v20, v20
    v_exp_f32 v21, v21
    v_mfma_f32_32x32x4_2b_bf16 v[48:79], v[122:123], v[120:121], 0 cbsz:1 abid:1
    v_exp_f32 v22, v22
    v_exp_f32 v23, v23
    v_exp_f32 v24, v24
    v_exp_f32 v25, v25
    v_exp_f32 v26, v26
    v_exp_f32 v27, v27
    v_exp_f32 v28, v28
    v_exp_f32 v29, v29
    v_smfmac_f32_32x32x32_bf16 v[80:95], v[128:131], v[16:23], v144
    ds_read_b128 v[140:143], v152 offset:12512
    v_exp_f32 v30, v30
    v_exp_f32 v31, v31
    v_exp_f32 v32, v32
    v_exp_f32 v33, v33
    v_smfmac_f32_32x32x32_bf16 v[80:95], v[132:135], v[24:31], v144
    s_waitcnt lgkmcnt(2)
    ds_read_b64 v[122:123], v149 offset:20992
    v_exp_f32 v34, v34
    v_exp_f32 v35, v35
    v_exp_f32 v36, v36
    v_exp_f32 v37, v37
    v_mfma_f32_32x32x16_bf16 v[48:63], v[124:127], v[112:115], v[48:63]
    buffer_load_dword v255, v154, s[72:75], 0 offen
    v_exp_f32 v38, v38
    v_exp_f32 v39, v39
    v_exp_f32 v40, v40
    v_exp_f32 v41, v41
    v_mfma_f32_32x32x16_bf16 v[64:79], v[124:127], v[116:119], v[64:79]
    ds_read_b128 v[124:127], v146 offset:20992
    s_setprio 1
    v_exp_f32 v42, v42
    v_exp_f32 v43, v43
    v_exp_f32 v44, v44
    v_exp_f32 v45, v45
    v_smfmac_f32_32x32x32_bf16 v[96:111], v[128:131], v[32:39], v144
    s_waitcnt lgkmcnt(1)
    v_exp_f32 v46, v46
    v_exp_f32 v47, v47
    v_exp_f32 v48, v48
    v_exp_f32 v49, v49
    v_smfmac_f32_32x32x32_bf16 v[96:111], v[132:135], v[40:47], v144
    ds_read_b128 v[128:131], v152 offset:20992
    v_exp_f32 v50, v50
    v_exp_f32 v51, v51
    v_exp_f32 v52, v52
    v_exp_f32 v53, v53
    v_mfma_f32_32x32x4_2b_bf16 v[16:47], v[122:123], v[120:121], 0 cbsz:1 abid:0
    v_exp_f32 v54, v54
    v_exp_f32 v55, v55
    v_exp_f32 v56, v56
    v_exp_f32 v57, v57
    v_exp_f32 v58, v58
    v_exp_f32 v59, v59
    v_exp_f32 v60, v60
    v_exp_f32 v61, v61
    v_smfmac_f32_32x32x32_bf16 v[80:95], v[136:139], v[48:55], v144
    ds_read_b128 v[132:135], v152 offset:21664
    v_exp_f32 v62, v62
    v_exp_f32 v63, v63
    v_exp_f32 v64, v64
    v_exp_f32 v65, v65
    v_smfmac_f32_32x32x32_bf16 v[80:95], v[140:143], v[56:63], v144
    s_waitcnt lgkmcnt(2)
    v_exp_f32 v66, v66
    v_exp_f32 v67, v67
    v_exp_f32 v68, v68
    v_exp_f32 v69, v69
    v_mfma_f32_32x32x16_bf16 v[16:31], v[124:127], v[112:115], v[16:31]
    v_exp_f32 v70, v70
    v_exp_f32 v71, v71
    v_exp_f32 v72, v72
    v_exp_f32 v73, v73
    v_mfma_f32_32x32x16_bf16 v[32:47], v[124:127], v[116:119], v[32:47]
    ds_read_b128 v[124:127], v146 offset:22016
    v_exp_f32 v74, v74
    v_exp_f32 v75, v75
    v_exp_f32 v76, v76
    v_exp_f32 v77, v77
    v_smfmac_f32_32x32x32_bf16 v[96:111], v[136:139], v[64:71], v144
    s_waitcnt lgkmcnt(1)
    v_exp_f32 v78, v78
    v_exp_f32 v79, v79
    v_exp_f32 v16, v16
    v_exp_f32 v17, v17
    v_smfmac_f32_32x32x32_bf16 v[96:111], v[140:143], v[72:79], v144
    ds_read_b128 v[136:139], v152 offset:22336
    v_exp_f32 v18, v18
    v_exp_f32 v19, v19
    v_exp_f32 v20, v20
    v_exp_f32 v21, v21
    v_mfma_f32_32x32x4_2b_bf16 v[48:79], v[122:123], v[120:121], 0 cbsz:1 abid:1
    v_exp_f32 v22, v22
    v_exp_f32 v23, v23
    v_exp_f32 v24, v24
    v_exp_f32 v25, v25
    v_exp_f32 v26, v26
    v_exp_f32 v27, v27
    v_exp_f32 v28, v28
    v_exp_f32 v29, v29
    v_smfmac_f32_32x32x32_bf16 v[80:95], v[128:131], v[16:23], v144
    ds_read_b128 v[140:143], v152 offset:23008
    v_exp_f32 v30, v30
    v_exp_f32 v31, v31
    v_exp_f32 v32, v32
    v_exp_f32 v33, v33
    v_smfmac_f32_32x32x32_bf16 v[80:95], v[132:135], v[24:31], v144
    s_waitcnt lgkmcnt(2)
    ds_read_b64 v[122:123], v149 offset:31488
    v_exp_f32 v34, v34
    v_exp_f32 v35, v35
    v_exp_f32 v36, v36
    v_exp_f32 v37, v37
    v_mfma_f32_32x32x16_bf16 v[48:63], v[124:127], v[112:115], v[48:63]
    v_exp_f32 v38, v38
    v_exp_f32 v39, v39
    v_exp_f32 v40, v40
    v_exp_f32 v41, v41
    v_mfma_f32_32x32x16_bf16 v[64:79], v[124:127], v[116:119], v[64:79]
    ds_read_b128 v[124:127], v146 offset:31488
    s_setprio 0
    v_exp_f32 v42, v42
    v_exp_f32 v43, v43
    v_exp_f32 v44, v44
    v_exp_f32 v45, v45
    v_smfmac_f32_32x32x32_bf16 v[96:111], v[128:131], v[32:39], v144
    s_waitcnt lgkmcnt(1)
    v_exp_f32 v46, v46
    v_exp_f32 v47, v47
    v_exp_f32 v48, v48
    v_exp_f32 v49, v49
    v_smfmac_f32_32x32x32_bf16 v[96:111], v[132:135], v[40:47], v144
    ds_read_b128 v[128:131], v152 offset:31488
    v_exp_f32 v50, v50
    v_exp_f32 v51, v51
    v_exp_f32 v52, v52
    v_exp_f32 v53, v53
    v_mfma_f32_32x32x4_2b_bf16 v[16:47], v[122:123], v[120:121], 0 cbsz:1 abid:0
    v_exp_f32 v54, v54
    v_exp_f32 v55, v55
    v_exp_f32 v56, v56
    v_exp_f32 v57, v57
    v_exp_f32 v58, v58
    v_exp_f32 v59, v59
    v_exp_f32 v60, v60
    v_exp_f32 v61, v61
    v_smfmac_f32_32x32x32_bf16 v[80:95], v[136:139], v[48:55], v144
    ds_read_b128 v[132:135], v152 offset:32160
    v_exp_f32 v62, v62
    v_exp_f32 v63, v63
    v_exp_f32 v64, v64
    v_exp_f32 v65, v65
    v_smfmac_f32_32x32x32_bf16 v[80:95], v[140:143], v[56:63], v144
    s_waitcnt lgkmcnt(2)
    v_exp_f32 v66, v66
    v_exp_f32 v67, v67
    v_exp_f32 v68, v68
    v_exp_f32 v69, v69
    v_mfma_f32_32x32x16_bf16 v[16:31], v[124:127], v[112:115], v[16:31]
    v_exp_f32 v70, v70
    v_exp_f32 v71, v71
    v_exp_f32 v72, v72
    v_exp_f32 v73, v73
    v_mfma_f32_32x32x16_bf16 v[32:47], v[124:127], v[116:119], v[32:47]
    ds_read_b128 v[124:127], v146 offset:32512
    v_exp_f32 v74, v74
    v_exp_f32 v75, v75
    v_exp_f32 v76, v76
    v_exp_f32 v77, v77
    v_smfmac_f32_32x32x32_bf16 v[96:111], v[136:139], v[64:71], v144
    s_waitcnt lgkmcnt(1)
    v_exp_f32 v78, v78
    v_exp_f32 v79, v79
    v_exp_f32 v16, v16
    v_exp_f32 v17, v17
    v_smfmac_f32_32x32x32_bf16 v[96:111], v[140:143], v[72:79], v144
    ds_read_b128 v[136:139], v152 offset:32832
    v_exp_f32 v18, v18
    v_exp_f32 v19, v19
    v_exp_f32 v20, v20
    v_exp_f32 v21, v21
    v_mfma_f32_32x32x4_2b_bf16 v[48:79], v[122:123], v[120:121], 0 cbsz:1 abid:1
    v_exp_f32 v22, v22
    v_exp_f32 v23, v23
    v_exp_f32 v24, v24
    v_exp_f32 v25, v25
    v_exp_f32 v26, v26
    v_exp_f32 v27, v27
    v_exp_f32 v28, v28
    v_exp_f32 v29, v29
    v_smfmac_f32_32x32x32_bf16 v[80:95], v[128:131], v[16:23], v144
    ds_read_b128 v[140:143], v152 offset:33504
    v_exp_f32 v30, v30
    v_exp_f32 v31, v31
    v_exp_f32 v32, v32
    v_exp_f32 v33, v33
    v_smfmac_f32_32x32x32_bf16 v[80:95], v[132:135], v[24:31], v144
    s_waitcnt lgkmcnt(2)
    ds_read_b64 v[122:123], v150 offset:0
    v_exp_f32 v34, v34
    v_exp_f32 v35, v35
    v_exp_f32 v36, v36
    v_exp_f32 v37, v37
    v_mfma_f32_32x32x16_bf16 v[48:63], v[124:127], v[112:115], v[48:63]
    v_exp_f32 v38, v38
    v_exp_f32 v39, v39
    v_exp_f32 v40, v40
    v_exp_f32 v41, v41
    v_mfma_f32_32x32x16_bf16 v[64:79], v[124:127], v[116:119], v[64:79]
    ds_read_b128 v[124:127], v147 offset:0
    v_exp_f32 v42, v42
    v_exp_f32 v43, v43
    v_exp_f32 v44, v44
    v_exp_f32 v45, v45
    v_smfmac_f32_32x32x32_bf16 v[96:111], v[128:131], v[32:39], v144
    s_waitcnt vmcnt(1) lgkmcnt(1)
    s_barrier
    s_setprio 3
    v_exp_f32 v46, v46
    v_exp_f32 v47, v47
    v_exp_f32 v48, v48
    v_exp_f32 v49, v49
    v_smfmac_f32_32x32x32_bf16 v[96:111], v[132:135], v[40:47], v144
    s_cmp_eq_u32 s3, 0
    s_cbranch_scc0 Lx_41
    s_mov_b32 m0, 40960
    s_mov_b32 s12, 166912
    buffer_load_dwordx4 v8, s[64:67], s12 offen sc1 lds
Lx_41:
    ds_read_b128 v[128:131], v153 offset:0
    s_add_u32 m0, s51, 32768
    s_add_u32 s12, s51, 158720
    buffer_load_dwordx4 v8, s[64:67], s12 offen sc1 lds
    v_exp_f32 v50, v50
    v_exp_f32 v51, v51
    v_exp_f32 v52, v52
    v_exp_f32 v53, v53
    v_mfma_f32_32x32x4_2b_bf16 v[16:47], v[122:123], v[120:121], 0 cbsz:1 abid:0
    s_add_u32 m0, s91, 40960
    s_nop 0
    buffer_load_dwordx4 v155, s[72:75], s93 offen lds
    v_exp_f32 v54, v54
    v_exp_f32 v55, v55
    v_exp_f32 v56, v56
    v_exp_f32 v57, v57
    v_exp_f32 v58, v58
    v_exp_f32 v59, v59
    v_exp_f32 v60, v60
    v_exp_f32 v61, v61
    v_smfmac_f32_32x32x32_bf16 v[80:95], v[136:139], v[48:55], v144
    ds_read_b128 v[132:135], v153 offset:672
    v_exp_f32 v62, v62
    v_exp_f32 v63, v63
    v_exp_f32 v64, v64
    v_exp_f32 v65, v65
    v_smfmac_f32_32x32x32_bf16 v[80:95], v[140:143], v[56:63], v144
    s_waitcnt lgkmcnt(2)
    v_exp_f32 v66, v66
    v_exp_f32 v67, v67
    v_exp_f32 v68, v68
    v_exp_f32 v69, v69
    v_mfma_f32_32x32x16_bf16 v[16:31], v[124:127], v[112:115], v[16:31]
    s_add_u32 m0, s91, 41984
    s_nop 0
    buffer_load_dwordx4 v156, s[72:75], s93 offen lds
    v_exp_f32 v70, v70
    v_exp_f32 v71, v71
    v_exp_f32 v72, v72
    v_exp_f32 v73, v73
    v_mfma_f32_32x32x16_bf16 v[32:47], v[124:127], v[116:119], v[32:47]
    ds_read_b128 v[124:127], v147 offset:1024
    v_exp_f32 v74, v74
    v_exp_f32 v75, v75
    v_exp_f32 v76, v76
    v_exp_f32 v77, v77
    v_smfmac_f32_32x32x32_bf16 v[96:111], v[136:139], v[64:71], v144
    s_waitcnt lgkmcnt(1)
    v_exp_f32 v78, v78
    v_exp_f32 v79, v79
    v_exp_f32 v16, v16
    v_exp_f32 v17, v17
    v_smfmac_f32_32x32x32_bf16 v[96:111], v[140:143], v[72:79], v144
    ds_read_b128 v[136:139], v153 offset:1344
    v_exp_f32 v18, v18
    v_exp_f32 v19, v19
    v_exp_f32 v20, v20
    v_exp_f32 v21, v21
    v_mfma_f32_32x32x4_2b_bf16 v[48:79], v[122:123], v[120:121], 0 cbsz:1 abid:1
    s_add_u32 m0, s91, 43008
    s_nop 0
    buffer_load_dwordx4 v157, s[72:75], s93 offen lds
    v_exp_f32 v22, v22
    v_exp_f32 v23, v23
    v_exp_f32 v24, v24
    v_exp_f32 v25, v25
    v_exp_f32 v26, v26
    v_exp_f32 v27, v27
    v_exp_f32 v28, v28
    v_exp_f32 v29, v29
    v_smfmac_f32_32x32x32_bf16 v[80:95], v[128:131], v[16:23], v144
    ds_read_b128 v[140:143], v153 offset:2016
    v_exp_f32 v30, v30
    v_exp_f32 v31, v31
    v_exp_f32 v32, v32
    v_exp_f32 v33, v33
    v_smfmac_f32_32x32x32_bf16 v[80:95], v[132:135], v[24:31], v144
    s_waitcnt lgkmcnt(2)
    ds_read_b64 v[122:123], v150 offset:10496
    v_exp_f32 v34, v34
    v_exp_f32 v35, v35
    v_exp_f32 v36, v36
    v_exp_f32 v37, v37
    v_mfma_f32_32x32x16_bf16 v[48:63], v[124:127], v[112:115], v[48:63]
    s_add_u32 m0, s91, 44032
    s_nop 0
    buffer_load_dwordx4 v158, s[72:75], s93 offen lds
    v_exp_f32 v38, v38
    v_exp_f32 v39, v39
    v_exp_f32 v40, v40
    v_exp_f32 v41, v41
    v_mfma_f32_32x32x16_bf16 v[64:79], v[124:127], v[116:119], v[64:79]
    ds_read_b128 v[124:127], v147 offset:10496
    s_setprio 2
    v_exp_f32 v42, v42
    v_exp_f32 v43, v43
    v_exp_f32 v44, v44
    v_exp_f32 v45, v45
    v_smfmac_f32_32x32x32_bf16 v[96:111], v[128:131], v[32:39], v144
    s_waitcnt lgkmcnt(1)
    v_exp_f32 v46, v46
    v_exp_f32 v47, v47
    v_exp_f32 v48, v48
    v_exp_f32 v49, v49
    v_smfmac_f32_32x32x32_bf16 v[96:111], v[132:135], v[40:47], v144
    ds_read_b128 v[128:131], v153 offset:10496
    v_exp_f32 v50, v50
    v_exp_f32 v51, v51
    v_exp_f32 v52, v52
    v_exp_f32 v53, v53
    v_mfma_f32_32x32x4_2b_bf16 v[16:47], v[122:123], v[120:121], 0 cbsz:1 abid:0
    s_add_u32 m0, s91, 45056
    s_nop 0
    buffer_load_dwordx4 v159, s[72:75], s93 offen lds
    v_exp_f32 v54, v54
    v_exp_f32 v55, v55
    v_exp_f32 v56, v56
    v_exp_f32 v57, v57
    v_exp_f32 v58, v58
    v_exp_f32 v59, v59
    v_exp_f32 v60, v60
    v_exp_f32 v61, v61
    v_smfmac_f32_32x32x32_bf16 v[80:95], v[136:139], v[48:55], v144
    ds_read_b128 v[132:135], v153 offset:11168
    v_exp_f32 v62, v62
    v_exp_f32 v63, v63
    v_exp_f32 v64, v64
    v_exp_f32 v65, v65
    v_smfmac_f32_32x32x32_bf16 v[80:95], v[140:143], v[56:63], v144
    s_waitcnt lgkmcnt(2)
    v_exp_f32 v66, v66
    v_exp_f32 v67, v67
    v_exp_f32 v68, v68
    v_exp_f32 v69, v69
    v_mfma_f32_32x32x16_bf16 v[16:31], v[124:127], v[112:115], v[16:31]
    s_add_u32 m0, s91, 61440
    s_nop 0
    buffer_load_dwordx4 v155, s[72:75], s94 offen lds
    v_exp_f32 v70, v70
    v_exp_f32 v71, v71
    v_exp_f32 v72, v72
    v_exp_f32 v73, v73
    v_mfma_f32_32x32x16_bf16 v[32:47], v[124:127], v[116:119], v[32:47]
    ds_read_b128 v[124:127], v147 offset:11520
    v_exp_f32 v74, v74
    v_exp_f32 v75, v75
    v_exp_f32 v76, v76
    v_exp_f32 v77, v77
    v_smfmac_f32_32x32x32_bf16 v[96:111], v[136:139], v[64:71], v144
    s_waitcnt lgkmcnt(1)
    v_exp_f32 v78, v78
    v_exp_f32 v79, v79
    v_exp_f32 v16, v16
    v_exp_f32 v17, v17
    v_smfmac_f32_32x32x32_bf16 v[96:111], v[140:143], v[72:79], v144
    ds_read_b128 v[136:139], v153 offset:11840
    v_exp_f32 v18, v18
    v_exp_f32 v19, v19
    v_exp_f32 v20, v20
    v_exp_f32 v21, v21
    v_mfma_f32_32x32x4_2b_bf16 v[48:79], v[122:123], v[120:121], 0 cbsz:1 abid:1
    s_add_u32 m0, s91, 62464
    s_nop 0
    buffer_load_dwordx4 v156, s[72:75], s94 offen lds
    v_exp_f32 v22, v22
    v_exp_f32 v23, v23
    v_exp_f32 v24, v24
    v_exp_f32 v25, v25
    v_exp_f32 v26, v26
    v_exp_f32 v27, v27
    v_exp_f32 v28, v28
    v_exp_f32 v29, v29
    v_smfmac_f32_32x32x32_bf16 v[80:95], v[128:131], v[16:23], v144
    ds_read_b128 v[140:143], v153 offset:12512
    v_exp_f32 v30, v30
    v_exp_f32 v31, v31
    v_exp_f32 v32, v32
    v_exp_f32 v33, v33
    v_smfmac_f32_32x32x32_bf16 v[80:95], v[132:135], v[24:31], v144
    s_waitcnt lgkmcnt(2)
    ds_read_b64 v[122:123], v150 offset:20992
    v_exp_f32 v34, v34
    v_exp_f32 v35, v35
    v_exp_f32 v36, v36
    v_exp_f32 v37, v37
    v_mfma_f32_32x32x16_bf16 v[48:63], v[124:127], v[112:115], v[48:63]
    s_add_u32 m0, s91, 63488
    s_nop 0
    buffer_load_dwordx4 v157, s[72:75], s94 offen lds
    v_exp_f32 v38, v38
    v_exp_f32 v39, v39
    v_exp_f32 v40, v40
    v_exp_f32 v41, v41
    v_mfma_f32_32x32x16_bf16 v[64:79], v[124:127], v[116:119], v[64:79]
    ds_read_b128 v[124:127], v147 offset:20992
    s_setprio 1
    v_exp_f32 v42, v42
    v_exp_f32 v43, v43
    v_exp_f32 v44, v44
    v_exp_f32 v45, v45
    v_smfmac_f32_32x32x32_bf16 v[96:111], v[128:131], v[32:39], v144
    s_waitcnt lgkmcnt(1)
    v_exp_f32 v46, v46
    v_exp_f32 v47, v47
    v_exp_f32 v48, v48
    v_exp_f32 v49, v49
    v_smfmac_f32_32x32x32_bf16 v[96:111], v[132:135], v[40:47], v144
    ds_read_b128 v[128:131], v153 offset:20992
    v_exp_f32 v50, v50
    v_exp_f32 v51, v51
    v_exp_f32 v52, v52
    v_exp_f32 v53, v53
    v_mfma_f32_32x32x4_2b_bf16 v[16:47], v[122:123], v[120:121], 0 cbsz:1 abid:0
    s_add_u32 m0, s91, 64512
    s_nop 0
    buffer_load_dwordx4 v158, s[72:75], s94 offen lds
    v_exp_f32 v54, v54
    v_exp_f32 v55, v55
    v_exp_f32 v56, v56
    v_exp_f32 v57, v57
    v_exp_f32 v58, v58
    v_exp_f32 v59, v59
    v_exp_f32 v60, v60
    v_exp_f32 v61, v61
    v_smfmac_f32_32x32x32_bf16 v[80:95], v[136:139], v[48:55], v144
    ds_read_b128 v[132:135], v153 offset:21664
    v_exp_f32 v62, v62
    v_exp_f32 v63, v63
    v_exp_f32 v64, v64
    v_exp_f32 v65, v65
    v_smfmac_f32_32x32x32_bf16 v[80:95], v[140:143], v[56:63], v144
    s_waitcnt lgkmcnt(2)
    v_exp_f32 v66, v66
    v_exp_f32 v67, v67
    v_exp_f32 v68, v68
    v_exp_f32 v69, v69
    v_mfma_f32_32x32x16_bf16 v[16:31], v[124:127], v[112:115], v[16:31]
    s_add_u32 m0, s91, 65536
    s_nop 0
    buffer_load_dwordx4 v159, s[72:75], s94 offen lds
    v_exp_f32 v70, v70
    v_exp_f32 v71, v71
    v_exp_f32 v72, v72
    v_exp_f32 v73, v73
    v_mfma_f32_32x32x16_bf16 v[32:47], v[124:127], v[116:119], v[32:47]
    ds_read_b128 v[124:127], v147 offset:22016
    v_exp_f32 v74, v74
    v_exp_f32 v75, v75
    v_exp_f32 v76, v76
    v_exp_f32 v77, v77
    v_smfmac_f32_32x32x32_bf16 v[96:111], v[136:139], v[64:71], v144
    s_waitcnt lgkmcnt(1)
    v_exp_f32 v78, v78
    v_exp_f32 v79, v79
    v_exp_f32 v16, v16
    v_exp_f32 v17, v17
    v_smfmac_f32_32x32x32_bf16 v[96:111], v[140:143], v[72:79], v144
    ds_read_b128 v[136:139], v153 offset:22336
    v_exp_f32 v18, v18
    v_exp_f32 v19, v19
    v_exp_f32 v20, v20
    v_exp_f32 v21, v21
    v_mfma_f32_32x32x4_2b_bf16 v[48:79], v[122:123], v[120:121], 0 cbsz:1 abid:1
    s_add_u32 s98, s6, L_tabA-L_pc+4096
    s_addc_u32 s99, s7, 0
    global_load_dwordx4 v[12:15], v8, s[98:99]
    v_mov_b32 v6, 0
    v_exp_f32 v22, v22
    v_exp_f32 v23, v23
    v_exp_f32 v24, v24
    v_exp_f32 v25, v25
    v_exp_f32 v26, v26
    v_exp_f32 v27, v27
    v_exp_f32 v28, v28
    v_exp_f32 v29, v29
    v_smfmac_f32_32x32x32_bf16 v[80:95], v[128:131], v[16:23], v144
    ds_read_b128 v[140:143], v153 offset:23008
    v_exp_f32 v30, v30
    v_exp_f32 v31, v31
    v_exp_f32 v32, v32
    v_exp_f32 v33, v33
    v_smfmac_f32_32x32x32_bf16 v[80:95], v[132:135], v[24:31], v144
    s_waitcnt lgkmcnt(2)
    ds_read_b64 v[122:123], v150 offset:31488
    v_exp_f32 v34, v34
    v_exp_f32 v35, v35
    v_exp_f32 v36, v36
    v_exp_f32 v37, v37
    v_mfma_f32_32x32x16_bf16 v[48:63], v[124:127], v[112:115], v[48:63]
    v_exp_f32 v38, v38
    v_exp_f32 v39, v39
    v_exp_f32 v40, v40
    v_exp_f32 v41, v41
    v_mfma_f32_32x32x16_bf16 v[64:79], v[124:127], v[116:119], v[64:79]
    ds_read_b128 v[124:127], v147 offset:31488
    s_setprio 0
    v_exp_f32 v42, v42
    v_exp_f32 v43, v43
    v_exp_f32 v44, v44
    v_exp_f32 v45, v45
    v_smfmac_f32_32x32x32_bf16 v[96:111], v[128:131], v[32:39], v144
    s_waitcnt lgkmcnt(1)
    v_exp_f32 v46, v46
    v_exp_f32 v47, v47
    v_exp_f32 v48, v48
    v_exp_f32 v49, v49
    v_smfmac_f32_32x32x32_bf16 v[96:111], v[132:135], v[40:47], v144
    ds_read_b128 v[128:131], v153 offset:31488
    v_exp_f32 v50, v50
    v_exp_f32 v51, v51
    v_exp_f32 v52, v52
    v_exp_f32 v53, v53
    v_mfma_f32_32x32x4_2b_bf16 v[16:47], v[122:123], v[120:121], 0 cbsz:1 abid:0
    v_exp_f32 v54, v54
    v_exp_f32 v55, v55
    v_exp_f32 v56, v56
    v_exp_f32 v57, v57
    v_exp_f32 v58, v58
    v_exp_f32 v59, v59
    v_exp_f32 v60, v60
    v_exp_f32 v61, v61
    v_smfmac_f32_32x32x32_bf16 v[80:95], v[136:139], v[48:55], v144
    ds_read_b128 v[132:135], v153 offset:32160
    v_exp_f32 v62, v62
    v_exp_f32 v63, v63
    v_exp_f32 v64, v64
    v_exp_f32 v65, v65
    v_smfmac_f32_32x32x32_bf16 v[80:95], v[140:143], v[56:63], v144
    s_waitcnt lgkmcnt(2)
    v_exp_f32 v66, v66
    v_exp_f32 v67, v67
    v_exp_f32 v68, v68
    v_exp_f32 v69, v69
    v_mfma_f32_32x32x16_bf16 v[16:31], v[124:127], v[112:115], v[16:31]
    v_exp_f32 v70, v70
    v_exp_f32 v71, v71
    v_exp_f32 v72, v72
    v_exp_f32 v73, v73
    v_mfma_f32_32x32x16_bf16 v[32:47], v[124:127], v[116:119], v[32:47]
    ds_read_b128 v[124:127], v147 offset:32512
    v_exp_f32 v74, v74
    v_exp_f32 v75, v75
    v_exp_f32 v76, v76
    v_exp_f32 v77, v77
    v_smfmac_f32_32x32x32_bf16 v[96:111], v[136:139], v[64:71], v144
    s_waitcnt lgkmcnt(1)
    v_exp_f32 v78, v78
    v_exp_f32 v79, v79
    v_exp_f32 v16, v16
    v_exp_f32 v17, v17
    v_smfmac_f32_32x32x32_bf16 v[96:111], v[140:143], v[72:79], v144
    ds_read_b128 v[136:139], v153 offset:32832
    v_exp_f32 v18, v18
    v_exp_f32 v19, v19
    v_exp_f32 v20, v20
    v_exp_f32 v21, v21
    v_mfma_f32_32x32x4_2b_bf16 v[48:79], v[122:123], v[120:121], 0 cbsz:1 abid:1
    v_exp_f32 v22, v22
    v_exp_f32 v23, v23
    v_exp_f32 v24, v24
    v_exp_f32 v25, v25
    v_exp_f32 v26, v26
    v_exp_f32 v27, v27
    v_exp_f32 v28, v28
    v_exp_f32 v29, v29
    v_smfmac_f32_32x32x32_bf16 v[80:95], v[128:131], v[16:23], v144
    ds_read_b128 v[140:143], v153 offset:33504
    v_exp_f32 v30, v30
    v_exp_f32 v31, v31
    v_exp_f32 v32, v32
    v_exp_f32 v33, v33
    v_smfmac_f32_32x32x32_bf16 v[80:95], v[132:135], v[24:31], v144
    s_waitcnt lgkmcnt(2)
    ds_read_b64 v[122:123], v148 offset:0
    v_exp_f32 v34, v34
    v_exp_f32 v35, v35
    v_exp_f32 v36, v36
    v_exp_f32 v37, v37
    v_mfma_f32_32x32x16_bf16 v[48:63], v[124:127], v[112:115], v[48:63]
    v_exp_f32 v38, v38
    v_exp_f32 v39, v39
    v_exp_f32 v40, v40
    v_exp_f32 v41, v41
    v_mfma_f32_32x32x16_bf16 v[64:79], v[124:127], v[116:119], v[64:79]
    ds_read_b128 v[124:127], v145 offset:0
    v_exp_f32 v42, v42
    v_exp_f32 v43, v43
    v_exp_f32 v44, v44
    v_exp_f32 v45, v45
    v_smfmac_f32_32x32x32_bf16 v[96:111], v[128:131], v[32:39], v144
    s_waitcnt vmcnt(0) lgkmcnt(1)
    s_barrier
    s_setprio 3
    v_exp_f32 v46, v46
    v_exp_f32 v47, v47
    v_exp_f32 v48, v48
    v_exp_f32 v49, v49
    v_smfmac_f32_32x32x32_bf16 v[96:111], v[132:135], v[40:47], v144
    ds_read_b128 v[128:131], v151 offset:0
    ds_read_b64_tr_b16 v[160:161], v240 offset:0
    v_exp_f32 v50, v50
    v_exp_f32 v51, v51
    v_exp_f32 v52, v52
    v_exp_f32 v53, v53
    v_mfma_f32_32x32x4_2b_bf16 v[16:47], v[122:123], v[120:121], 0 cbsz:1 abid:0
    ds_read_b64_tr_b16 v[162:163], v241 offset:0
    v_exp_f32 v54, v54
    v_exp_f32 v55, v55
    v_exp_f32 v56, v56
    v_exp_f32 v57, v57
    v_exp_f32 v58, v58
    v_exp_f32 v59, v59
    v_exp_f32 v60, v60
    v_exp_f32 v61, v61
    v_smfmac_f32_32x32x32_bf16 v[80:95], v[136:139], v[48:55], v144
    ds_read_b128 v[132:135], v151 offset:672
    ds_read_b64_tr_b16 v[164:165], v240 offset:32
    v_exp_f32 v62, v62
    v_exp_f32 v63, v63
    v_exp_f32 v64, v64
    v_exp_f32 v65, v65
    v_smfmac_f32_32x32x32_bf16 v[80:95], v[140:143], v[56:63], v144
    s_waitcnt lgkmcnt(5)
    v_exp_f32 v66, v66
    v_exp_f32 v67, v67
    v_exp_f32 v68, v68
    v_exp_f32 v69, v69
    v_mfma_f32_32x32x16_bf16 v[16:31], v[124:127], v[112:115], v[16:31]
    s_add_u32 m0, s91, 81920
    s_nop 0
    buffer_load_dwordx4 v155, s[72:75], s95 offen lds
    ds_read_b64_tr_b16 v[166:167], v241 offset:32
    v_exp_f32 v70, v70
    v_exp_f32 v71, v71
    v_exp_f32 v72, v72
    v_exp_f32 v73, v73
    v_mfma_f32_32x32x16_bf16 v[32:47], v[124:127], v[116:119], v[32:47]
    ds_read_b128 v[124:127], v145 offset:1024
    v_exp_f32 v74, v74
    v_exp_f32 v75, v75
    v_exp_f32 v76, v76
    v_exp_f32 v77, v77
    v_smfmac_f32_32x32x32_bf16 v[96:111], v[136:139], v[64:71], v144
    s_waitcnt lgkmcnt(1)
    v_exp_f32 v78, v78
    v_exp_f32 v79, v79
    v_exp_f32 v16, v16
    v_exp_f32 v17, v17
    v_smfmac_f32_32x32x32_bf16 v[96:111], v[140:143], v[72:79], v144
    ds_read_b128 v[136:139], v151 offset:1344
    ds_read_b64_tr_b16 v[168:169], v240 offset:64
    v_exp_f32 v18, v18
    v_exp_f32 v19, v19
    v_exp_f32 v20, v20
    v_exp_f32 v21, v21
    v_mfma_f32_32x32x4_2b_bf16 v[48:79], v[122:123], v[120:121], 0 cbsz:1 abid:1
    ds_read_b64_tr_b16 v[170:171], v241 offset:64
    v_exp_f32 v22, v22
    v_exp_f32 v23, v23
    v_exp_f32 v24, v24
    v_exp_f32 v25, v25
    v_exp_f32 v26, v26
    v_exp_f32 v27, v27
    v_exp_f32 v28, v28
    v_exp_f32 v29, v29
    v_smfmac_f32_32x32x32_bf16 v[80:95], v[128:131], v[16:23], v144
    ds_read_b128 v[140:143], v151 offset:2016
    ds_read_b64_tr_b16 v[172:173], v240 offset:96
    v_exp_f32 v30, v30
    v_exp_f32 v31, v31
    v_exp_f32 v32, v32
    v_exp_f32 v33, v33
    v_smfmac_f32_32x32x32_bf16 v[80:95], v[132:135], v[24:31], v144
    s_waitcnt lgkmcnt(5)
    ds_read_b64 v[122:123], v148 offset:10496
    v_exp_f32 v34, v34
    v_exp_f32 v35, v35
    v_exp_f32 v36, v36
    v_exp_f32 v37, v37
    v_mfma_f32_32x32x16_bf16 v[48:63], v[124:127], v[112:115], v[48:63]
    s_add_u32 m0, s91, 82944
    s_nop 0
    buffer_load_dwordx4 v156, s[72:75], s95 offen lds
    ds_read_b64_tr_b16 v[174:175], v241 offset:96
    v_exp_f32 v38, v38
    v_exp_f32 v39, v39
    v_exp_f32 v40, v40
    v_exp_f32 v41, v41
    v_mfma_f32_32x32x16_bf16 v[64:79], v[124:127], v[116:119], v[64:79]
    ds_read_b128 v[124:127], v145 offset:10496
    s_setprio 2
    v_exp_f32 v42, v42
    v_exp_f32 v43, v43
    v_exp_f32 v44, v44
    v_exp_f32 v45, v45
    v_smfmac_f32_32x32x32_bf16 v[96:111], v[128:131], v[32:39], v144
    s_waitcnt lgkmcnt(1)
    v_exp_f32 v46, v46
    v_exp_f32 v47, v47
    v_exp_f32 v48, v48
    v_exp_f32 v49, v49
    v_smfmac_f32_32x32x32_bf16 v[96:111], v[132:135], v[40:47], v144
    ds_read_b128 v[128:131], v151 offset:10496
    ds_read_b64_tr_b16 v[176:177], v240 offset:128
    v_exp_f32 v50, v50
    v_exp_f32 v51, v51
    v_exp_f32 v52, v52
    v_exp_f32 v53, v53
    v_mfma_f32_32x32x4_2b_bf16 v[16:47], v[122:123], v[120:121], 0 cbsz:1 abid:0
    ds_read_b64_tr_b16 v[178:179], v241 offset:128
    v_exp_f32 v54, v54
    v_exp_f32 v55, v55
    v_exp_f32 v56, v56
    v_exp_f32 v57, v57
    v_exp_f32 v58, v58
    v_exp_f32 v59, v59
    v_exp_f32 v60, v60
    v_exp_f32 v61, v61
    v_smfmac_f32_32x32x32_bf16 v[80:95], v[136:139], v[48:55], v144
    ds_read_b128 v[132:135], v151 offset:11168
    ds_read_b64_tr_b16 v[180:181], v242 offset:0
    v_exp_f32 v62, v62
    v_exp_f32 v63, v63
    v_exp_f32 v64, v64
    v_exp_f32 v65, v65
    v_smfmac_f32_32x32x32_bf16 v[80:95], v[140:143], v[56:63], v144
    s_waitcnt lgkmcnt(5)
    v_exp_f32 v66, v66
    v_exp_f32 v67, v67
    v_exp_f32 v68, v68
    v_exp_f32 v69, v69
    v_mfma_f32_32x32x16_bf16 v[16:31], v[124:127], v[112:115], v[16:31]
    s_add_u32 m0, s91, 83968
    s_nop 0
    buffer_load_dwordx4 v157, s[72:75], s95 offen lds
    ds_read_b64_tr_b16 v[182:183], v243 offset:0
    v_exp_f32 v70, v70
    v_exp_f32 v71, v71
    v_exp_f32 v72, v72
    v_exp_f32 v73, v73
    v_mfma_f32_32x32x16_bf16 v[32:47], v[124:127], v[116:119], v[32:47]
    ds_read_b128 v[124:127], v145 offset:11520
    v_exp_f32 v74, v74
    v_exp_f32 v75, v75
    v_exp_f32 v76, v76
    v_exp_f32 v77, v77
    v_smfmac_f32_32x32x32_bf16 v[96:111], v[136:139], v[64:71], v144
    s_waitcnt lgkmcnt(1)
    v_exp_f32 v78, v78
    v_exp_f32 v79, v79
    v_exp_f32 v16, v16
    v_exp_f32 v17, v17
    v_smfmac_f32_32x32x32_bf16 v[96:111], v[140:143], v[72:79], v144
    ds_read_b128 v[136:139], v151 offset:11840
    ds_read_b64_tr_b16 v[184:185], v242 offset:32
    v_exp_f32 v18, v18
    v_exp_f32 v19, v19
    v_exp_f32 v20, v20
    v_exp_f32 v21, v21
    v_mfma_f32_32x32x4_2b_bf16 v[48:79], v[122:123], v[120:121], 0 cbsz:1 abid:1
    ds_read_b64_tr_b16 v[186:187], v243 offset:32
    v_exp_f32 v22, v22
    v_exp_f32 v23, v23
    v_exp_f32 v24, v24
    v_exp_f32 v25, v25
    v_exp_f32 v26, v26
    v_exp_f32 v27, v27
    v_exp_f32 v28, v28
    v_exp_f32 v29, v29
    v_smfmac_f32_32x32x32_bf16 v[80:95], v[128:131], v[16:23], v144
    ds_read_b128 v[140:143], v151 offset:12512
    ds_read_b64_tr_b16 v[188:189], v242 offset:64
    v_exp_f32 v30, v30
    v_exp_f32 v31, v31
    v_exp_f32 v32, v32
    v_exp_f32 v33, v33
    v_smfmac_f32_32x32x32_bf16 v[80:95], v[132:135], v[24:31], v144
    s_waitcnt lgkmcnt(5)
    ds_read_b64 v[122:123], v148 offset:20992
    v_exp_f32 v34, v34
    v_exp_f32 v35, v35
    v_exp_f32 v36, v36
    v_exp_f32 v37, v37
    v_mfma_f32_32x32x16_bf16 v[48:63], v[124:127], v[112:115], v[48:63]
    s_add_u32 m0, s91, 84992
    s_nop 0
    buffer_load_dwordx4 v158, s[72:75], s95 offen lds
    ds_read_b64_tr_b16 v[190:191], v243 offset:64
    v_exp_f32 v38, v38
    v_exp_f32 v39, v39
    v_exp_f32 v40, v40
    v_exp_f32 v41, v41
    v_mfma_f32_32x32x16_bf16 v[64:79], v[124:127], v[116:119], v[64:79]
    ds_read_b128 v[124:127], v145 offset:20992
    s_setprio 1
    v_exp_f32 v42, v42
    v_exp_f32 v43, v43
    v_exp_f32 v44, v44
    v_exp_f32 v45, v45
    v_smfmac_f32_32x32x32_bf16 v[96:111], v[128:131], v[32:39], v144
    s_waitcnt lgkmcnt(1)
    v_exp_f32 v46, v46
    v_exp_f32 v47, v47
    v_exp_f32 v48, v48
    v_exp_f32 v49, v49
    v_smfmac_f32_32x32x32_bf16 v[96:111], v[132:135], v[40:47], v144
    ds_read_b128 v[128:131], v151 offset:20992
    ds_read_b64_tr_b16 v[192:193], v242 offset:96
    v_exp_f32 v50, v50
    v_exp_f32 v51, v51
    v_exp_f32 v52, v52
    v_exp_f32 v53, v53
    v_mfma_f32_32x32x4_2b_bf16 v[16:47], v[122:123], v[120:121], 0 cbsz:1 abid:0
    ds_read_b64_tr_b16 v[194:195], v243 offset:96
    v_exp_f32 v54, v54
    v_exp_f32 v55, v55
    v_exp_f32 v56, v56
    v_exp_f32 v57, v57
    v_exp_f32 v58, v58
    v_exp_f32 v59, v59
    v_exp_f32 v60, v60
    v_exp_f32 v61, v61
    v_smfmac_f32_32x32x32_bf16 v[80:95], v[136:139], v[48:55], v144
    ds_read_b128 v[132:135], v151 offset:21664
    ds_read_b64_tr_b16 v[196:197], v242 offset:128
    v_exp_f32 v62, v62
    v_exp_f32 v63, v63
    v_exp_f32 v64, v64
    v_exp_f32 v65, v65
    v_smfmac_f32_32x32x32_bf16 v[80:95], v[140:143], v[56:63], v144
    s_waitcnt lgkmcnt(5)
    v_exp_f32 v66, v66
    v_exp_f32 v67, v67
    v_exp_f32 v68, v68
    v_exp_f32 v69, v69
    v_mfma_f32_32x32x16_bf16 v[16:31], v[124:127], v[112:115], v[16:31]
    s_add_u32 m0, s91, 86016
    s_nop 0
    buffer_load_dwordx4 v159, s[72:75], s95 offen lds
    ds_read_b64_tr_b16 v[198:199], v243 offset:128
    v_exp_f32 v70, v70
    v_exp_f32 v71, v71
    v_exp_f32 v72, v72
    v_exp_f32 v73, v73
    v_mfma_f32_32x32x16_bf16 v[32:47], v[124:127], v[116:119], v[32:47]
    ds_read_b128 v[124:127], v145 offset:22016
    v_exp_f32 v74, v74
    v_exp_f32 v75, v75
    v_exp_f32 v76, v76
    v_exp_f32 v77, v77
    v_smfmac_f32_32x32x32_bf16 v[96:111], v[136:139], v[64:71], v144
    s_waitcnt lgkmcnt(1)
    v_exp_f32 v78, v78
    v_exp_f32 v79, v79
    v_exp_f32 v16, v16
    v_exp_f32 v17, v17
    v_smfmac_f32_32x32x32_bf16 v[96:111], v[140:143], v[72:79], v144
    ds_read_b128 v[136:139], v151 offset:22336
    ds_read_b64_tr_b16 v[200:201], v244 offset:0
    v_exp_f32 v18, v18
    v_exp_f32 v19, v19
    v_exp_f32 v20, v20
    v_exp_f32 v21, v21
    v_mfma_f32_32x32x4_2b_bf16 v[48:79], v[122:123], v[120:121], 0 cbsz:1 abid:1
    ds_read_b64_tr_b16 v[202:203], v245 offset:0
    v_exp_f32 v22, v22
    v_exp_f32 v23, v23
    v_exp_f32 v24, v24
    v_exp_f32 v25, v25
    v_exp_f32 v26, v26
    v_exp_f32 v27, v27
    v_exp_f32 v28, v28
    v_exp_f32 v29, v29
    v_smfmac_f32_32x32x32_bf16 v[80:95], v[128:131], v[16:23], v144
    ds_read_b128 v[140:143], v151 offset:23008
    ds_read_b64_tr_b16 v[204:205], v244 offset:32
    v_exp_f32 v30, v30
    v_exp_f32 v31, v31
    v_exp_f32 v32, v32
    v_exp_f32 v33, v33
    v_smfmac_f32_32x32x32_bf16 v[80:95], v[132:135], v[24:31], v144
    s_waitcnt lgkmcnt(5)
    ds_read_b64 v[122:123], v148 offset:31488
    v_exp_f32 v34, v34
    v_exp_f32 v35, v35
    v_exp_f32 v36, v36
    v_exp_f32 v37, v37
    v_mfma_f32_32x32x16_bf16 v[48:63], v[124:127], v[112:115], v[48:63]
    buffer_load_dwordx2 v[2:3], v251, s[64:67], s92 offen sc1
    ds_read_b64_tr_b16 v[206:207], v245 offset:32
    v_exp_f32 v38, v38
    v_exp_f32 v39, v39
    v_exp_f32 v40, v40
    v_exp_f32 v41, v41
    v_mfma_f32_32x32x16_bf16 v[64:79], v[124:127], v[116:119], v[64:79]
    ds_read_b128 v[124:127], v145 offset:31488
    s_setprio 0
    v_exp_f32 v42, v42
    v_exp_f32 v43, v43
    v_exp_f32 v44, v44
    v_exp_f32 v45, v45
    v_smfmac_f32_32x32x32_bf16 v[96:111], v[128:131], v[32:39], v144
    s_waitcnt lgkmcnt(1)
    v_exp_f32 v46, v46
    v_exp_f32 v47, v47
    v_exp_f32 v48, v48
    v_exp_f32 v49, v49
    v_smfmac_f32_32x32x32_bf16 v[96:111], v[132:135], v[40:47], v144
    ds_read_b128 v[128:131], v151 offset:31488
    ds_read_b64_tr_b16 v[208:209], v244 offset:64
    v_exp_f32 v50, v50
    v_exp_f32 v51, v51
    v_exp_f32 v52, v52
    v_exp_f32 v53, v53
    v_mfma_f32_32x32x4_2b_bf16 v[16:47], v[122:123], v[120:121], 0 cbsz:1 abid:0
    ds_read_b64_tr_b16 v[210:211], v245 offset:64
    v_exp_f32 v54, v54
    v_exp_f32 v55, v55
    v_exp_f32 v56, v56
    v_exp_f32 v57, v57
    v_exp_f32 v58, v58
    v_exp_f32 v59, v59
    v_exp_f32 v60, v60
    v_exp_f32 v61, v61
    v_smfmac_f32_32x32x32_bf16 v[80:95], v[136:139], v[48:55], v144
    ds_read_b128 v[132:135], v151 offset:32160
    ds_read_b64_tr_b16 v[212:213], v244 offset:96
    v_exp_f32 v62, v62
    v_exp_f32 v63, v63
    v_exp_f32 v64, v64
    v_exp_f32 v65, v65
    v_smfmac_f32_32x32x32_bf16 v[80:95], v[140:143], v[56:63], v144
    s_waitcnt lgkmcnt(5)
    v_exp_f32 v66, v66
    v_exp_f32 v67, v67
    v_exp_f32 v68, v68
    v_exp_f32 v69, v69
    v_mfma_f32_32x32x16_bf16 v[16:31], v[124:127], v[112:115], v[16:31]
    s_add_u32 s93, s90, s90
    s_mul_i32 s13, s5, 160
    s_sub_u32 s93, s93, s13
    s_add_u32 s94, s93, 40960
    s_add_u32 s95, s91, s91
    ds_read_b64_tr_b16 v[214:215], v245 offset:96
    v_exp_f32 v70, v70
    v_exp_f32 v71, v71
    v_exp_f32 v72, v72
    v_exp_f32 v73, v73
    v_mfma_f32_32x32x16_bf16 v[32:47], v[124:127], v[116:119], v[32:47]
    ds_read_b128 v[124:127], v145 offset:32512
    v_exp_f32 v74, v74
    v_exp_f32 v75, v75
    v_exp_f32 v76, v76
    v_exp_f32 v77, v77
    v_smfmac_f32_32x32x32_bf16 v[96:111], v[136:139], v[64:71], v144
    s_waitcnt lgkmcnt(1)
    v_exp_f32 v78, v78
    v_exp_f32 v79, v79
    v_exp_f32 v16, v16
    v_exp_f32 v17, v17
    v_smfmac_f32_32x32x32_bf16 v[96:111], v[140:143], v[72:79], v144
    ds_read_b128 v[136:139], v151 offset:32832
    ds_read_b64_tr_b16 v[216:217], v244 offset:128
    v_exp_f32 v18, v18
    v_exp_f32 v19, v19
    v_exp_f32 v20, v20
    v_exp_f32 v21, v21
    v_mfma_f32_32x32x4_2b_bf16 v[48:79], v[122:123], v[120:121], 0 cbsz:1 abid:1
    ds_read_b64_tr_b16 v[218:219], v245 offset:128
    v_exp_f32 v22, v22
    v_exp_f32 v23, v23
    v_exp_f32 v24, v24
    v_exp_f32 v25, v25
    v_exp_f32 v26, v26
    v_exp_f32 v27, v27
    v_exp_f32 v28, v28
    v_exp_f32 v29, v29
    v_smfmac_f32_32x32x32_bf16 v[80:95], v[128:131], v[16:23], v144
    ds_read_b128 v[140:143], v151 offset:33504
    v_exp_f32 v30, v30
    v_exp_f32 v31, v31
    v_exp_f32 v32, v32
    v_exp_f32 v33, v33
    v_smfmac_f32_32x32x32_bf16 v[80:95], v[132:135], v[24:31], v144
    s_waitcnt lgkmcnt(4)
    v_exp_f32 v34, v34
    v_exp_f32 v35, v35
    v_exp_f32 v36, v36
    v_exp_f32 v37, v37
    v_mfma_f32_32x32x16_bf16 v[48:63], v[124:127], v[112:115], v[48:63]
    v_exp_f32 v38, v38
    v_exp_f32 v39, v39
    v_exp_f32 v40, v40
    v_exp_f32 v41, v41
    v_mfma_f32_32x32x16_bf16 v[64:79], v[124:127], v[116:119], v[64:79]
    v_exp_f32 v42, v42
    v_exp_f32 v43, v43
    v_exp_f32 v44, v44
    v_exp_f32 v45, v45
    v_smfmac_f32_32x32x32_bf16 v[96:111], v[128:131], v[32:39], v144
    s_waitcnt vmcnt(0) lgkmcnt(0)
    s_barrier
    s_setprio 0
    v_exp_f32 v46, v46
    v_exp_f32 v47, v47
    v_exp_f32 v48, v48
    v_exp_f32 v49, v49
    v_smfmac_f32_32x32x32_bf16 v[96:111], v[132:135], v[40:47], v144
    v_exp_f32 v50, v50
    v_exp_f32 v51, v51
    v_exp_f32 v52, v52
    v_exp_f32 v53, v53
    v_exp_f32 v54, v54
    v_exp_f32 v55, v55
    v_exp_f32 v56, v56
    v_exp_f32 v57, v57
    v_exp_f32 v58, v58
    v_exp_f32 v59, v59
    v_exp_f32 v60, v60
    v_exp_f32 v61, v61
    v_smfmac_f32_32x32x32_bf16 v[80:95], v[136:139], v[48:55], v144
    v_exp_f32 v62, v62
    v_exp_f32 v63, v63
    v_exp_f32 v64, v64
    v_exp_f32 v65, v65
    v_smfmac_f32_32x32x32_bf16 v[80:95], v[140:143], v[56:63], v144
    v_exp_f32 v66, v66
    v_exp_f32 v67, v67
    v_exp_f32 v68, v68
    v_exp_f32 v69, v69
    v_exp_f32 v70, v70
    v_exp_f32 v71, v71
    v_exp_f32 v72, v72
    v_exp_f32 v73, v73
    v_exp_f32 v74, v74
    v_exp_f32 v75, v75
    v_exp_f32 v76, v76
    v_exp_f32 v77, v77
    v_smfmac_f32_32x32x32_bf16 v[96:111], v[136:139], v[64:71], v144
    v_exp_f32 v78, v78
    v_exp_f32 v79, v79
    s_nop 1
    v_smfmac_f32_32x32x32_bf16 v[96:111], v[140:143], v[72:79], v144
    s_setprio 3
    s_and_b32 s98, s3, 1
    s_mul_i32 s12, s98, 5120
    s_add_u32 s14, s14, s12
    s_mul_i32 s90, s3, 20480
    s_add_u32 s90, s90, s14
    s_xor_b32 s99, s3, 1
    s_mul_i32 s91, s99, 20480
    s_add_u32 s91, s91, s14
    v_cmp_eq_u64 s[94:95], s[96:97], v[2:3]
    s_mov_b32 s13, 0
    s_mov_b32 s83, 0x57800000
    s_add_u32 s12, s3, 163828
    v_mov_b32 v4, s12
    s_mov_b32 s82, 0
L_t1:
    ds_read_u8 v5, v4
    s_add_u32 s82, s82, 1
    s_waitcnt lgkmcnt(0)
    v_cmp_ne_u32 vcc, 0, v5
    s_cmp_gt_u32 s82, 0x20000
    s_cbranch_vccnz L_t1d
    s_cbranch_scc0 L_t1
L_t1d:
    ds_read_b128 v[24:27], v9 offset:2048
    ds_read_b128 v[36:39], v9 offset:5120
    ds_read_b128 v[16:19], v9 offset:0
    ds_read_b128 v[20:23], v9 offset:1024
    ds_read_b128 v[28:31], v9 offset:3072
    ds_read_b128 v[32:35], v9 offset:4096
    s_waitcnt lgkmcnt(4)
    v_add_f32 v88, v88, v24
    v_add_f32 v104, v104, v36
L_lext:
    v_mov_b32 v40, v88
    v_mov_b32 v41, v88
    v_mov_b32 v42, v104
    v_mov_b32 v43, v104
    v_add_f32 v89, v89, v25
    v_add_f32 v90, v90, v26
    v_add_f32 v91, v91, v27
    v_add_f32 v105, v105, v37
    v_add_f32 v106, v106, v38
    v_add_f32 v107, v107, v39
    v_permlane32_swap_b32 v40, v41
    v_permlane32_swap_b32 v42, v43
    s_cmp_eq_u32 s13, 1
    v_rcp_f32 v44, v41
    v_rcp_f32 v45, v43
    v_min_f32 v40, v41, v43
    v_max_f32 v42, v41, v43
    s_waitcnt lgkmcnt(2)
    v_add_f32 v80, v80, v16
    v_add_f32 v81, v81, v17
    v_add_f32 v82, v82, v18
    v_add_f32 v83, v83, v19
    v_add_f32 v84, v84, v20
    v_add_f32 v85, v85, v21
    v_add_f32 v86, v86, v22
    v_add_f32 v87, v87, v23
    v_mul_f32 v80, v80, v44
    v_mul_f32 v81, v81, v44
    v_mul_f32 v82, v82, v44
    v_mul_f32 v83, v83, v44
    v_mul_f32 v84, v84, v44
    v_mul_f32 v85, v85, v44
    v_mul_f32 v86, v86, v44
    v_mul_f32 v87, v87, v44
    v_mul_f32 v88, v88, v44
    v_mul_f32 v89, v89, v44
    v_mul_f32 v90, v90, v44
    v_mul_f32 v91, v91, v44
    v_cvt_pk_bf16_f32 v124, v80, v81
    v_cvt_pk_bf16_f32 v125, v82, v83
    v_cvt_pk_bf16_f32 v126, v84, v85
    v_cvt_pk_bf16_f32 v127, v86, v87
    v_cvt_pk_bf16_f32 v132, v88, v89
    v_cvt_pk_bf16_f32 v133, v90, v91
    s_waitcnt lgkmcnt(0)
    v_add_f32 v96, v96, v28
    v_add_f32 v97, v97, v29
    v_add_f32 v98, v98, v30
    v_add_f32 v99, v99, v31
    v_add_f32 v100, v100, v32
    v_add_f32 v101, v101, v33
    v_add_f32 v102, v102, v34
    v_add_f32 v103, v103, v35
    v_mul_f32 v96, v96, v45
    v_mul_f32 v97, v97, v45
    v_mul_f32 v98, v98, v45
    v_mul_f32 v99, v99, v45
    v_mul_f32 v100, v100, v45
    v_mul_f32 v101, v101, v45
    v_mul_f32 v102, v102, v45
    v_mul_f32 v103, v103, v45
    v_mul_f32 v104, v104, v45
    v_mul_f32 v105, v105, v45
    v_mul_f32 v106, v106, v45
    v_mul_f32 v107, v107, v45
    v_cvt_pk_bf16_f32 v128, v96, v97
    v_cvt_pk_bf16_f32 v129, v98, v99
    v_cvt_pk_bf16_f32 v130, v100, v101
    v_cvt_pk_bf16_f32 v131, v102, v103
    v_cvt_pk_bf16_f32 v134, v104, v105
    v_cvt_pk_bf16_f32 v135, v106, v107
    s_cbranch_scc1 L_norm
    v_permlane32_swap_b32 v132, v134
    v_permlane32_swap_b32 v133, v135
    v_fmac_f32 v6, v80, v81
    v_fmac_f32 v6, v82, v83
    v_fmac_f32 v6, v84, v85
    v_fmac_f32 v6, v86, v87
    v_fmac_f32 v6, v88, v89
    v_fmac_f32 v6, v90, v91
    v_fmac_f32 v6, v96, v97
    v_fmac_f32 v6, v98, v99
    v_fmac_f32 v6, v100, v101
    v_fmac_f32 v6, v102, v103
    v_fmac_f32 v6, v104, v105
    v_fmac_f32 v6, v106, v107
    v_cmp_ge_f32 s[84:85], s83, v42
    v_fmac_f32 v40, 0, v6
    v_cmp_le_f32 vcc, 0x33800000, v40
    s_nop 0
    s_and_b64 vcc, vcc, s[84:85]
    s_cmp_eq_u64 vcc, -1
    s_cbranch_scc0 L_slow
L_norm2:
    s_cmp_eq_u64 s[94:95], -1
    s_cbranch_scc0 L_far
    buffer_store_dwordx4 v[124:127], v10, s[64:67], s10 offen
    buffer_store_dwordx4 v[128:131], v10, s[64:67], s11 offen
    buffer_store_dwordx2 v[132:133], v11, s[64:67], s15 offen offset:2048
L_pod:
    buffer_load_dwordx4 v[96:99], v15, s[64:67], s90 offen sc1
    ds_read_b64_tr_b16 v[220:221], v246 offset:0
    ds_read_b64_tr_b16 v[222:223], v247 offset:0
    ds_read_b64_tr_b16 v[224:225], v246 offset:32
    ds_read_b64_tr_b16 v[226:227], v247 offset:32
    ds_read_b64_tr_b16 v[228:229], v246 offset:64
    ds_read_b64_tr_b16 v[230:231], v247 offset:64
    ds_read_b64_tr_b16 v[232:233], v246 offset:96
    ds_read_b64_tr_b16 v[234:235], v247 offset:96
    ds_read_b64_tr_b16 v[236:237], v246 offset:128
    ds_read_b64_tr_b16 v[238:239], v247 offset:128
    ds_read_b64_tr_b16 v[136:137], v248 offset:0
    ds_read_b64_tr_b16 v[138:139], v249 offset:0
    ds_read_b64_tr_b16 v[140:141], v248 offset:32
    ds_read_b64_tr_b16 v[142:143], v249 offset:32
    ds_read_b64_tr_b16 v[144:145], v248 offset:64
    ds_read_b64_tr_b16 v[146:147], v249 offset:64
    ds_read_b64_tr_b16 v[148:149], v248 offset:96
    ds_read_b64_tr_b16 v[150:151], v249 offset:96
    ds_read_b64_tr_b16 v[152:153], v248 offset:128
    ds_read_b64_tr_b16 v[154:155], v249 offset:128
    s_mov_b32 s82, 0
    s_waitcnt vmcnt(4)
    v_mov_b32 v4, 163808
    v_mov_b32 v5, 1
    s_mov_b64 exec, 1
    ds_add_u32 v4, v5
    s_mov_b64 exec, -1
L_pr:
    s_waitcnt vmcnt(0)
    v_max_u32 v6, v96, v98
    s_add_u32 s82, s82, 1
    v_cmp_eq_u32 vcc, -1, v6
    s_cbranch_vccz L_prd
    s_cmp_gt_u32 s82, 20000
    s_cbranch_scc1 L_prd
    buffer_load_dwordx4 v[96:99], v15, s[64:67], s90 offen sc1
    s_branch L_pr
L_prd:
    s_add_u32 s13, s90, 8192
    buffer_load_dwordx4 v[16:19], v8, s[64:67], s13 offen offset:2048 sc1
    s_add_u32 s13, s91, 8192
    buffer_load_dwordx4 v[20:23], v8, s[64:67], s13 offen offset:2048 sc1
    s_add_u32 s13, s90, 8192
    buffer_load_dwordx4 v[24:27], v8, s[64:67], s13 offen offset:3072 sc1
    s_add_u32 s13, s91, 8192
    buffer_load_dwordx4 v[28:31], v8, s[64:67], s13 offen offset:3072 sc1
    s_add_u32 s13, s90, 12288
    buffer_load_dwordx4 v[32:35], v8, s[64:67], s13 offen offset:0 sc1
    s_add_u32 s13, s91, 12288
    buffer_load_dwordx4 v[36:39], v8, s[64:67], s13 offen offset:0 sc1
    s_add_u32 s13, s90, 12288
    buffer_load_dwordx4 v[40:43], v8, s[64:67], s13 offen offset:1024 sc1
    s_add_u32 s13, s91, 12288
    buffer_load_dwordx4 v[44:47], v8, s[64:67], s13 offen offset:1024 sc1
    s_add_u32 s13, s90, 12288
    buffer_load_dwordx4 v[48:51], v8, s[64:67], s13 offen offset:2048 sc1
    s_add_u32 s13, s91, 12288
    buffer_load_dwordx4 v[52:55], v8, s[64:67], s13 offen offset:2048 sc1
    s_add_u32 s13, s90, 0
    buffer_load_dwordx4 v[56:59], v8, s[64:67], s13 offen offset:0 sc1
    s_add_u32 s13, s91, 0
    buffer_load_dwordx4 v[60:63], v8, s[64:67], s13 offen offset:0 sc1
    s_add_u32 s13, s90, 0
    buffer_load_dwordx4 v[64:67], v8, s[64:67], s13 offen offset:1024 sc1
    s_add_u32 s13, s91, 0
    buffer_load_dwordx4 v[68:71], v8, s[64:67], s13 offen offset:1024 sc1
    s_add_u32 s13, s90, 0
    buffer_load_dwordx4 v[72:75], v8, s[64:67], s13 offen offset:2048 sc1
    s_add_u32 s13, s91, 0
    buffer_load_dwordx4 v[76:79], v8, s[64:67], s13 offen offset:2048 sc1
    s_add_u32 s13, s90, 0
    buffer_load_dwordx4 v[80:83], v8, s[64:67], s13 offen offset:3072 sc1
    s_add_u32 s13, s91, 0
    buffer_load_dwordx4 v[84:87], v8, s[64:67], s13 offen offset:3072 sc1
    s_add_u32 s13, s90, 4096
    buffer_load_dwordx4 v[88:91], v8, s[64:67], s13 offen offset:0 sc1
    s_add_u32 s13, s91, 4096
    buffer_load_dwordx4 v[92:95], v8, s[64:67], s13 offen offset:0 sc1
    v_mov_b32 v2, 163816
    v_mov_b32 v3, 16
    s_mul_i32 s84, s98, 10240
    s_sub_u32 s84, s84, 40960
    s_mul_i32 s85, s98, 66560
    s_sub_u32 s85, s85, 56320
    v_add_u32 v240, s84, v240
    v_add_u32 v241, s84, v241
    v_add_u32 v242, s84, v242
    v_add_u32 v243, s84, v243
    v_add_u32 v244, s84, v244
    v_add_u32 v245, s84, v245
    v_add_u32 v246, s85, v246
    v_add_u32 v247, s85, v247
    v_add_u32 v248, s85, v248
    v_add_u32 v249, s85, v249
    s_mul_i32 s12, s3, 5120
    s_add_u32 s12, s12, 41984
    v_add_u32 v9, s12, v8
    s_mul_i32 s12, s99, 5120
    s_add_u32 s12, s12, 41984
    v_add_u32 v1, s12, v8
    v_add_u32 v250, s12, v250
    s_and_b32 s12, s3, 2
    s_lshl2_add_u32 s12, s12, 163812
    v_mov_b32 v7, s12
    s_mov_b32 s82, 0
Lsy_42:
    ds_read_b32 v5, v4
    s_add_u32 s82, s82, 1
    s_waitcnt lgkmcnt(0)
    v_readfirstlane_b32 s83, v5
    s_cmp_gt_u32 s82, 0x40000
    s_cbranch_scc1 Lsyd_43
    s_cmp_lt_u32 s83, 8
    s_cbranch_scc1 Lsy_42
Lsyd_43:
    s_setprio 0
    s_lshl_b32 s12, s4, 6
    s_lshl4_add_u32 s12, s3, s12
    s_mul_i32 s12, s12, 2560
    s_mul_i32 s84, s5, 160
    s_add_u32 s12, s12, s84
    v_mov_b32 v5, 1
    s_mov_b32 s82, 0
    s_waitcnt vmcnt(18)
    v_max3_u32 v6, v16, v18, v20
    v_max_u32 v6, v6, v22
    v_cmp_eq_u32 vcc, -1, v6
    s_cbranch_vccnz L_re0
L_ok0:
    v_mfma_f32_16x16x32_bf16 v[96:99], v[160:163], v[16:19], 0
    v_mfma_f32_16x16x32_bf16 v[116:119], v[160:163], v[20:23], 0
    v_mfma_f32_16x16x32_bf16 v[100:103], v[164:167], v[16:19], 0
    ds_read_b64_tr_b16 v[160:161], v240 offset:0
    v_mfma_f32_16x16x32_bf16 v[120:123], v[164:167], v[20:23], 0
    ds_read_b64_tr_b16 v[162:163], v241 offset:0
    v_mfma_f32_16x16x32_bf16 v[104:107], v[168:171], v[16:19], 0
    ds_read_b64_tr_b16 v[164:165], v240 offset:32
    v_mfma_f32_16x16x32_bf16 v[124:127], v[168:171], v[20:23], 0
    ds_read_b64_tr_b16 v[166:167], v241 offset:32
    v_mfma_f32_16x16x32_bf16 v[108:111], v[172:175], v[16:19], 0
    ds_read_b64_tr_b16 v[168:169], v240 offset:64
    s_waitcnt vmcnt(16)
    v_max3_u32 v6, v24, v26, v28
    v_mfma_f32_16x16x32_bf16 v[128:131], v[172:175], v[20:23], 0
    ds_read_b64_tr_b16 v[170:171], v241 offset:64
    v_max_u32 v6, v6, v30
    v_mfma_f32_16x16x32_bf16 v[112:115], v[176:179], v[16:19], 0
    ds_read_b64_tr_b16 v[172:173], v240 offset:96
    v_cmp_eq_u32 vcc, -1, v6
    v_mfma_f32_16x16x32_bf16 v[132:135], v[176:179], v[20:23], 0
    ds_read_b64_tr_b16 v[174:175], v241 offset:96
    s_cbranch_vccnz L_re1
L_ok1:
    v_mfma_f32_16x16x32_bf16 v[96:99], v[180:183], v[24:27], v[96:99]
    ds_read_b64_tr_b16 v[176:177], v240 offset:128
    v_mfma_f32_16x16x32_bf16 v[116:119], v[180:183], v[28:31], v[116:119]
    ds_read_b64_tr_b16 v[178:179], v241 offset:128
    v_mfma_f32_16x16x32_bf16 v[100:103], v[184:187], v[24:27], v[100:103]
    ds_read_b64_tr_b16 v[180:181], v242 offset:0
    v_mfma_f32_16x16x32_bf16 v[120:123], v[184:187], v[28:31], v[120:123]
    ds_read_b64_tr_b16 v[182:183], v243 offset:0
    v_mfma_f32_16x16x32_bf16 v[104:107], v[188:191], v[24:27], v[104:107]
    ds_read_b64_tr_b16 v[184:185], v242 offset:32
    v_mfma_f32_16x16x32_bf16 v[124:127], v[188:191], v[28:31], v[124:127]
    ds_read_b64_tr_b16 v[186:187], v243 offset:32
    v_mfma_f32_16x16x32_bf16 v[108:111], v[192:195], v[24:27], v[108:111]
    ds_read_b64_tr_b16 v[188:189], v242 offset:64
    s_waitcnt vmcnt(14)
    v_max3_u32 v6, v32, v34, v36
    v_mfma_f32_16x16x32_bf16 v[128:131], v[192:195], v[28:31], v[128:131]
    ds_read_b64_tr_b16 v[190:191], v243 offset:64
    v_max_u32 v6, v6, v38
    v_mfma_f32_16x16x32_bf16 v[112:115], v[196:199], v[24:27], v[112:115]
    ds_read_b64_tr_b16 v[192:193], v242 offset:96
    v_cmp_eq_u32 vcc, -1, v6
    v_mfma_f32_16x16x32_bf16 v[132:135], v[196:199], v[28:31], v[132:135]
    ds_read_b64_tr_b16 v[194:195], v243 offset:96
    s_cbranch_vccnz L_re2
L_ok2:
    v_mfma_f32_16x16x32_bf16 v[96:99], v[200:203], v[32:35], v[96:99]
    ds_read_b64_tr_b16 v[196:197], v242 offset:128
    v_mfma_f32_16x16x32_bf16 v[116:119], v[200:203], v[36:39], v[116:119]
    ds_read_b64_tr_b16 v[198:199], v243 offset:128
    v_mfma_f32_16x16x32_bf16 v[100:103], v[204:207], v[32:35], v[100:103]
    ds_read_b64_tr_b16 v[200:201], v244 offset:0
    v_mfma_f32_16x16x32_bf16 v[120:123], v[204:207], v[36:39], v[120:123]
    ds_read_b64_tr_b16 v[202:203], v245 offset:0
    v_mfma_f32_16x16x32_bf16 v[104:107], v[208:211], v[32:35], v[104:107]
    ds_read_b64_tr_b16 v[204:205], v244 offset:32
    v_mfma_f32_16x16x32_bf16 v[124:127], v[208:211], v[36:39], v[124:127]
    ds_read_b64_tr_b16 v[206:207], v245 offset:32
    v_mfma_f32_16x16x32_bf16 v[108:111], v[212:215], v[32:35], v[108:111]
    ds_read_b64_tr_b16 v[208:209], v244 offset:64
    s_waitcnt vmcnt(12)
    v_max3_u32 v6, v40, v42, v44
    v_mfma_f32_16x16x32_bf16 v[128:131], v[212:215], v[36:39], v[128:131]
    ds_read_b64_tr_b16 v[210:211], v245 offset:64
    v_max_u32 v6, v6, v46
    v_mfma_f32_16x16x32_bf16 v[112:115], v[216:219], v[32:35], v[112:115]
    ds_read_b64_tr_b16 v[212:213], v244 offset:96
    v_cmp_eq_u32 vcc, -1, v6
    v_mfma_f32_16x16x32_bf16 v[132:135], v[216:219], v[36:39], v[132:135]
    ds_read_b64_tr_b16 v[214:215], v245 offset:96
    s_cbranch_vccnz L_re3
L_ok3:
    v_mfma_f32_16x16x32_bf16 v[96:99], v[220:223], v[40:43], v[96:99]
    ds_read_b64_tr_b16 v[216:217], v244 offset:128
    v_mfma_f32_16x16x32_bf16 v[116:119], v[220:223], v[44:47], v[116:119]
    ds_read_b64_tr_b16 v[218:219], v245 offset:128
    v_mfma_f32_16x16x32_bf16 v[100:103], v[224:227], v[40:43], v[100:103]
    ds_read_b64_tr_b16 v[220:221], v246 offset:0
    v_mfma_f32_16x16x32_bf16 v[120:123], v[224:227], v[44:47], v[120:123]
    ds_read_b64_tr_b16 v[222:223], v247 offset:0
    v_mfma_f32_16x16x32_bf16 v[104:107], v[228:231], v[40:43], v[104:107]
    ds_read_b64_tr_b16 v[224:225], v246 offset:32
    v_mfma_f32_16x16x32_bf16 v[124:127], v[228:231], v[44:47], v[124:127]
    ds_read_b64_tr_b16 v[226:227], v247 offset:32
    v_mfma_f32_16x16x32_bf16 v[108:111], v[232:235], v[40:43], v[108:111]
    ds_read_b64_tr_b16 v[228:229], v246 offset:64
    s_waitcnt vmcnt(10)
    v_max3_u32 v6, v48, v50, v52
    v_mfma_f32_16x16x32_bf16 v[128:131], v[232:235], v[44:47], v[128:131]
    ds_read_b64_tr_b16 v[230:231], v247 offset:64
    v_max_u32 v6, v6, v54
    v_mfma_f32_16x16x32_bf16 v[112:115], v[236:239], v[40:43], v[112:115]
    ds_read_b64_tr_b16 v[232:233], v246 offset:96
    v_cmp_eq_u32 vcc, -1, v6
    v_mfma_f32_16x16x32_bf16 v[132:135], v[236:239], v[44:47], v[132:135]
    ds_read_b64_tr_b16 v[234:235], v247 offset:96
    s_cbranch_vccnz L_re4
L_ok4:
    v_mfma_f32_16x16x32_bf16 v[96:99], v[136:139], v[48:51], v[96:99]
    ds_read_b64_tr_b16 v[236:237], v246 offset:128
    v_mfma_f32_16x16x32_bf16 v[116:119], v[136:139], v[52:55], v[116:119]
    ds_read_b64_tr_b16 v[238:239], v247 offset:128
    v_mfma_f32_16x16x32_bf16 v[100:103], v[140:143], v[48:51], v[100:103]
    ds_read_b64_tr_b16 v[136:137], v248 offset:0
    v_mfma_f32_16x16x32_bf16 v[120:123], v[140:143], v[52:55], v[120:123]
    ds_read_b64_tr_b16 v[138:139], v249 offset:0
    v_mfma_f32_16x16x32_bf16 v[104:107], v[144:147], v[48:51], v[104:107]
    ds_read_b64_tr_b16 v[140:141], v248 offset:32
    v_mfma_f32_16x16x32_bf16 v[124:127], v[144:147], v[52:55], v[124:127]
    ds_read_b64_tr_b16 v[142:143], v249 offset:32
    v_mfma_f32_16x16x32_bf16 v[108:111], v[148:151], v[48:51], v[108:111]
    ds_read_b64_tr_b16 v[144:145], v248 offset:64
    s_waitcnt vmcnt(8)
    v_max3_u32 v6, v56, v58, v60
    v_mfma_f32_16x16x32_bf16 v[128:131], v[148:151], v[52:55], v[128:131]
    ds_read_b64_tr_b16 v[146:147], v249 offset:64
    v_max_u32 v6, v6, v62
    v_mfma_f32_16x16x32_bf16 v[112:115], v[152:155], v[48:51], v[112:115]
    ds_read_b64_tr_b16 v[148:149], v248 offset:96
    v_cmp_eq_u32 vcc, -1, v6
    v_mfma_f32_16x16x32_bf16 v[132:135], v[152:155], v[52:55], v[132:135]
    ds_read_b64_tr_b16 v[150:151], v249 offset:96
    s_cbranch_vccnz L_re5
L_ok5:
    s_waitcnt lgkmcnt(15)
    v_mfma_f32_16x16x32_bf16 v[96:99], v[160:163], v[56:59], v[96:99]
    ds_read_b64_tr_b16 v[152:153], v248 offset:128
    v_mfma_f32_16x16x32_bf16 v[116:119], v[160:163], v[60:63], v[116:119]
    ds_read_b64_tr_b16 v[154:155], v249 offset:128
    v_mfma_f32_16x16x32_bf16 v[100:103], v[164:167], v[56:59], v[100:103]
    v_mfma_f32_16x16x32_bf16 v[120:123], v[164:167], v[60:63], v[120:123]
    v_mfma_f32_16x16x32_bf16 v[104:107], v[168:171], v[56:59], v[104:107]
    v_mfma_f32_16x16x32_bf16 v[124:127], v[168:171], v[60:63], v[124:127]
    v_mfma_f32_16x16x32_bf16 v[108:111], v[172:175], v[56:59], v[108:111]
    s_waitcnt vmcnt(6)
    v_max3_u32 v6, v64, v66, v68
    v_mfma_f32_16x16x32_bf16 v[128:131], v[172:175], v[60:63], v[128:131]
    v_max_u32 v6, v6, v70
    v_mfma_f32_16x16x32_bf16 v[112:115], v[176:179], v[56:59], v[112:115]
    v_cmp_eq_u32 vcc, -1, v6
    v_mfma_f32_16x16x32_bf16 v[132:135], v[176:179], v[60:63], v[132:135]
    s_cbranch_vccnz L_re6
L_ok6:
    s_waitcnt lgkmcnt(15)
    v_mfma_f32_16x16x32_bf16 v[116:119], v[180:183], v[68:71], v[116:119]
    s_waitcnt vmcnt(4)
    v_max3_u32 v6, v72, v74, v76
    v_mfma_f32_16x16x32_bf16 v[120:123], v[184:187], v[68:71], v[120:123]
    v_max_u32 v6, v6, v78
    v_mfma_f32_16x16x32_bf16 v[124:127], v[188:191], v[68:71], v[124:127]
    v_cmp_eq_u32 vcc, -1, v6
    v_mfma_f32_16x16x32_bf16 v[128:131], v[192:195], v[68:71], v[128:131]
    v_mfma_f32_16x16x32_bf16 v[132:135], v[196:199], v[68:71], v[132:135]
    s_cbranch_vccnz L_re7
L_ok7:
    s_waitcnt lgkmcnt(15)
    v_mfma_f32_16x16x32_bf16 v[116:119], v[200:203], v[76:79], v[116:119]
    s_waitcnt vmcnt(2)
    v_max3_u32 v6, v80, v82, v84
    v_mfma_f32_16x16x32_bf16 v[120:123], v[204:207], v[76:79], v[120:123]
    v_max_u32 v6, v6, v86
    v_mfma_f32_16x16x32_bf16 v[124:127], v[208:211], v[76:79], v[124:127]
    v_cmp_eq_u32 vcc, -1, v6
    v_mfma_f32_16x16x32_bf16 v[128:131], v[212:215], v[76:79], v[128:131]
    v_mfma_f32_16x16x32_bf16 v[132:135], v[216:219], v[76:79], v[132:135]
    s_cbranch_vccnz L_re8
L_ok8:
    s_waitcnt lgkmcnt(10)
    v_mfma_f32_16x16x32_bf16 v[116:119], v[220:223], v[84:87], v[116:119]
    s_waitcnt vmcnt(0)
    v_max3_u32 v6, v88, v90, v92
    v_mfma_f32_16x16x32_bf16 v[120:123], v[224:227], v[84:87], v[120:123]
    v_max_u32 v6, v6, v94
    v_mfma_f32_16x16x32_bf16 v[124:127], v[228:231], v[84:87], v[124:127]
    v_cmp_eq_u32 vcc, -1, v6
    v_mfma_f32_16x16x32_bf16 v[128:131], v[232:235], v[84:87], v[128:131]
    v_mfma_f32_16x16x32_bf16 v[132:135], v[236:239], v[84:87], v[132:135]
    s_cbranch_vccnz L_re9
L_ok9:
    s_waitcnt lgkmcnt(0)
    v_mfma_f32_16x16x32_bf16 v[116:119], v[136:139], v[92:95], v[116:119]
    v_mfma_f32_16x16x32_bf16 v[120:123], v[140:143], v[92:95], v[120:123]
    v_mfma_f32_16x16x32_bf16 v[124:127], v[144:147], v[92:95], v[124:127]
    v_mfma_f32_16x16x32_bf16 v[128:131], v[148:151], v[92:95], v[128:131]
    v_mfma_f32_16x16x32_bf16 v[132:135], v[152:155], v[92:95], v[132:135]
    v_mfma_f32_16x16x32_bf16 v[96:99], v[180:183], v[64:67], v[96:99]
    v_mfma_f32_16x16x32_bf16 v[100:103], v[184:187], v[64:67], v[100:103]
    s_nop 1
    ds_write_b128 v9, v[116:119] offset:0
    v_mfma_f32_16x16x32_bf16 v[104:107], v[188:191], v[64:67], v[104:107]
    s_nop 0
    ds_write_b128 v9, v[120:123] offset:1024
    v_mfma_f32_16x16x32_bf16 v[108:111], v[192:195], v[64:67], v[108:111]
    ds_write_b128 v9, v[124:127] offset:2048
    v_mfma_f32_16x16x32_bf16 v[112:115], v[196:199], v[64:67], v[112:115]
    ds_write_b128 v9, v[128:131] offset:3072
    v_mfma_f32_16x16x32_bf16 v[96:99], v[200:203], v[72:75], v[96:99]
    ds_write_b128 v9, v[132:135] offset:4096
    v_mfma_f32_16x16x32_bf16 v[100:103], v[204:207], v[72:75], v[100:103]
    s_mov_b64 exec, 1
    ds_add_u32 v7, v5
    s_mov_b64 exec, -1
    v_mfma_f32_16x16x32_bf16 v[104:107], v[208:211], v[72:75], v[104:107]
    v_mfma_f32_16x16x32_bf16 v[108:111], v[212:215], v[72:75], v[108:111]
    v_mfma_f32_16x16x32_bf16 v[112:115], v[216:219], v[72:75], v[112:115]
    v_mfma_f32_16x16x32_bf16 v[96:99], v[220:223], v[80:83], v[96:99]
    v_mfma_f32_16x16x32_bf16 v[100:103], v[224:227], v[80:83], v[100:103]
    v_mfma_f32_16x16x32_bf16 v[104:107], v[228:231], v[80:83], v[104:107]
    ds_read_b32 v6, v7
    v_mfma_f32_16x16x32_bf16 v[108:111], v[232:235], v[80:83], v[108:111]
    ds_read_b128 v[40:43], v1 offset:0
    v_mfma_f32_16x16x32_bf16 v[112:115], v[236:239], v[80:83], v[112:115]
    ds_read_b128 v[44:47], v1 offset:1024
    v_mfma_f32_16x16x32_bf16 v[96:99], v[136:139], v[88:91], v[96:99]
    ds_read_b128 v[48:51], v1 offset:2048
    v_mfma_f32_16x16x32_bf16 v[100:103], v[140:143], v[88:91], v[100:103]
    ds_read_b128 v[52:55], v1 offset:3072
    v_mfma_f32_16x16x32_bf16 v[104:107], v[144:147], v[88:91], v[104:107]
    ds_read_b128 v[56:59], v1 offset:4096
    v_mfma_f32_16x16x32_bf16 v[108:111], v[148:151], v[88:91], v[108:111]
    v_mfma_f32_16x16x32_bf16 v[112:115], v[152:155], v[88:91], v[112:115]
    s_mov_b32 s82, 0
L_ex:
    s_add_u32 s82, s82, 1
    s_waitcnt lgkmcnt(5)
    v_readfirstlane_b32 s83, v6
    s_cmp_gt_u32 s82, 0x40000
    s_cbranch_scc1 L_exd
    s_cmp_lt_u32 s83, 2
    s_cbranch_scc0 L_exd
    ds_read_b32 v6, v7
    ds_read_b128 v[40:43], v1 offset:0
    ds_read_b128 v[44:47], v1 offset:1024
    ds_read_b128 v[48:51], v1 offset:2048
    ds_read_b128 v[52:55], v1 offset:3072
    ds_read_b128 v[56:59], v1 offset:4096
    s_branch L_ex
L_exd:
    s_waitcnt lgkmcnt(4)
    v_add_f32 v96, v96, v40
    v_add_f32 v97, v97, v41
    v_add_f32 v98, v98, v42
    v_add_f32 v99, v99, v43
    v_cvt_pk_bf16_f32 v16, v96, v97
    v_cvt_pk_bf16_f32 v17, v98, v99
    ds_write_b64 v250, v[16:17] offset:0
    s_waitcnt lgkmcnt(4)
    v_add_f32 v100, v100, v44
    v_add_f32 v101, v101, v45
    v_add_f32 v102, v102, v46
    v_add_f32 v103, v103, v47
    v_cvt_pk_bf16_f32 v18, v100, v101
    v_cvt_pk_bf16_f32 v19, v102, v103
    ds_write_b64 v250, v[18:19] offset:32
    s_waitcnt lgkmcnt(4)
    v_add_f32 v104, v104, v48
    v_add_f32 v105, v105, v49
    v_add_f32 v106, v106, v50
    v_add_f32 v107, v107, v51
    v_cvt_pk_bf16_f32 v20, v104, v105
    v_cvt_pk_bf16_f32 v21, v106, v107
    ds_write_b64 v250, v[20:21] offset:64
    s_waitcnt lgkmcnt(4)
    v_add_f32 v108, v108, v52
    v_add_f32 v109, v109, v53
    v_add_f32 v110, v110, v54
    v_add_f32 v111, v111, v55
    v_cvt_pk_bf16_f32 v22, v108, v109
    v_cvt_pk_bf16_f32 v23, v110, v111
    ds_write_b64 v250, v[22:23] offset:96
    s_waitcnt lgkmcnt(4)
    v_add_f32 v112, v112, v56
    v_add_f32 v113, v113, v57
    v_add_f32 v114, v114, v58
    v_add_f32 v115, v115, v59
    v_cvt_pk_bf16_f32 v24, v112, v113
    v_cvt_pk_bf16_f32 v25, v114, v115
    ds_write_b64 v250, v[24:25] offset:128
    ds_read_b128 v[28:31], v1 offset:0
    ds_read_b128 v[32:35], v1 offset:1024
    ds_read_b128 v[36:39], v1 offset:2048
    s_waitcnt lgkmcnt(2)
    buffer_store_dwordx4 v[28:31], v12, s[68:71], s12 offen
    s_waitcnt lgkmcnt(1)
    buffer_store_dwordx4 v[32:35], v13, s[68:71], s12 offen
    s_waitcnt lgkmcnt(0)
    buffer_store_dwordx4 v[36:39], v14, s[68:71], s12 offen
    s_branch L_fin
L_norm:
    v_permlane32_swap_b32 v132, v134
    v_permlane32_swap_b32 v133, v135
    s_branch L_norm2
L_far:
    buffer_store_dwordx4 v[124:127], v10, s[64:67], s10 offen sc1
    buffer_store_dwordx4 v[128:131], v10, s[64:67], s11 offen sc1
    buffer_store_dwordx2 v[132:133], v11, s[64:67], s15 offen offset:2048 sc1
    s_mov_b32 s82, 0
L_po:
    v_xor_b32 v3, s81, v3
    v_xor_b32 v2, s80, v2
    v_lshl_or_b32 v2, v3, 4, v2
    s_add_u32 s82, s82, 1
    v_cmp_ne_u32 vcc, 0, v2
    s_cbranch_vccz L_pod
    s_cmp_gt_u32 s82, 20000
    s_cbranch_scc1 L_pod
    buffer_load_dwordx2 v[2:3], v251, s[64:67], s92 offen sc1
    s_waitcnt vmcnt(0)
    s_branch L_po
L_re0:
    s_add_u32 s13, s90, 8192
    buffer_load_dwordx4 v[16:19], v8, s[64:67], s13 offen offset:2048 sc1
    s_add_u32 s13, s91, 8192
    buffer_load_dwordx4 v[20:23], v8, s[64:67], s13 offen offset:2048 sc1
    s_add_u32 s82, s82, 1
    s_cmp_gt_u32 s82, 20000
    s_waitcnt vmcnt(0)
    s_cbranch_scc1 L_ok0
    v_max3_u32 v6, v16, v18, v20
    v_max_u32 v6, v6, v22
    v_cmp_eq_u32 vcc, -1, v6
    s_cbranch_vccnz L_re0
    s_branch L_ok0
L_re1:
    s_add_u32 s13, s90, 8192
    buffer_load_dwordx4 v[24:27], v8, s[64:67], s13 offen offset:3072 sc1
    s_add_u32 s13, s91, 8192
    buffer_load_dwordx4 v[28:31], v8, s[64:67], s13 offen offset:3072 sc1
    s_add_u32 s82, s82, 1
    s_cmp_gt_u32 s82, 20000
    s_waitcnt vmcnt(0)
    s_cbranch_scc1 L_ok1
    v_max3_u32 v6, v24, v26, v28
    v_max_u32 v6, v6, v30
    v_cmp_eq_u32 vcc, -1, v6
    s_cbranch_vccnz L_re1
    s_branch L_ok1
L_re2:
    s_add_u32 s13, s90, 12288
    buffer_load_dwordx4 v[32:35], v8, s[64:67], s13 offen offset:0 sc1
    s_add_u32 s13, s91, 12288
    buffer_load_dwordx4 v[36:39], v8, s[64:67], s13 offen offset:0 sc1
    s_add_u32 s82, s82, 1
    s_cmp_gt_u32 s82, 20000
    s_waitcnt vmcnt(0)
    s_cbranch_scc1 L_ok2
    v_max3_u32 v6, v32, v34, v36
    v_max_u32 v6, v6, v38
    v_cmp_eq_u32 vcc, -1, v6
    s_cbranch_vccnz L_re2
    s_branch L_ok2
L_re3:
    s_add_u32 s13, s90, 12288
    buffer_load_dwordx4 v[40:43], v8, s[64:67], s13 offen offset:1024 sc1
    s_add_u32 s13, s91, 12288
    buffer_load_dwordx4 v[44:47], v8, s[64:67], s13 offen offset:1024 sc1
    s_add_u32 s82, s82, 1
    s_cmp_gt_u32 s82, 20000
    s_waitcnt vmcnt(0)
    s_cbranch_scc1 L_ok3
    v_max3_u32 v6, v40, v42, v44
    v_max_u32 v6, v6, v46
    v_cmp_eq_u32 vcc, -1, v6
    s_cbranch_vccnz L_re3
    s_branch L_ok3
L_re4:
    s_add_u32 s13, s90, 12288
    buffer_load_dwordx4 v[48:51], v8, s[64:67], s13 offen offset:2048 sc1
    s_add_u32 s13, s91, 12288
    buffer_load_dwordx4 v[52:55], v8, s[64:67], s13 offen offset:2048 sc1
    s_add_u32 s82, s82, 1
    s_cmp_gt_u32 s82, 20000
    s_waitcnt vmcnt(0)
    s_cbranch_scc1 L_ok4
    v_max3_u32 v6, v48, v50, v52
    v_max_u32 v6, v6, v54
    v_cmp_eq_u32 vcc, -1, v6
    s_cbranch_vccnz L_re4
    s_branch L_ok4
L_re5:
    s_add_u32 s13, s90, 0
    buffer_load_dwordx4 v[56:59], v8, s[64:67], s13 offen offset:0 sc1
    s_add_u32 s13, s91, 0
    buffer_load_dwordx4 v[60:63], v8, s[64:67], s13 offen offset:0 sc1
    s_add_u32 s82, s82, 1
    s_cmp_gt_u32 s82, 20000
    s_waitcnt vmcnt(0)
    s_cbranch_scc1 L_ok5
    v_max3_u32 v6, v56, v58, v60
    v_max_u32 v6, v6, v62
    v_cmp_eq_u32 vcc, -1, v6
    s_cbranch_vccnz L_re5
    s_branch L_ok5
L_re6:
    s_add_u32 s13, s90, 0
    buffer_load_dwordx4 v[64:67], v8, s[64:67], s13 offen offset:1024 sc1
    s_add_u32 s13, s91, 0
    buffer_load_dwordx4 v[68:71], v8, s[64:67], s13 offen offset:1024 sc1
    s_add_u32 s82, s82, 1
    s_cmp_gt_u32 s82, 20000
    s_waitcnt vmcnt(0)
    s_cbranch_scc1 L_ok6
    v_max3_u32 v6, v64, v66, v68
    v_max_u32 v6, v6, v70
    v_cmp_eq_u32 vcc, -1, v6
    s_cbranch_vccnz L_re6
    s_branch L_ok6
L_re7:
    s_add_u32 s13, s90, 0
    buffer_load_dwordx4 v[72:75], v8, s[64:67], s13 offen offset:2048 sc1
    s_add_u32 s13, s91, 0
    buffer_load_dwordx4 v[76:79], v8, s[64:67], s13 offen offset:2048 sc1
    s_add_u32 s82, s82, 1
    s_cmp_gt_u32 s82, 20000
    s_waitcnt vmcnt(0)
    s_cbranch_scc1 L_ok7
    v_max3_u32 v6, v72, v74, v76
    v_max_u32 v6, v6, v78
    v_cmp_eq_u32 vcc, -1, v6
    s_cbranch_vccnz L_re7
    s_branch L_ok7
L_re8:
    s_add_u32 s13, s90, 0
    buffer_load_dwordx4 v[80:83], v8, s[64:67], s13 offen offset:3072 sc1
    s_add_u32 s13, s91, 0
    buffer_load_dwordx4 v[84:87], v8, s[64:67], s13 offen offset:3072 sc1
    s_add_u32 s82, s82, 1
    s_cmp_gt_u32 s82, 20000
    s_waitcnt vmcnt(0)
    s_cbranch_scc1 L_ok8
    v_max3_u32 v6, v80, v82, v84
    v_max_u32 v6, v6, v86
    v_cmp_eq_u32 vcc, -1, v6
    s_cbranch_vccnz L_re8
    s_branch L_ok8
L_re9:
    s_add_u32 s13, s90, 4096
    buffer_load_dwordx4 v[88:91], v8, s[64:67], s13 offen offset:0 sc1
    s_add_u32 s13, s91, 4096
    buffer_load_dwordx4 v[92:95], v8, s[64:67], s13 offen offset:0 sc1
    s_add_u32 s82, s82, 1
    s_cmp_gt_u32 s82, 20000
    s_waitcnt vmcnt(0)
    s_cbranch_scc1 L_ok9
    v_max3_u32 v6, v88, v90, v92
    v_max_u32 v6, v6, v94
    v_cmp_eq_u32 vcc, -1, v6
    s_cbranch_vccnz L_re9
    s_branch L_ok9
Lck_22s:
    ds_read_b32 v75, v74
    s_add_u32 s82, s82, 1
    s_waitcnt lgkmcnt(0)
    v_cmp_gt_u32_sdwa vcc, 8, v75 src0_sel:DWORD src1_sel:BYTE_0
    s_cbranch_vccz Lck_22
    s_cmp_lt_u32 s82, 0x40000
    s_cbranch_scc1 Lck_22s
    s_branch Lck_22
Lck_23s:
    ds_read_b32 v75, v74
    s_add_u32 s82, s82, 1
    s_waitcnt lgkmcnt(0)
    v_cmp_gt_u32_sdwa vcc, 4, v75 src0_sel:DWORD src1_sel:BYTE_1
    s_cbranch_vccz Lck_23
    s_cmp_lt_u32 s82, 0x40000
    s_cbranch_scc1 Lck_23s
    s_branch Lck_23
Lck_24s:
    ds_read_b32 v75, v74
    s_add_u32 s82, s82, 1
    s_waitcnt lgkmcnt(0)
    v_cmp_gt_u32_sdwa vcc, 12, v75 src0_sel:DWORD src1_sel:BYTE_0
    s_cbranch_vccz Lck_24
    s_cmp_lt_u32 s82, 0x40000
    s_cbranch_scc1 Lck_24s
    s_branch Lck_24
Lck_25s:
    ds_read_b32 v75, v74
    s_add_u32 s82, s82, 1
    s_waitcnt lgkmcnt(0)
    v_cmp_gt_u32_sdwa vcc, 8, v75 src0_sel:DWORD src1_sel:BYTE_1
    s_cbranch_vccz Lck_25
    s_cmp_lt_u32 s82, 0x40000
    s_cbranch_scc1 Lck_25s
    s_branch Lck_25
Lck_26s:
    ds_read_b32 v75, v74
    s_add_u32 s82, s82, 1
    s_waitcnt lgkmcnt(0)
    v_cmp_gt_u32_sdwa vcc, 16, v75 src0_sel:DWORD src1_sel:BYTE_0
    s_cbranch_vccz Lck_26
    s_cmp_lt_u32 s82, 0x40000
    s_cbranch_scc1 Lck_26s
    s_branch Lck_26
Lck_27s:
    ds_read_b32 v75, v74
    s_add_u32 s82, s82, 1
    s_waitcnt lgkmcnt(0)
    v_cmp_gt_u32_sdwa vcc, 20, v75 src0_sel:DWORD src1_sel:BYTE_0
    s_cbranch_vccz Lck_27
    s_cmp_lt_u32 s82, 0x40000
    s_cbranch_scc1 Lck_27s
    s_branch Lck_27
Lck_28s:
    ds_read_b32 v75, v74
    s_add_u32 s82, s82, 1
    s_waitcnt lgkmcnt(0)
    v_cmp_gt_u32_sdwa vcc, 12, v75 src0_sel:DWORD src1_sel:BYTE_1
    s_cbranch_vccz Lck_28
    s_cmp_lt_u32 s82, 0x40000
    s_cbranch_scc1 Lck_28s
    s_branch Lck_28
Lck_38s:
    ds_read_b32 v75, v74
    s_add_u32 s82, s82, 1
    s_waitcnt lgkmcnt(0)
    v_cmp_gt_u32_sdwa vcc, 16, v75 src0_sel:DWORD src1_sel:BYTE_1
    s_cbranch_vccz Lck_38
    s_cmp_lt_u32 s82, 0x40000
    s_cbranch_scc1 Lck_38s
    s_branch Lck_38
L_kg:
    s_mov_b32 s64, s48
    s_mov_b32 s65, s49
    s_mov_b32 s66, 6291456
    s_mov_b32 s67, 0x20000
    s_mov_b32 s68, s44
    s_mov_b32 s69, s45
    s_mov_b32 s70, 5242880
    s_mov_b32 s71, 0x20000
    s_mov_b32 s72, s24
    s_mov_b32 s73, s25
    s_mov_b32 s74, 819200
    s_mov_b32 s75, 0x20000
    s_mov_b32 s76, s26
    s_mov_b32 s77, s27
    s_mov_b32 s78, 2621440
    s_mov_b32 s79, 0x20000
    s_lshl_b32 s51, s3, 10
    v_add_u32 v145, 5248, v8
    v_lshlrev_b32 v148, 3, v0
    v_add_u32 v148, 7296, v148
    v_and_b32 v60, 31, v0
    v_cmp_lt_u32 vcc, 20, v60
    v_lshrrev_b32 v62, 5, v0
    v_mul_u32_u24 v62, 0x150, v62
    v_lshl_add_u32 v61, v60, 4, v62
    v_add_u32 v151, 7808, v61
    v_mov_b32 v61, 0x30000
    v_cndmask_b32 v151, v151, v61, vcc
    v_add_u32 v146, 41984, v145
    v_add_u32 v147, 83968, v145
    v_add_u32 v149, 41984, v148
    v_add_u32 v150, 83968, v148
    v_add_u32 v152, 41984, v151
    v_add_u32 v153, 83968, v151
    v_mov_b32 v144, 0xdddddddd
    s_and_b32 s10, s3, 3
    s_lshl_b32 s12, s50, 1
    s_mul_i32 s11, s10, 655360
    s_add_u32 s11, s11, s12
    s_movk_i32 s12, 1280
    v_mov_b32 v1, s11
    v_mad_u32_u24 v155, v0, s12, v1
    s_lshl_b32 s11, s10, 9
    s_add_u32 s11, s11, 123840
    v_lshl_add_u32 v156, v0, 3, s11
    v_and_b32 v1, 48, v0
    v_and_b32 v2, 3, v0
    v_lshl_add_u32 v1, v2, 2, v1
    v_bfe_u32 v3, v0, 2, 2
    v_add_u32 v1, v1, v3
    v_lshl_add_u32 v157, v1, 3, s11
    s_lshl_b32 s11, s10, 10
    s_add_u32 s11, s11, 103904
    v_lshrrev_b32 v1, 2, v0
    v_lshl_add_u32 v1, v1, 3, s11
    s_movk_i32 s12, 4592
    v_mad_u32_u24 v158, v2, s12, v1
    s_mul_i32 s11, s10, 4592
    s_add_u32 s11, s11, 103424
    v_min_u32 v1, 59, v0
    v_lshl_add_u32 v159, v1, 3, s11
    v_add_u32 v249, 0, v159
    v_mov_b32 v4, 0
    v_mov_b32 v5, 0
    s_mul_i32 s11, s10, 8320
    s_add_u32 s11, s11, 125952
    v_and_b32 v10, 15, v0
    v_lshrrev_b32 v11, 4, v0
    v_sub_u32 v12, 0x7ef, v10
    v_lshrrev_b32 v12, 1, v12
    v_lshl_add_u32 v12, v11, 2, v12
    v_lshlrev_b32 v12, 2, v12
    v_and_b32 v13, 1, v0
    v_xor_b32 v13, 1, v13
    v_mul_u32_u24 v13, 4160, v13
    s_sub_u32 s12, s11, 960
    v_add3_u32 v240, v12, v13, s12
    v_subrev_u32 v241, 1024, v240
    v_subrev_u32 v242, 2048, v240
    v_subrev_u32 v243, 3072, v240
    v_lshlrev_b32 v12, 5, v10
    s_mul_i32 s12, s10, 4592
    s_add_u32 s12, s12, 103424
    v_lshl_add_u32 v13, v11, 4, v12
    v_add_u32 v244, s12, v13
    s_lshr_b32 s12, s10, 1
    s_lshl_b32 s12, s12, 6
    s_add_u32 s12, s12, s11
    v_lshl_add_u32 v13, v11, 3, v12
    v_add_u32 v245, s12, v13
    v_bfe_u32 v12, v0, 2, 2
    s_movk_i32 s12, 8320
    v_lshrrev_b32 v13, 1, v12
    v_lshlrev_b32 v13, 6, v13
    v_mad_u32_u24 v13, v12, s12, v13
    v_lshl_add_u32 v13, v11, 5, v13
    v_and_b32 v12, 3, v0
    v_lshl_add_u32 v13, v12, 3, v13
    s_lshl_b32 s12, s10, 7
    s_add_u32 s12, s12, 125952
    v_add_u32 v246, s12, v13
    s_mul_i32 s11, s10, 163840
    s_lshl_b32 s12, s50, 1
    s_add_u32 s11, s11, s12
    s_add_u32 s11, s11, 1280
    s_movk_i32 s12, 2560
    v_mov_b32 v247, s11
    v_mad_u32_u24 v247, v0, s12, v247
    v_sub_u32 v250, 1008, v8
    v_lshlrev_b32 v251, 3, v0
    v_sub_u32 v251, 1528, v251
    v_and_b32 v12, 1, v11
    v_mul_u32_u24 v12, 2112, v12
    v_lshl_add_u32 v252, v10, 2, v12
    v_lshlrev_b32 v248, 24, v0
    s_add_u32 s11, s50, s10
    s_lshr_b32 s12, s50, 3
    s_lshl_b32 s12, s12, 7
    s_add_u32 s99, s12, 204800
    s_mul_i32 s90, s11, 4224
    s_add_u32 s90, s90, 2883584
    s_and_b32 s12, s11, 7
    s_lshl3_add_u32 s91, s12, s99
    s_mov_b32 s98, 0
    s_mul_i32 s11, s10, 6144
    s_add_u32 s11, s11, 41984
    v_add_u32 v9, s11, v8
    s_lshr_b32 s11, s2, 3
    s_mul_i32 s11, s11, 81920
    s_and_b32 s12, s2, 7
    s_mul_i32 s12, s12, 160
    s_add_u32 s11, s11, s12
    s_mul_i32 s12, s10, 156
    s_add_u32 s11, s11, s12
    s_cmp_lt_u32 s10, 2
    s_cselect_b32 s11, s11, 0x80000000
    s_movk_i32 s12, 1280
    v_mov_b32 v154, s11
    v_mad_u32_u24 v154, v0, s12, v154
    s_mul_i32 s11, s10, 4352
    s_add_u32 m0, s11, 45056
    s_add_u32 s11, s11, 102400
    v_and_b32 v45, 15, v0
    v_lshrrev_b32 v46, 4, v0
    v_mul_u32_u24 v27, 0x110, v45
    v_lshl_add_u32 v27, v46, 4, v27
    v_add_u32 v27, s11, v27
    s_add_u32 s11, s11, 16
    v_max_u32 v47, 1, v46
    v_cmp_gt_u32 vcc, 2, v46
    v_add_u32 v47, -1, v47
    v_lshrrev_b32 v47, v47, 16
    v_cndmask_b32 v48, 8, 3, vcc
    v_cmp_eq_u32 vcc, 3, v46
    v_lshlrev_b32 v48, v48, v46
    v_mad_u32_u24 v128, v45, v47, v48
    v_add_u32 v128, s11, v128
    v_cndmask_b32 v48, 2, 64, vcc
    v_lshl_add_u32 v129, v48, 1, v128
    v_lshl_add_u32 v130, v47, 4, v128
    v_lshl_add_u32 v131, v47, 4, v129
    v_lshlrev_b32 v132, 6, v45
    v_lshl_add_u32 v132, v46, 3, v132
    v_add_u32 v132, s11, v132
    s_sub_u32 s12, s11, 4
    v_mov_b32 v133, s12
    s_add_u32 s12, s11, 508
    v_lshl_add_u32 v134, v0, 2, s12
    v_lshl_add_u32 v135, v0, 3, v133
    v_mov_b32 v136, 0x03020302
    v_cmp_eq_u32 vcc, 0, v0
    v_mov_b32 v53, 0x01000302
    s_mul_i32 s11, s10, 8320
    s_add_u32 s11, s11, 125952
    v_cndmask_b32 v136, v136, v53, vcc
    v_lshlrev_b32 v48, 5, v0
    s_add_u32 s12, s11, 2016
    v_sub_u32 v2, s12, v48
    s_add_u32 s12, s11, 3056
    v_sub_u32 v3, s12, v8
    v_lshlrev_b32 v50, 3, v0
    s_add_u32 s12, s11, 3576
    v_sub_u32 v6, s12, v50
    v_bfe_u32 v51, v0, 4, 1
    v_mul_u32_u24 v51, 0x1040, v51
    v_lshl_add_u32 v51, v45, 2, v51
    v_add_u32 v7, s11, v51
    s_mov_b32 s8, 0x3fb8aa3b
    s_mov_b32 s9, 0x32a57060
    v_mov_b32 v1, 0
    v_mov_b32 v26, 0x3f80
    s_barrier
    s_setprio 0
    s_waitcnt vmcnt(1)
    s_lshl_b32 s12, s50, 1
    s_load_dwordx2 s[92:93], s[42:43], s12
    v_mul_f32 v28, s8, v16
    v_fma_f32 v29, v16, s8, -v28
    v_fmac_f32 v29, s9, v16
    v_exp_f32 v28, v28
    v_mul_f32 v29, 0x3f317218, v29
    v_fma_f32 v28, v28, v29, v28
    v_cvt_pk_bf16_f32 v28, v28, v28
    v_lshlrev_b32 v28, 16, v28
    v_lshlrev_b32 v10, 16, v160
    v_lshlrev_b32 v11, 16, v161
    v_lshlrev_b32 v12, 16, v162
    v_lshlrev_b32 v13, 16, v163
    v_lshlrev_b32 v14, 16, v164
    v_lshlrev_b32 v15, 16, v165
    v_mul_f32 v10, v28, v10
    v_mul_f32 v11, v28, v11
    v_mul_f32 v12, v28, v12
    v_mul_f32 v13, v28, v13
    v_mul_f32 v10, s8, v10
    v_mul_f32 v11, 0.15915494, v11
    v_mul_f32 v40, 0x41000000, v10
    v_mul_f32 v41, 0x41000000, v11
    v_mul_f32 v44, 0x43800000, v10
    v_mul_f32 v45, 0x43800000, v11
    v_fract_f32 v49, v11
    v_fract_f32 v41, v41
    v_fract_f32 v45, v45
    v_exp_f32 v48, v10
    v_exp_f32 v40, v40
    v_exp_f32 v44, v44
    v_cos_f32 v42, v41
    v_sin_f32 v43, v41
    v_cos_f32 v46, v45
    v_sin_f32 v47, v45
    v_cos_f32 v50, v49
    v_sin_f32 v51, v49
    v_pk_mul_f32 v[20:21], v[14:15], v[12:13] op_sel:[0,0] op_sel_hi:[1,0]
    v_pk_fma_f32 v[20:21], v[14:15], v[12:13], v[20:21] op_sel:[1,1,0] op_sel_hi:[0,1,1] neg_lo:[0,1,0]
    v_mul_f32 v34, v42, v40
    v_mul_f32 v35, v43, v40
    v_mul_f32 v22, v46, v44
    v_mul_f32 v23, v47, v44
    v_mul_f32 v24, v50, v48
    v_mul_f32 v25, v51, v48
    v_xor_b32 v21, 0x80000000, v21
    v_pk_mul_f32 v[36:37], v[34:35], v[34:35] op_sel:[0,0] op_sel_hi:[1,0]
    v_pk_fma_f32 v[36:37], v[34:35], v[34:35], v[36:37] op_sel:[1,1,0] op_sel_hi:[0,1,1] neg_lo:[0,1,0]
    v_pk_mul_f32 v[38:39], v[36:37], v[34:35] op_sel:[0,0] op_sel_hi:[1,0]
    v_pk_mul_f32 v[40:41], v[36:37], v[36:37] op_sel:[0,0] op_sel_hi:[1,0]
    v_pk_fma_f32 v[38:39], v[36:37], v[34:35], v[38:39] op_sel:[1,1,0] op_sel_hi:[0,1,1] neg_lo:[0,1,0]
    v_pk_fma_f32 v[40:41], v[36:37], v[36:37], v[40:41] op_sel:[1,1,0] op_sel_hi:[0,1,1] neg_lo:[0,1,0]
    v_cvt_pk_bf16_f32 v72, v34, v35
    v_cvt_pk_bf16_f32 v73, v36, v37
    v_cvt_pk_bf16_f32 v74, v38, v39
    v_cvt_pk_bf16_f32 v75, v40, v41
    ds_write_addtid_b32 v26 offset:57344
    ds_write_addtid_b32 v72 offset:57616
    ds_write_addtid_b32 v73 offset:57888
    ds_write_addtid_b32 v74 offset:58160
    ds_write_addtid_b32 v75 offset:58432
    v_pk_mul_f32 v[42:43], v[40:41], v[34:35] op_sel:[0,0] op_sel_hi:[1,0]
    v_pk_mul_f32 v[44:45], v[40:41], v[36:37] op_sel:[0,0] op_sel_hi:[1,0]
    v_pk_mul_f32 v[46:47], v[40:41], v[38:39] op_sel:[0,0] op_sel_hi:[1,0]
    v_pk_mul_f32 v[48:49], v[40:41], v[40:41] op_sel:[0,0] op_sel_hi:[1,0]
    v_pk_fma_f32 v[42:43], v[40:41], v[34:35], v[42:43] op_sel:[1,1,0] op_sel_hi:[0,1,1] neg_lo:[0,1,0]
    v_pk_fma_f32 v[44:45], v[40:41], v[36:37], v[44:45] op_sel:[1,1,0] op_sel_hi:[0,1,1] neg_lo:[0,1,0]
    v_pk_fma_f32 v[46:47], v[40:41], v[38:39], v[46:47] op_sel:[1,1,0] op_sel_hi:[0,1,1] neg_lo:[0,1,0]
    v_pk_fma_f32 v[48:49], v[40:41], v[40:41], v[48:49] op_sel:[1,1,0] op_sel_hi:[0,1,1] neg_lo:[0,1,0]
    v_cvt_pk_bf16_f32 v76, v42, v43
    v_cvt_pk_bf16_f32 v77, v44, v45
    v_cvt_pk_bf16_f32 v78, v46, v47
    v_cvt_pk_bf16_f32 v79, v48, v49
    ds_write_addtid_b32 v76 offset:58704
    ds_write_addtid_b32 v77 offset:58976
    ds_write_addtid_b32 v78 offset:59248
    ds_write_addtid_b32 v79 offset:59520
    v_pk_mul_f32 v[50:51], v[48:49], v[34:35] op_sel:[0,0] op_sel_hi:[1,0]
    v_pk_mul_f32 v[52:53], v[48:49], v[36:37] op_sel:[0,0] op_sel_hi:[1,0]
    v_pk_mul_f32 v[54:55], v[48:49], v[38:39] op_sel:[0,0] op_sel_hi:[1,0]
    v_pk_mul_f32 v[56:57], v[48:49], v[40:41] op_sel:[0,0] op_sel_hi:[1,0]
    v_pk_fma_f32 v[50:51], v[48:49], v[34:35], v[50:51] op_sel:[1,1,0] op_sel_hi:[0,1,1] neg_lo:[0,1,0]
    v_pk_fma_f32 v[52:53], v[48:49], v[36:37], v[52:53] op_sel:[1,1,0] op_sel_hi:[0,1,1] neg_lo:[0,1,0]
    v_pk_fma_f32 v[54:55], v[48:49], v[38:39], v[54:55] op_sel:[1,1,0] op_sel_hi:[0,1,1] neg_lo:[0,1,0]
    v_pk_fma_f32 v[56:57], v[48:49], v[40:41], v[56:57] op_sel:[1,1,0] op_sel_hi:[0,1,1] neg_lo:[0,1,0]
    v_cvt_pk_bf16_f32 v72, v50, v51
    v_cvt_pk_bf16_f32 v73, v52, v53
    v_cvt_pk_bf16_f32 v74, v54, v55
    v_cvt_pk_bf16_f32 v75, v56, v57
    ds_write_addtid_b32 v72 offset:59792
    ds_write_addtid_b32 v73 offset:60064
    ds_write_addtid_b32 v74 offset:60336
    ds_write_addtid_b32 v75 offset:60608
    v_pk_mul_f32 v[58:59], v[48:49], v[42:43] op_sel:[0,0] op_sel_hi:[1,0]
    v_pk_mul_f32 v[60:61], v[48:49], v[44:45] op_sel:[0,0] op_sel_hi:[1,0]
    v_pk_mul_f32 v[62:63], v[48:49], v[46:47] op_sel:[0,0] op_sel_hi:[1,0]
    v_pk_mul_f32 v[30:31], v[48:49], v[48:49] op_sel:[0,0] op_sel_hi:[1,0]
    v_pk_fma_f32 v[58:59], v[48:49], v[42:43], v[58:59] op_sel:[1,1,0] op_sel_hi:[0,1,1] neg_lo:[0,1,0]
    v_pk_fma_f32 v[60:61], v[48:49], v[44:45], v[60:61] op_sel:[1,1,0] op_sel_hi:[0,1,1] neg_lo:[0,1,0]
    v_pk_fma_f32 v[62:63], v[48:49], v[46:47], v[62:63] op_sel:[1,1,0] op_sel_hi:[0,1,1] neg_lo:[0,1,0]
    v_pk_fma_f32 v[30:31], v[48:49], v[48:49], v[30:31] op_sel:[1,1,0] op_sel_hi:[0,1,1] neg_lo:[0,1,0]
    v_cvt_pk_bf16_f32 v76, v58, v59
    v_cvt_pk_bf16_f32 v77, v60, v61
    v_cvt_pk_bf16_f32 v78, v62, v63
    ds_write_addtid_b32 v76 offset:60880
    ds_write_addtid_b32 v77 offset:61152
    ds_write_addtid_b32 v78 offset:61424
    ds_read_b128 v[176:179], v27 offset:0
    ds_read_b128 v[180:183], v27 offset:64
    ds_read_b128 v[184:187], v27 offset:128
    ds_read_b128 v[188:191], v27 offset:192
    v_pk_mul_f32 v[66:67], v[34:35], v[30:31] op_sel:[0,0] op_sel_hi:[1,0]
    v_pk_mul_f32 v[68:69], v[36:37], v[30:31] op_sel:[0,0] op_sel_hi:[1,0]
    v_pk_mul_f32 v[70:71], v[38:39], v[30:31] op_sel:[0,0] op_sel_hi:[1,0]
    v_pk_fma_f32 v[66:67], v[34:35], v[30:31], v[66:67] op_sel:[1,1,0] op_sel_hi:[0,1,1] neg_lo:[0,1,0]
    v_pk_fma_f32 v[68:69], v[36:37], v[30:31], v[68:69] op_sel:[1,1,0] op_sel_hi:[0,1,1] neg_lo:[0,1,0]
    v_pk_fma_f32 v[70:71], v[38:39], v[30:31], v[70:71] op_sel:[1,1,0] op_sel_hi:[0,1,1] neg_lo:[0,1,0]
    v_cvt_pk_bf16_f32 v79, v30, v31
    v_cvt_pk_bf16_f32 v72, v66, v67
    v_cvt_pk_bf16_f32 v73, v68, v69
    v_cvt_pk_bf16_f32 v74, v70, v71
    ds_write_addtid_b32 v79 offset:57344
    ds_write_addtid_b32 v72 offset:57616
    ds_write_addtid_b32 v73 offset:57888
    ds_write_addtid_b32 v74 offset:58160
    v_pk_mul_f32 v[64:65], v[40:41], v[30:31] op_sel:[0,0] op_sel_hi:[1,0]
    v_pk_mul_f32 v[66:67], v[42:43], v[30:31] op_sel:[0,0] op_sel_hi:[1,0]
    v_pk_mul_f32 v[68:69], v[44:45], v[30:31] op_sel:[0,0] op_sel_hi:[1,0]
    v_pk_mul_f32 v[70:71], v[46:47], v[30:31] op_sel:[0,0] op_sel_hi:[1,0]
    v_pk_fma_f32 v[64:65], v[40:41], v[30:31], v[64:65] op_sel:[1,1,0] op_sel_hi:[0,1,1] neg_lo:[0,1,0]
    v_pk_fma_f32 v[66:67], v[42:43], v[30:31], v[66:67] op_sel:[1,1,0] op_sel_hi:[0,1,1] neg_lo:[0,1,0]
    v_pk_fma_f32 v[68:69], v[44:45], v[30:31], v[68:69] op_sel:[1,1,0] op_sel_hi:[0,1,1] neg_lo:[0,1,0]
    v_pk_fma_f32 v[70:71], v[46:47], v[30:31], v[70:71] op_sel:[1,1,0] op_sel_hi:[0,1,1] neg_lo:[0,1,0]
    v_cvt_pk_bf16_f32 v75, v64, v65
    v_cvt_pk_bf16_f32 v76, v66, v67
    v_cvt_pk_bf16_f32 v77, v68, v69
    v_cvt_pk_bf16_f32 v78, v70, v71
    ds_write_addtid_b32 v75 offset:58432
    ds_write_addtid_b32 v76 offset:58704
    ds_write_addtid_b32 v77 offset:58976
    ds_write_addtid_b32 v78 offset:59248
    v_pk_mul_f32 v[64:65], v[48:49], v[30:31] op_sel:[0,0] op_sel_hi:[1,0]
    v_pk_mul_f32 v[66:67], v[50:51], v[30:31] op_sel:[0,0] op_sel_hi:[1,0]
    v_pk_mul_f32 v[68:69], v[52:53], v[30:31] op_sel:[0,0] op_sel_hi:[1,0]
    v_pk_mul_f32 v[70:71], v[54:55], v[30:31] op_sel:[0,0] op_sel_hi:[1,0]
    v_pk_fma_f32 v[64:65], v[48:49], v[30:31], v[64:65] op_sel:[1,1,0] op_sel_hi:[0,1,1] neg_lo:[0,1,0]
    v_pk_fma_f32 v[66:67], v[50:51], v[30:31], v[66:67] op_sel:[1,1,0] op_sel_hi:[0,1,1] neg_lo:[0,1,0]
    v_pk_fma_f32 v[68:69], v[52:53], v[30:31], v[68:69] op_sel:[1,1,0] op_sel_hi:[0,1,1] neg_lo:[0,1,0]
    v_pk_fma_f32 v[70:71], v[54:55], v[30:31], v[70:71] op_sel:[1,1,0] op_sel_hi:[0,1,1] neg_lo:[0,1,0]
    v_cvt_pk_bf16_f32 v79, v64, v65
    v_cvt_pk_bf16_f32 v72, v66, v67
    v_cvt_pk_bf16_f32 v73, v68, v69
    v_cvt_pk_bf16_f32 v74, v70, v71
    ds_write_addtid_b32 v79 offset:59520
    ds_write_addtid_b32 v72 offset:59792
    ds_write_addtid_b32 v73 offset:60064
    ds_write_addtid_b32 v74 offset:60336
    v_pk_mul_f32 v[64:65], v[56:57], v[30:31] op_sel:[0,0] op_sel_hi:[1,0]
    v_pk_mul_f32 v[66:67], v[58:59], v[30:31] op_sel:[0,0] op_sel_hi:[1,0]
    v_pk_mul_f32 v[68:69], v[60:61], v[30:31] op_sel:[0,0] op_sel_hi:[1,0]
    v_pk_mul_f32 v[70:71], v[62:63], v[30:31] op_sel:[0,0] op_sel_hi:[1,0]
    v_pk_fma_f32 v[64:65], v[56:57], v[30:31], v[64:65] op_sel:[1,1,0] op_sel_hi:[0,1,1] neg_lo:[0,1,0]
    v_pk_fma_f32 v[66:67], v[58:59], v[30:31], v[66:67] op_sel:[1,1,0] op_sel_hi:[0,1,1] neg_lo:[0,1,0]
    v_pk_fma_f32 v[68:69], v[60:61], v[30:31], v[68:69] op_sel:[1,1,0] op_sel_hi:[0,1,1] neg_lo:[0,1,0]
    v_pk_fma_f32 v[70:71], v[62:63], v[30:31], v[70:71] op_sel:[1,1,0] op_sel_hi:[0,1,1] neg_lo:[0,1,0]
    v_cvt_pk_bf16_f32 v75, v64, v65
    v_cvt_pk_bf16_f32 v76, v66, v67
    v_cvt_pk_bf16_f32 v77, v68, v69
    v_cvt_pk_bf16_f32 v78, v70, v71
    ds_write_addtid_b32 v75 offset:60608
    ds_write_addtid_b32 v76 offset:60880
    ds_write_addtid_b32 v77 offset:61152
    ds_write_addtid_b32 v78 offset:61424
    ds_read_b128 v[192:195], v27 offset:0
    ds_read_b128 v[196:199], v27 offset:64
    ds_read_b128 v[200:203], v27 offset:128
    ds_read_b128 v[204:207], v27 offset:192
    v_pk_mul_f32 v[80:81], v[20:21], v[24:25] op_sel:[0,0] op_sel_hi:[1,0]
    v_pk_fma_f32 v[80:81], v[20:21], v[24:25], v[80:81] op_sel:[1,1,0] op_sel_hi:[0,1,1] neg_hi:[0,1,0]
    v_pk_mul_f32 v[82:83], v[80:81], v[24:25] op_sel:[0,0] op_sel_hi:[1,0]
    v_pk_fma_f32 v[82:83], v[80:81], v[24:25], v[82:83] op_sel:[1,1,0] op_sel_hi:[0,1,1] neg_hi:[0,1,0]
    v_pk_mul_f32 v[84:85], v[82:83], v[24:25] op_sel:[0,0] op_sel_hi:[1,0]
    v_pk_fma_f32 v[84:85], v[82:83], v[24:25], v[84:85] op_sel:[1,1,0] op_sel_hi:[0,1,1] neg_hi:[0,1,0]
    v_pk_mul_f32 v[86:87], v[84:85], v[24:25] op_sel:[0,0] op_sel_hi:[1,0]
    v_pk_fma_f32 v[86:87], v[84:85], v[24:25], v[86:87] op_sel:[1,1,0] op_sel_hi:[0,1,1] neg_hi:[0,1,0]
    v_cvt_pk_bf16_f32 v79, v80, v81
    v_cvt_pk_bf16_f32 v72, v82, v83
    v_cvt_pk_bf16_f32 v73, v84, v85
    v_cvt_pk_bf16_f32 v74, v86, v87
    ds_write_addtid_b32 v79 offset:57344
    ds_write_addtid_b32 v72 offset:57616
    ds_write_addtid_b32 v73 offset:57888
    ds_write_addtid_b32 v74 offset:58160
    v_pk_mul_f32 v[88:89], v[86:87], v[24:25] op_sel:[0,0] op_sel_hi:[1,0]
    v_pk_fma_f32 v[88:89], v[86:87], v[24:25], v[88:89] op_sel:[1,1,0] op_sel_hi:[0,1,1] neg_hi:[0,1,0]
    v_pk_mul_f32 v[90:91], v[88:89], v[24:25] op_sel:[0,0] op_sel_hi:[1,0]
    v_pk_fma_f32 v[90:91], v[88:89], v[24:25], v[90:91] op_sel:[1,1,0] op_sel_hi:[0,1,1] neg_hi:[0,1,0]
    v_pk_mul_f32 v[92:93], v[90:91], v[24:25] op_sel:[0,0] op_sel_hi:[1,0]
    v_pk_fma_f32 v[92:93], v[90:91], v[24:25], v[92:93] op_sel:[1,1,0] op_sel_hi:[0,1,1] neg_hi:[0,1,0]
    v_pk_mul_f32 v[94:95], v[92:93], v[24:25] op_sel:[0,0] op_sel_hi:[1,0]
    v_pk_fma_f32 v[94:95], v[92:93], v[24:25], v[94:95] op_sel:[1,1,0] op_sel_hi:[0,1,1] neg_hi:[0,1,0]
    v_cvt_pk_bf16_f32 v75, v88, v89
    v_cvt_pk_bf16_f32 v76, v90, v91
    v_cvt_pk_bf16_f32 v77, v92, v93
    v_cvt_pk_bf16_f32 v78, v94, v95
    ds_write_addtid_b32 v75 offset:58432
    ds_write_addtid_b32 v76 offset:58704
    ds_write_addtid_b32 v77 offset:58976
    ds_write_addtid_b32 v78 offset:59248
    v_pk_mul_f32 v[96:97], v[82:83], v[22:23] op_sel:[0,0] op_sel_hi:[1,0]
    v_pk_mul_f32 v[98:99], v[86:87], v[22:23] op_sel:[0,0] op_sel_hi:[1,0]
    v_pk_mul_f32 v[100:101], v[90:91], v[22:23] op_sel:[0,0] op_sel_hi:[1,0]
    v_pk_mul_f32 v[102:103], v[94:95], v[22:23] op_sel:[0,0] op_sel_hi:[1,0]
    v_pk_fma_f32 v[96:97], v[82:83], v[22:23], v[96:97] op_sel:[1,1,0] op_sel_hi:[0,1,1] neg_hi:[0,1,0]
    v_pk_fma_f32 v[98:99], v[86:87], v[22:23], v[98:99] op_sel:[1,1,0] op_sel_hi:[0,1,1] neg_hi:[0,1,0]
    v_pk_fma_f32 v[100:101], v[90:91], v[22:23], v[100:101] op_sel:[1,1,0] op_sel_hi:[0,1,1] neg_hi:[0,1,0]
    v_pk_fma_f32 v[102:103], v[94:95], v[22:23], v[102:103] op_sel:[1,1,0] op_sel_hi:[0,1,1] neg_hi:[0,1,0]
    v_cvt_pk_bf16_f32 v79, v96, v97
    v_cvt_pk_bf16_f32 v72, v98, v99
    v_cvt_pk_bf16_f32 v73, v100, v101
    v_cvt_pk_bf16_f32 v74, v102, v103
    ds_write_addtid_b32 v79 offset:59520
    ds_write_addtid_b32 v72 offset:59792
    ds_write_addtid_b32 v73 offset:60064
    ds_write_addtid_b32 v74 offset:60336
    v_pk_mul_f32 v[104:105], v[98:99], v[22:23] op_sel:[0,0] op_sel_hi:[1,0]
    v_pk_mul_f32 v[106:107], v[102:103], v[22:23] op_sel:[0,0] op_sel_hi:[1,0]
    v_pk_fma_f32 v[104:105], v[98:99], v[22:23], v[104:105] op_sel:[1,1,0] op_sel_hi:[0,1,1] neg_hi:[0,1,0]
    v_pk_fma_f32 v[106:107], v[102:103], v[22:23], v[106:107] op_sel:[1,1,0] op_sel_hi:[0,1,1] neg_hi:[0,1,0]
    v_pk_mul_f32 v[108:109], v[104:105], v[22:23] op_sel:[0,0] op_sel_hi:[1,0]
    v_pk_mul_f32 v[110:111], v[106:107], v[22:23] op_sel:[0,0] op_sel_hi:[1,0]
    v_pk_fma_f32 v[108:109], v[104:105], v[22:23], v[108:109] op_sel:[1,1,0] op_sel_hi:[0,1,1] neg_hi:[0,1,0]
    v_pk_fma_f32 v[110:111], v[106:107], v[22:23], v[110:111] op_sel:[1,1,0] op_sel_hi:[0,1,1] neg_hi:[0,1,0]
    v_cvt_pk_bf16_f32 v75, v104, v105
    v_cvt_pk_bf16_f32 v76, v106, v107
    v_cvt_pk_bf16_f32 v77, v108, v109
    v_cvt_pk_bf16_f32 v78, v110, v111
    ds_write_addtid_b32 v75 offset:60608
    ds_write_addtid_b32 v76 offset:60880
    ds_write_addtid_b32 v77 offset:61152
    ds_write_addtid_b32 v78 offset:61424
    ds_read_b128 v[208:211], v27 offset:0
    ds_read_b128 v[212:215], v27 offset:64
    ds_read_b128 v[216:219], v27 offset:128
    ds_read_b128 v[220:223], v27 offset:192
    v_pk_mul_f32 v[64:65], v[110:111], v[22:23] op_sel:[0,0] op_sel_hi:[1,0]
    v_pk_fma_f32 v[64:65], v[110:111], v[22:23], v[64:65] op_sel:[1,1,0] op_sel_hi:[0,1,1] neg_hi:[0,1,0]
    v_pk_mul_f32 v[66:67], v[64:65], v[22:23] op_sel:[0,0] op_sel_hi:[1,0]
    v_pk_fma_f32 v[66:67], v[64:65], v[22:23], v[66:67] op_sel:[1,1,0] op_sel_hi:[0,1,1] neg_hi:[0,1,0]
    v_pk_mul_f32 v[68:69], v[66:67], v[22:23] op_sel:[0,0] op_sel_hi:[1,0]
    v_pk_fma_f32 v[68:69], v[66:67], v[22:23], v[68:69] op_sel:[1,1,0] op_sel_hi:[0,1,1] neg_hi:[0,1,0]
    v_pk_mul_f32 v[70:71], v[68:69], v[22:23] op_sel:[0,0] op_sel_hi:[1,0]
    v_pk_fma_f32 v[70:71], v[68:69], v[22:23], v[70:71] op_sel:[1,1,0] op_sel_hi:[0,1,1] neg_hi:[0,1,0]
    v_cvt_pk_bf16_f32 v79, v64, v65
    v_cvt_pk_bf16_f32 v72, v66, v67
    v_cvt_pk_bf16_f32 v73, v68, v69
    v_cvt_pk_bf16_f32 v74, v70, v71
    v_cvt_pk_bf16_f32 v75, v20, v21
    ds_write_addtid_b32 v79 offset:57344
    ds_write_addtid_b32 v72 offset:57616
    ds_write_addtid_b32 v73 offset:57888
    ds_write_addtid_b32 v74 offset:58160
    ds_write_addtid_b32 v75 offset:58432
    ds_read_b128 v[224:227], v27 offset:0
    ds_read_b128 v[228:231], v27 offset:64
    ds_read_b128 v[232:235], v27 offset:128
    ds_read_b128 v[236:239], v27 offset:192
    v_and_b32 v10, 0xffff0000, v160
    v_and_b32 v11, 0xffff0000, v161
    v_and_b32 v12, 0xffff0000, v162
    v_and_b32 v13, 0xffff0000, v163
    s_waitcnt lgkmcnt(9)
    v_mfma_f32_16x16x32_bf16 v[112:115], v[208:211], v[176:179], 0
    v_and_b32 v14, 0xffff0000, v164
    v_and_b32 v15, 0xffff0000, v165
    v_mfma_f32_16x16x32_bf16 v[112:115], v[212:215], v[180:183], v[112:115]
    v_mul_f32 v10, v28, v10
    v_mul_f32 v11, v28, v11
    v_mfma_f32_16x16x32_bf16 v[112:115], v[216:219], v[184:187], v[112:115]
    v_mul_f32 v12, v28, v12
    v_mul_f32 v13, v28, v13
    v_mfma_f32_16x16x32_bf16 v[112:115], v[220:223], v[188:191], v[112:115]
    v_mul_f32 v10, s8, v10
    v_mul_f32 v11, 0.15915494, v11
    v_mfma_f32_16x16x32_bf16 v[116:119], v[208:211], v[192:195], 0
    v_mul_f32 v40, 0x41000000, v10
    v_mul_f32 v41, 0x41000000, v11
    v_mfma_f32_16x16x32_bf16 v[116:119], v[212:215], v[196:199], v[116:119]
    v_mul_f32 v44, 0x43800000, v10
    v_mul_f32 v45, 0x43800000, v11
    v_mfma_f32_16x16x32_bf16 v[116:119], v[216:219], v[200:203], v[116:119]
    v_fract_f32 v49, v11
    v_fract_f32 v41, v41
    s_waitcnt lgkmcnt(0)
    v_mfma_f32_16x16x32_bf16 v[116:119], v[220:223], v[204:207], v[116:119]
    v_fract_f32 v45, v45
    v_mfma_f32_16x16x32_bf16 v[120:123], v[176:179], v[224:227], 0
    v_exp_f32 v48, v10
    v_mfma_f32_16x16x32_bf16 v[120:123], v[180:183], v[228:231], v[120:123]
    v_exp_f32 v40, v40
    v_mfma_f32_16x16x32_bf16 v[120:123], v[184:187], v[232:235], v[120:123]
    v_exp_f32 v44, v44
    v_mfma_f32_16x16x32_bf16 v[120:123], v[188:191], v[236:239], v[120:123]
    v_cos_f32 v42, v41
    v_mfma_f32_16x16x32_bf16 v[124:127], v[192:195], v[224:227], 0
    v_sin_f32 v43, v41
    v_mfma_f32_16x16x32_bf16 v[124:127], v[196:199], v[228:231], v[124:127]
    v_cos_f32 v46, v45
    v_mfma_f32_16x16x32_bf16 v[124:127], v[200:203], v[232:235], v[124:127]
    v_sin_f32 v47, v45
    v_mfma_f32_16x16x32_bf16 v[124:127], v[204:207], v[236:239], v[124:127]
    v_cos_f32 v50, v49
    v_sin_f32 v51, v49
    v_pk_mul_f32 v[20:21], v[14:15], v[12:13] op_sel:[0,0] op_sel_hi:[1,0]
    v_pk_fma_f32 v[20:21], v[14:15], v[12:13], v[20:21] op_sel:[1,1,0] op_sel_hi:[0,1,1] neg_lo:[0,1,0]
    v_mul_f32 v34, v42, v40
    v_mul_f32 v35, v43, v40
    v_mul_f32 v22, v46, v44
    v_mul_f32 v23, v47, v44
    v_mul_f32 v24, v50, v48
    v_mul_f32 v25, v51, v48
    v_xor_b32 v21, 0x80000000, v21
    v_pk_mul_f32 v[36:37], v[34:35], v[34:35] op_sel:[0,0] op_sel_hi:[1,0]
    v_pk_fma_f32 v[36:37], v[34:35], v[34:35], v[36:37] op_sel:[1,1,0] op_sel_hi:[0,1,1] neg_lo:[0,1,0]
    v_pk_mul_f32 v[38:39], v[36:37], v[34:35] op_sel:[0,0] op_sel_hi:[1,0]
    v_pk_mul_f32 v[40:41], v[36:37], v[36:37] op_sel:[0,0] op_sel_hi:[1,0]
    v_pk_fma_f32 v[38:39], v[36:37], v[34:35], v[38:39] op_sel:[1,1,0] op_sel_hi:[0,1,1] neg_lo:[0,1,0]
    v_pk_fma_f32 v[40:41], v[36:37], v[36:37], v[40:41] op_sel:[1,1,0] op_sel_hi:[0,1,1] neg_lo:[0,1,0]
    v_cvt_pk_bf16_f32 v76, v34, v35
    v_cvt_pk_bf16_f32 v77, v36, v37
    v_cvt_pk_bf16_f32 v78, v38, v39
    v_cvt_pk_bf16_f32 v79, v40, v41
    ds_write_addtid_b32 v26 offset:57344
    ds_write_addtid_b32 v76 offset:57616
    ds_write_addtid_b32 v77 offset:57888
    ds_write_addtid_b32 v78 offset:58160
    ds_write_addtid_b32 v79 offset:58432
    v_pk_mul_f32 v[42:43], v[40:41], v[34:35] op_sel:[0,0] op_sel_hi:[1,0]
    v_pk_mul_f32 v[44:45], v[40:41], v[36:37] op_sel:[0,0] op_sel_hi:[1,0]
    v_pk_mul_f32 v[46:47], v[40:41], v[38:39] op_sel:[0,0] op_sel_hi:[1,0]
    v_pk_mul_f32 v[48:49], v[40:41], v[40:41] op_sel:[0,0] op_sel_hi:[1,0]
    v_pk_fma_f32 v[42:43], v[40:41], v[34:35], v[42:43] op_sel:[1,1,0] op_sel_hi:[0,1,1] neg_lo:[0,1,0]
    v_pk_fma_f32 v[44:45], v[40:41], v[36:37], v[44:45] op_sel:[1,1,0] op_sel_hi:[0,1,1] neg_lo:[0,1,0]
    v_pk_fma_f32 v[46:47], v[40:41], v[38:39], v[46:47] op_sel:[1,1,0] op_sel_hi:[0,1,1] neg_lo:[0,1,0]
    v_pk_fma_f32 v[48:49], v[40:41], v[40:41], v[48:49] op_sel:[1,1,0] op_sel_hi:[0,1,1] neg_lo:[0,1,0]
    v_cvt_pk_bf16_f32 v72, v42, v43
    v_cvt_pk_bf16_f32 v73, v44, v45
    v_cvt_pk_bf16_f32 v74, v46, v47
    v_cvt_pk_bf16_f32 v75, v48, v49
    ds_write_addtid_b32 v72 offset:58704
    ds_write_addtid_b32 v73 offset:58976
    ds_write_addtid_b32 v74 offset:59248
    ds_write_addtid_b32 v75 offset:59520
    v_pk_mul_f32 v[50:51], v[48:49], v[34:35] op_sel:[0,0] op_sel_hi:[1,0]
    v_mul_f32 v52, v48, v36
    v_mul_f32 v53, v49, v36
    v_mul_f32 v54, v48, v38
    v_mul_f32 v55, v49, v38
    v_mul_f32 v56, v48, v40
    v_mul_f32 v57, v49, v40
    v_pk_fma_f32 v[50:51], v[48:49], v[34:35], v[50:51] op_sel:[1,1,0] op_sel_hi:[0,1,1] neg_lo:[0,1,0]
    v_fma_f32 v52, -v49, v37, v52
    v_fmac_f32 v53, v48, v37
    v_fma_f32 v54, -v49, v39, v54
    v_fmac_f32 v55, v48, v39
    v_fma_f32 v56, -v49, v41, v56
    v_fmac_f32 v57, v48, v41
    v_cvt_pk_bf16_f32 v76, v50, v51
    v_cvt_pk_bf16_f32 v77, v52, v53
    v_cvt_pk_bf16_f32 v78, v54, v55
    v_cvt_pk_bf16_f32 v79, v56, v57
    ds_write_addtid_b32 v76 offset:59792
    ds_write_addtid_b32 v77 offset:60064
    ds_write_addtid_b32 v78 offset:60336
    ds_write_addtid_b32 v79 offset:60608
    v_mul_f32 v58, v48, v42
    v_mul_f32 v59, v49, v42
    v_mul_f32 v60, v48, v44
    v_mul_f32 v61, v49, v44
    v_mul_f32 v62, v48, v46
    v_mul_f32 v63, v49, v46
    v_mul_f32 v30, v48, v48
    v_mul_f32 v31, v49, v48
    v_fma_f32 v58, -v49, v43, v58
    v_fmac_f32 v59, v48, v43
    v_fma_f32 v60, -v49, v45, v60
    v_fmac_f32 v61, v48, v45
    v_fma_f32 v62, -v49, v47, v62
    v_fmac_f32 v63, v48, v47
    v_fma_f32 v30, -v49, v49, v30
    v_fmac_f32 v31, v48, v49
    v_cvt_pk_bf16_f32 v72, v58, v59
    v_cvt_pk_bf16_f32 v73, v60, v61
    v_cvt_pk_bf16_f32 v74, v62, v63
    ds_write_addtid_b32 v72 offset:60880
    ds_write_addtid_b32 v73 offset:61152
    ds_write_addtid_b32 v74 offset:61424
    ds_read_b128 v[176:179], v27 offset:0
    ds_read_b128 v[180:183], v27 offset:64
    ds_read_b128 v[184:187], v27 offset:128
    ds_read_b128 v[188:191], v27 offset:192
    v_mul_f32 v66, v34, v30
    v_mul_f32 v67, v35, v30
    v_mul_f32 v68, v36, v30
    v_mul_f32 v69, v37, v30
    v_mul_f32 v70, v38, v30
    v_mul_f32 v71, v39, v30
    v_fma_f32 v66, -v35, v31, v66
    v_fmac_f32 v67, v34, v31
    v_fma_f32 v68, -v37, v31, v68
    v_fmac_f32 v69, v36, v31
    v_fma_f32 v70, -v39, v31, v70
    v_fmac_f32 v71, v38, v31
    v_cvt_pk_bf16_f32 v75, v30, v31
    v_cvt_pk_bf16_f32 v76, v66, v67
    v_cvt_pk_bf16_f32 v77, v68, v69
    v_cvt_pk_bf16_f32 v78, v70, v71
    ds_write_addtid_b32 v75 offset:57344
    ds_write_addtid_b32 v76 offset:57616
    ds_write_addtid_b32 v77 offset:57888
    ds_write_addtid_b32 v78 offset:58160
    v_mul_f32 v64, v40, v30
    v_mul_f32 v65, v41, v30
    v_mul_f32 v66, v42, v30
    v_mul_f32 v67, v43, v30
    v_mul_f32 v68, v44, v30
    v_mul_f32 v69, v45, v30
    v_mul_f32 v70, v46, v30
    v_mul_f32 v71, v47, v30
    v_fma_f32 v64, -v41, v31, v64
    v_fmac_f32 v65, v40, v31
    v_fma_f32 v66, -v43, v31, v66
    v_fmac_f32 v67, v42, v31
    v_fma_f32 v68, -v45, v31, v68
    v_fmac_f32 v69, v44, v31
    v_fma_f32 v70, -v47, v31, v70
    v_fmac_f32 v71, v46, v31
    v_cvt_pk_bf16_f32 v79, v64, v65
    v_cvt_pk_bf16_f32 v72, v66, v67
    v_cvt_pk_bf16_f32 v73, v68, v69
    v_cvt_pk_bf16_f32 v74, v70, v71
    ds_write_addtid_b32 v79 offset:58432
    ds_write_addtid_b32 v72 offset:58704
    ds_write_addtid_b32 v73 offset:58976
    ds_write_addtid_b32 v74 offset:59248
    v_mul_f32 v64, v48, v30
    v_mul_f32 v65, v49, v30
    v_mul_f32 v66, v50, v30
    v_mul_f32 v67, v51, v30
    v_mul_f32 v68, v52, v30
    v_mul_f32 v69, v53, v30
    v_mul_f32 v70, v54, v30
    v_mul_f32 v71, v55, v30
    v_fma_f32 v64, -v49, v31, v64
    v_fmac_f32 v65, v48, v31
    v_fma_f32 v66, -v51, v31, v66
    v_fmac_f32 v67, v50, v31
    v_fma_f32 v68, -v53, v31, v68
    v_fmac_f32 v69, v52, v31
    v_fma_f32 v70, -v55, v31, v70
    v_fmac_f32 v71, v54, v31
    v_cvt_pk_bf16_f32 v75, v64, v65
    v_cvt_pk_bf16_f32 v76, v66, v67
    v_cvt_pk_bf16_f32 v77, v68, v69
    v_cvt_pk_bf16_f32 v78, v70, v71
    ds_write_addtid_b32 v75 offset:59520
    ds_write_addtid_b32 v76 offset:59792
    ds_write_addtid_b32 v77 offset:60064
    ds_write_addtid_b32 v78 offset:60336
    v_mul_f32 v64, v56, v30
    v_mul_f32 v65, v57, v30
    v_mul_f32 v66, v58, v30
    v_mul_f32 v67, v59, v30
    v_mul_f32 v68, v60, v30
    v_mul_f32 v69, v61, v30
    v_mul_f32 v70, v62, v30
    v_mul_f32 v71, v63, v30
    v_fma_f32 v64, -v57, v31, v64
    v_fmac_f32 v65, v56, v31
    v_fma_f32 v66, -v59, v31, v66
    v_fmac_f32 v67, v58, v31
    v_fma_f32 v68, -v61, v31, v68
    v_fmac_f32 v69, v60, v31
    v_fma_f32 v70, -v63, v31, v70
    v_fmac_f32 v71, v62, v31
    v_cvt_pk_bf16_f32 v79, v64, v65
    v_cvt_pk_bf16_f32 v72, v66, v67
    v_cvt_pk_bf16_f32 v73, v68, v69
    v_cvt_pk_bf16_f32 v74, v70, v71
    ds_write_addtid_b32 v79 offset:60608
    ds_write_addtid_b32 v72 offset:60880
    ds_write_addtid_b32 v73 offset:61152
    ds_write_addtid_b32 v74 offset:61424
    ds_read_b128 v[192:195], v27 offset:0
    ds_read_b128 v[196:199], v27 offset:64
    ds_read_b128 v[200:203], v27 offset:128
    ds_read_b128 v[204:207], v27 offset:192
    v_mul_f32 v80, v20, v24
    v_mul_f32 v81, v21, v24
    v_fmac_f32 v80, v21, v25
    v_fma_f32 v81, -v20, v25, v81
    v_mul_f32 v82, v80, v24
    v_mul_f32 v83, v81, v24
    v_fmac_f32 v82, v81, v25
    v_fma_f32 v83, -v80, v25, v83
    v_mul_f32 v84, v82, v24
    v_mul_f32 v85, v83, v24
    v_fmac_f32 v84, v83, v25
    v_fma_f32 v85, -v82, v25, v85
    v_mul_f32 v86, v84, v24
    v_mul_f32 v87, v85, v24
    v_fmac_f32 v86, v85, v25
    v_fma_f32 v87, -v84, v25, v87
    v_cvt_pk_bf16_f32 v75, v80, v81
    v_cvt_pk_bf16_f32 v76, v82, v83
    v_cvt_pk_bf16_f32 v77, v84, v85
    v_cvt_pk_bf16_f32 v78, v86, v87
    ds_write_addtid_b32 v75 offset:57344
    ds_write_addtid_b32 v76 offset:57616
    ds_write_addtid_b32 v77 offset:57888
    ds_write_addtid_b32 v78 offset:58160
    v_mul_f32 v88, v86, v24
    v_mul_f32 v89, v87, v24
    v_fmac_f32 v88, v87, v25
    v_fma_f32 v89, -v86, v25, v89
    v_mul_f32 v90, v88, v24
    v_mul_f32 v91, v89, v24
    v_fmac_f32 v90, v89, v25
    v_fma_f32 v91, -v88, v25, v91
    v_mul_f32 v92, v90, v24
    v_mul_f32 v93, v91, v24
    v_fmac_f32 v92, v91, v25
    v_fma_f32 v93, -v90, v25, v93
    v_mul_f32 v94, v92, v24
    v_mul_f32 v95, v93, v24
    v_fmac_f32 v94, v93, v25
    v_fma_f32 v95, -v92, v25, v95
    v_cvt_pk_bf16_f32 v79, v88, v89
    v_cvt_pk_bf16_f32 v72, v90, v91
    v_cvt_pk_bf16_f32 v73, v92, v93
    v_cvt_pk_bf16_f32 v74, v94, v95
    ds_write_addtid_b32 v79 offset:58432
    ds_write_addtid_b32 v72 offset:58704
    ds_write_addtid_b32 v73 offset:58976
    ds_write_addtid_b32 v74 offset:59248
    v_mul_f32 v96, v82, v22
    v_mul_f32 v97, v83, v22
    v_mul_f32 v98, v86, v22
    v_mul_f32 v99, v87, v22
    v_mul_f32 v100, v90, v22
    v_mul_f32 v101, v91, v22
    v_mul_f32 v102, v94, v22
    v_mul_f32 v103, v95, v22
    v_fmac_f32 v96, v83, v23
    v_fma_f32 v97, -v82, v23, v97
    v_fmac_f32 v98, v87, v23
    v_fma_f32 v99, -v86, v23, v99
    v_fmac_f32 v100, v91, v23
    v_fma_f32 v101, -v90, v23, v101
    v_fmac_f32 v102, v95, v23
    v_fma_f32 v103, -v94, v23, v103
    v_cvt_pk_bf16_f32 v75, v96, v97
    v_cvt_pk_bf16_f32 v76, v98, v99
    v_cvt_pk_bf16_f32 v77, v100, v101
    v_cvt_pk_bf16_f32 v78, v102, v103
    ds_write_addtid_b32 v75 offset:59520
    ds_write_addtid_b32 v76 offset:59792
    ds_write_addtid_b32 v77 offset:60064
    ds_write_addtid_b32 v78 offset:60336
    v_mul_f32 v104, v98, v22
    v_mul_f32 v105, v99, v22
    v_mul_f32 v106, v102, v22
    v_mul_f32 v107, v103, v22
    v_fmac_f32 v104, v99, v23
    v_fma_f32 v105, -v98, v23, v105
    v_fmac_f32 v106, v103, v23
    v_fma_f32 v107, -v102, v23, v107
    v_mul_f32 v108, v104, v22
    v_mul_f32 v109, v105, v22
    v_mul_f32 v110, v106, v22
    v_mul_f32 v111, v107, v22
    v_fmac_f32 v108, v105, v23
    v_fma_f32 v109, -v104, v23, v109
    v_fmac_f32 v110, v107, v23
    v_fma_f32 v111, -v106, v23, v111
    v_cvt_pk_bf16_f32 v79, v104, v105
    v_cvt_pk_bf16_f32 v72, v106, v107
    v_cvt_pk_bf16_f32 v73, v108, v109
    v_cvt_pk_bf16_f32 v74, v110, v111
    ds_write_addtid_b32 v79 offset:60608
    ds_write_addtid_b32 v72 offset:60880
    ds_write_addtid_b32 v73 offset:61152
    ds_write_addtid_b32 v74 offset:61424
    ds_read_b128 v[208:211], v27 offset:0
    ds_read_b128 v[212:215], v27 offset:64
    ds_read_b128 v[216:219], v27 offset:128
    ds_read_b128 v[220:223], v27 offset:192
    v_mul_f32 v64, v110, v22
    v_mul_f32 v65, v111, v22
    v_fmac_f32 v64, v111, v23
    v_fma_f32 v65, -v110, v23, v65
    v_mul_f32 v66, v64, v22
    v_mul_f32 v67, v65, v22
    v_fmac_f32 v66, v65, v23
    v_fma_f32 v67, -v64, v23, v67
    v_mul_f32 v68, v66, v22
    v_mul_f32 v69, v67, v22
    v_fmac_f32 v68, v67, v23
    v_fma_f32 v69, -v66, v23, v69
    v_mul_f32 v70, v68, v22
    v_mul_f32 v71, v69, v22
    v_fmac_f32 v70, v69, v23
    v_fma_f32 v71, -v68, v23, v71
    v_cvt_pk_bf16_f32 v75, v64, v65
    v_cvt_pk_bf16_f32 v76, v66, v67
    v_cvt_pk_bf16_f32 v77, v68, v69
    v_cvt_pk_bf16_f32 v78, v70, v71
    v_cvt_pk_bf16_f32 v79, v20, v21
    ds_write_addtid_b32 v75 offset:57344
    ds_write_addtid_b32 v76 offset:57616
    ds_write_addtid_b32 v77 offset:57888
    ds_write_addtid_b32 v78 offset:58160
    ds_write_addtid_b32 v79 offset:58432
    ds_read_b128 v[224:227], v27 offset:0
    ds_read_b128 v[228:231], v27 offset:64
    ds_read_b128 v[232:235], v27 offset:128
    ds_read_b128 v[236:239], v27 offset:192
    global_load_dwordx2 v[12:13], v1, s[46:47] sc1
    s_waitcnt lgkmcnt(9)
    v_mfma_f32_16x16x32_bf16 v[112:115], v[208:211], v[176:179], v[112:115]
    v_mfma_f32_16x16x32_bf16 v[112:115], v[212:215], v[180:183], v[112:115]
    v_mfma_f32_16x16x32_bf16 v[112:115], v[216:219], v[184:187], v[112:115]
    v_mfma_f32_16x16x32_bf16 v[112:115], v[220:223], v[188:191], v[112:115]
    v_mfma_f32_16x16x32_bf16 v[116:119], v[208:211], v[192:195], v[116:119]
    v_mfma_f32_16x16x32_bf16 v[116:119], v[212:215], v[196:199], v[116:119]
    v_mfma_f32_16x16x32_bf16 v[116:119], v[216:219], v[200:203], v[116:119]
    v_mfma_f32_16x16x32_bf16 v[116:119], v[220:223], v[204:207], v[116:119]
    s_waitcnt lgkmcnt(0)
    v_mfma_f32_16x16x32_bf16 v[120:123], v[176:179], v[224:227], v[120:123]
    v_mfma_f32_16x16x32_bf16 v[120:123], v[180:183], v[228:231], v[120:123]
    v_mfma_f32_16x16x32_bf16 v[120:123], v[184:187], v[232:235], v[120:123]
    v_mfma_f32_16x16x32_bf16 v[120:123], v[188:191], v[236:239], v[120:123]
    v_mfma_f32_16x16x32_bf16 v[124:127], v[192:195], v[224:227], v[124:127]
    v_mfma_f32_16x16x32_bf16 v[124:127], v[196:199], v[228:231], v[124:127]
    v_mfma_f32_16x16x32_bf16 v[124:127], v[200:203], v[232:235], v[124:127]
    v_mfma_f32_16x16x32_bf16 v[124:127], v[204:207], v[236:239], v[124:127]
    s_mov_b32 s8, 0x7060706
    s_mov_b32 s9, 0x5040504
    s_mov_b32 s13, 0x3020302
    s_mov_b32 s14, 0x3020504
    s_mov_b32 s15, 0x5040706
    v_cvt_pk_bf16_f32 v32, v112, v113
    ds_write_b32 v128, v32
    v_cvt_pk_bf16_f32 v33, v114, v115
    ds_write_b32 v129, v33
    v_cvt_pk_bf16_f32 v34, v116, v117
    ds_write_b32 v130, v34
    v_cvt_pk_bf16_f32 v35, v118, v119
    ds_write_b32 v131, v35
    v_cvt_pk_bf16_f32 v36, v120, v121
    v_cvt_pk_bf16_f32 v37, v122, v123
    v_cvt_pk_bf16_f32 v38, v124, v125
    v_cvt_pk_bf16_f32 v39, v126, v127
    v_cvt_pk_bf16_f32 v49, 0, v120
    ds_write_b64 v132, v[36:37] offset:1024
    ds_write_b64 v132, v[38:39] offset:1056
    s_mov_b64 exec, 16
    ds_write_b32 v133, v49
    s_mov_b64 exec, -1
    ds_read2_b32 v[54:55], v134 offset0:128 offset1:129
    ds_read2_b32 v[56:57], v134 offset0:64 offset1:65
    ds_read2_b32 v[58:59], v134 offset0:0 offset1:1
    ds_read2_b32 v[60:61], v135 offset0:0 offset1:1
    ds_read_b32 v62, v135 offset:8
    v_mov_b64 v[80:81], 0
    v_mov_b64 v[82:83], 0
    v_mov_b64 v[84:85], 0
    v_mov_b64 v[86:87], 0
    v_mov_b64 v[88:89], 0
    v_mov_b64 v[90:91], 0
    v_mov_b64 v[92:93], 0
    v_mov_b64 v[94:95], 0
    v_mov_b64 v[96:97], 0
    v_mov_b64 v[98:99], 0
    v_mov_b64 v[100:101], 0
    v_mov_b64 v[102:103], 0
    v_mov_b64 v[104:105], 0
    v_mov_b64 v[106:107], 0
    v_mov_b64 v[108:109], 0
    v_mov_b64 v[110:111], 0
    s_waitcnt lgkmcnt(0)
    v_perm_b32 v224, v55, v54, s8
    v_perm_b32 v225, v55, v54, s8
    v_perm_b32 v226, v55, v54, s9
    v_perm_b32 v227, v55, v54, s9
    v_perm_b32 v228, v55, v54, s9
    v_perm_b32 v229, v55, v54, s14
    v_perm_b32 v230, v55, v54, s13
    v_perm_b32 v231, v55, v54, s13
    v_perm_b32 v232, v55, v54, s8
    v_perm_b32 v233, v55, v54, s15
    v_perm_b32 v234, v55, v54, s9
    v_perm_b32 v235, v55, v54, s9
    v_perm_b32 v236, v55, v54, s9
    v_perm_b32 v237, v55, v54, s13
    v_perm_b32 v238, v55, v54, s13
    v_perm_b32 v239, v55, v54, s13
    v_perm_b32 v196, v57, v56, s8
    v_perm_b32 v197, v57, v56, s9
    v_perm_b32 v198, v57, v56, s14
    v_perm_b32 v199, v57, v56, s13
    v_perm_b32 v200, v57, v56, s15
    v_perm_b32 v201, v57, v56, s9
    v_perm_b32 v202, v57, v56, s13
    v_perm_b32 v203, v57, v56, s13
    v_perm_b32 v204, v59, v58, s15
    v_perm_b32 v205, v59, v58, s13
    v_perm_b32 v206, v59, v58, s14
    v_perm_b32 v207, v59, v58, v136
    v_perm_b32 v208, v62, v61, s14
    v_perm_b32 v209, v61, v60, s14
    v_alignbit_b32 v210, v61, v61, 16
    v_alignbit_b32 v211, v60, v60, 16
    s_waitcnt vmcnt(0)
    s_mov_b32 s82, 0
Lnon_44:
    v_readfirstlane_b32 s80, v12
    v_readfirstlane_b32 s81, v13
    s_add_u32 s82, s82, 1
    s_bitcmp1_b32 s80, 0
    s_cbranch_scc1 Lnond_45
    s_cmp_gt_u32 s82, 20000
    s_cbranch_scc1 Lnond_45
    s_sleep 4
    global_load_dwordx2 v[12:13], v1, s[46:47] sc1
    s_waitcnt vmcnt(0)
    s_branch Lnon_44
Lnond_45:
    s_branch L_b_6
L_b_G2:
    s_mov_b32 s64, s48
    s_mov_b32 s65, s49
    s_mov_b32 s66, 6291456
    s_mov_b32 s67, 0x20000
    s_mov_b32 s68, s44
    s_mov_b32 s69, s45
    s_mov_b32 s70, 5242880
    s_mov_b32 s71, 0x20000
    s_mov_b32 s72, s24
    s_mov_b32 s73, s25
    s_mov_b32 s74, 819200
    s_mov_b32 s75, 0x20000
    s_mov_b32 s76, s26
    s_mov_b32 s77, s27
    s_mov_b32 s78, 2621440
    s_mov_b32 s79, 0x20000
    v_lshlrev_b32 v2, 18, v0
    v_mov_b32 v1, 0
    s_cmp_eq_u32 s10, 0
    s_mov_b32 s12, 0x3f000
    s_cselect_b32 s12, s12, 0x80000000
    buffer_load_dword v255, v2, s[64:67], s12 offen sc1
    s_cmp_eq_u32 s10, 1
    s_cselect_b32 s12, 0, 0x80000000
    buffer_load_dword v255, v2, s[76:79], s12 offen sc1
    s_cmp_eq_u32 s10, 2
    s_cselect_b32 s12, 0, 0x80000000
    buffer_load_dword v255, v2, s[72:75], s12 offen sc1
    s_cmp_eq_u32 s10, 3
    s_cselect_b32 s12, 0, 0x80000000
    buffer_load_dword v255, v2, s[68:71], s12 offen sc1
    global_load_dword v255, v1, s[46:47] offset:128 sc1
    s_lshl_b32 s51, s3, 10
    v_add_u32 v145, 5248, v8
    v_lshlrev_b32 v148, 3, v0
    v_add_u32 v148, 7296, v148
    v_and_b32 v60, 31, v0
    v_cmp_lt_u32 vcc, 20, v60
    v_lshrrev_b32 v62, 5, v0
    v_mul_u32_u24 v62, 0x150, v62
    v_lshl_add_u32 v61, v60, 4, v62
    v_add_u32 v151, 7808, v61
    v_mov_b32 v61, 0x30000
    v_cndmask_b32 v151, v151, v61, vcc
    v_add_u32 v146, 41984, v145
    v_add_u32 v147, 83968, v145
    v_add_u32 v149, 41984, v148
    v_add_u32 v150, 83968, v148
    v_add_u32 v152, 41984, v151
    v_add_u32 v153, 83968, v151
    v_mov_b32 v144, 0xdddddddd
    v_mov_b64 v[80:81], 0
    v_mov_b64 v[82:83], 0
    v_mov_b64 v[84:85], 0
    v_mov_b64 v[86:87], 0
    v_mov_b64 v[88:89], 0
    v_mov_b64 v[90:91], 0
    v_mov_b64 v[92:93], 0
    v_mov_b64 v[94:95], 0
    v_mov_b64 v[96:97], 0
    v_mov_b64 v[98:99], 0
    v_mov_b64 v[100:101], 0
    v_mov_b64 v[102:103], 0
    v_mov_b64 v[104:105], 0
    v_mov_b64 v[106:107], 0
    v_mov_b64 v[108:109], 0
    v_mov_b64 v[110:111], 0
    s_and_b32 s10, s3, 3
    s_lshl_b32 s12, s50, 1
    s_load_dwordx4 s[92:95], s[42:43], s12
    s_and_b32 s13, s10, 1
    s_mul_i32 s11, s13, 655360
    s_add_u32 s11, s11, s12
    s_lshr_b32 s14, s10, 1
    s_lshl3_add_u32 s11, s14, s11
    s_cmp_lt_u32 s2, 80
    s_cselect_b32 s11, s11, 0x80000000
    s_movk_i32 s12, 1280
    v_mov_b32 v1, s11
    v_mad_u32_u24 v155, v0, s12, v1
    s_lshl_b32 s11, s10, 9
    s_add_u32 s11, s11, 123840
    v_lshl_add_u32 v156, v0, 3, s11
    v_and_b32 v1, 48, v0
    v_and_b32 v2, 3, v0
    v_lshl_add_u32 v1, v2, 2, v1
    v_bfe_u32 v3, v0, 2, 2
    v_add_u32 v1, v1, v3
    v_lshl_add_u32 v157, v1, 3, s11
    s_mul_i32 s11, s14, 10176
    s_lshl_b32 s13, s13, 10
    s_add_u32 s11, s11, s13
    s_add_u32 s11, s11, 103904
    v_lshrrev_b32 v1, 2, v0
    v_lshl_add_u32 v1, v1, 3, s11
    s_movk_i32 s12, 2544
    v_mad_u32_u24 v158, v2, s12, v1
    s_mul_i32 s11, s10, 2544
    s_add_u32 s11, s11, 103424
    v_min_u32 v1, 59, v0
    v_lshl_add_u32 v159, v1, 3, s11
    v_add_u32 v249, 10176, v159
    v_mov_b32 v4, 0
    v_mov_b32 v5, 0
    s_mul_i32 s11, s10, 4224
    s_add_u32 s11, s11, 125952
    v_and_b32 v10, 15, v0
    v_lshrrev_b32 v11, 4, v0
    v_sub_u32 v12, 0x7ef, v10
    v_lshrrev_b32 v12, 1, v12
    v_lshl_add_u32 v12, v11, 2, v12
    v_lshlrev_b32 v12, 2, v12
    v_and_b32 v13, 1, v0
    v_xor_b32 v13, 1, v13
    v_mul_u32_u24 v13, 2112, v13
    s_sub_u32 s12, s11, 3008
    v_add3_u32 v240, v12, v13, s12
    v_subrev_u32 v241, 1024, v240
    v_add_u32 v242, 16896, v240
    v_add_u32 v243, 16896, v241
    v_lshlrev_b32 v12, 5, v10
    s_mul_i32 s12, s10, 2544
    s_add_u32 s12, s12, 103424
    v_lshl_add_u32 v13, v11, 4, v12
    v_add_u32 v244, s12, v13
    s_lshr_b32 s12, s10, 1
    s_lshl_b32 s12, s12, 6
    s_add_u32 s12, s12, s11
    v_lshl_add_u32 v13, v11, 3, v12
    v_add_u32 v245, s12, v13
    v_bfe_u32 v12, v0, 2, 2
    s_movk_i32 s12, 4224
    v_lshrrev_b32 v13, 1, v12
    v_lshlrev_b32 v13, 6, v13
    v_mad_u32_u24 v13, v12, s12, v13
    v_lshl_add_u32 v13, v11, 5, v13
    v_and_b32 v12, 3, v0
    v_lshl_add_u32 v13, v12, 3, v13
    s_lshl_b32 s12, s10, 7
    s_add_u32 s12, s12, 125952
    v_add_u32 v246, s12, v13
    s_mul_i32 s11, s10, 163840
    s_lshl_b32 s12, s50, 1
    s_add_u32 s11, s11, s12
    s_add_u32 s11, s11, 1280
    s_movk_i32 s12, 2560
    v_mov_b32 v247, s11
    v_mad_u32_u24 v247, v0, s12, v247
    v_sub_u32 v250, 1008, v8
    v_lshlrev_b32 v251, 3, v0
    v_sub_u32 v251, 1528, v251
    v_and_b32 v12, 1, v11
    v_mul_u32_u24 v12, 2112, v12
    v_lshl_add_u32 v252, v10, 2, v12
    v_lshlrev_b32 v248, 24, v0
    s_add_u32 s11, s50, s10
    s_lshr_b32 s12, s50, 3
    s_lshl_b32 s12, s12, 7
    s_add_u32 s99, s12, 204800
    s_mov_b32 s90, 0x80000000
    s_mov_b32 s91, 0x80000000
    s_mul_i32 s98, s50, 4224
    s_lshl_b32 s12, s10, 10
    s_add_u32 s98, s98, s12
    s_add_u32 s98, s98, 2883584
    s_mul_i32 s11, s10, 6144
    s_add_u32 s11, s11, 41984
    v_add_u32 v9, s11, v8
    s_lshr_b32 s11, s2, 3
    s_mul_i32 s11, s11, 81920
    s_and_b32 s12, s2, 7
    s_mul_i32 s12, s12, 160
    s_add_u32 s11, s11, s12
    s_mul_i32 s12, s10, 156
    s_add_u32 s11, s11, s12
    s_cmp_lt_u32 s10, 2
    s_cselect_b32 s11, s11, 0x80000000
    s_movk_i32 s12, 1280
    v_mov_b32 v154, s11
    v_mad_u32_u24 v154, v0, s12, v154
    v_mov_b32 v1, 0
    v_mov_b32 v2, 163824
    s_setprio 0
    s_barrier
    s_mov_b32 s82, 0
L_g2w:
    s_sleep 8
    ds_read_b32 v3, v2
    s_add_u32 s82, s82, 1
    s_waitcnt lgkmcnt(0)
    v_readfirstlane_b32 s83, v3
    s_cmp_gt_u32 s82, 0x4000
    s_cbranch_scc1 L_g2d
    s_cmp_lt_u32 s83, 8
    s_cbranch_scc1 L_g2w
L_g2d:
    global_load_dwordx2 v[12:13], v1, s[46:47] sc1
    s_waitcnt vmcnt(0)
    s_mov_b32 s82, 0
Lnon_46:
    v_readfirstlane_b32 s80, v12
    v_readfirstlane_b32 s81, v13
    s_add_u32 s82, s82, 1
    s_bitcmp1_b32 s80, 0
    s_cbranch_scc1 Lnond_47
    s_cmp_gt_u32 s82, 20000
    s_cbranch_scc1 Lnond_47
    s_sleep 4
    global_load_dwordx2 v[12:13], v1, s[46:47] sc1
    s_waitcnt vmcnt(0)
    s_branch Lnon_46
Lnond_47:
    s_branch L_b_5
L_pro_kv:
    s_mov_b32 s64, s48
    s_mov_b32 s65, s49
    s_mov_b32 s66, 6291456
    s_mov_b32 s67, 0x20000
    s_mov_b32 s68, s44
    s_mov_b32 s69, s45
    s_mov_b32 s70, 5242880
    s_mov_b32 s71, 0x20000
    s_mov_b32 s72, s24
    s_mov_b32 s73, s25
    s_mov_b32 s74, 819200
    s_mov_b32 s75, 0x20000
    s_mov_b32 s76, s26
    s_mov_b32 s77, s27
    s_mov_b32 s78, 2621440
    s_mov_b32 s79, 0x20000
    s_lshl_b32 s51, s3, 10
    v_add_u32 v145, 5248, v8
    v_lshlrev_b32 v148, 3, v0
    v_add_u32 v148, 7296, v148
    v_and_b32 v60, 31, v0
    v_cmp_lt_u32 vcc, 20, v60
    v_lshrrev_b32 v62, 5, v0
    v_mul_u32_u24 v62, 0x150, v62
    v_lshl_add_u32 v61, v60, 4, v62
    v_add_u32 v151, 7808, v61
    v_mov_b32 v61, 0x30000
    v_cndmask_b32 v151, v151, v61, vcc
    v_add_u32 v146, 41984, v145
    v_add_u32 v147, 83968, v145
    v_add_u32 v149, 41984, v148
    v_add_u32 v150, 83968, v148
    v_add_u32 v152, 41984, v151
    v_add_u32 v153, 83968, v151
    v_mov_b32 v144, 0xdddddddd
    s_and_b32 s10, s3, 3
    s_lshl_b32 s12, s50, 1
    s_load_dwordx4 s[92:95], s[42:43], s12
    s_and_b32 s13, s10, 1
    s_mul_i32 s11, s13, 655360
    s_add_u32 s11, s11, s12
    s_lshr_b32 s14, s10, 1
    s_lshl3_add_u32 s11, s14, s11
    s_cmp_lt_u32 s2, 80
    s_cselect_b32 s11, s11, 0x80000000
    s_movk_i32 s12, 1280
    v_mov_b32 v1, s11
    v_mad_u32_u24 v155, v0, s12, v1
    s_lshl_b32 s11, s10, 9
    s_add_u32 s11, s11, 123840
    v_lshl_add_u32 v156, v0, 3, s11
    v_and_b32 v1, 48, v0
    v_and_b32 v2, 3, v0
    v_lshl_add_u32 v1, v2, 2, v1
    v_bfe_u32 v3, v0, 2, 2
    v_add_u32 v1, v1, v3
    v_lshl_add_u32 v157, v1, 3, s11
    s_mul_i32 s11, s14, 10176
    s_lshl_b32 s13, s13, 10
    s_add_u32 s11, s11, s13
    s_add_u32 s11, s11, 103904
    v_lshrrev_b32 v1, 2, v0
    v_lshl_add_u32 v1, v1, 3, s11
    s_movk_i32 s12, 2544
    v_mad_u32_u24 v158, v2, s12, v1
    s_mul_i32 s11, s10, 2544
    s_add_u32 s11, s11, 103424
    v_min_u32 v1, 59, v0
    v_lshl_add_u32 v159, v1, 3, s11
    v_add_u32 v249, 10176, v159
    v_mov_b32 v4, 0
    v_mov_b32 v5, 0
    s_mul_i32 s11, s10, 4224
    s_add_u32 s11, s11, 125952
    v_and_b32 v10, 15, v0
    v_lshrrev_b32 v11, 4, v0
    v_sub_u32 v12, 0x7ef, v10
    v_lshrrev_b32 v12, 1, v12
    v_lshl_add_u32 v12, v11, 2, v12
    v_lshlrev_b32 v12, 2, v12
    v_and_b32 v13, 1, v0
    v_xor_b32 v13, 1, v13
    v_mul_u32_u24 v13, 2112, v13
    s_sub_u32 s12, s11, 3008
    v_add3_u32 v240, v12, v13, s12
    v_subrev_u32 v241, 1024, v240
    v_add_u32 v242, 16896, v240
    v_add_u32 v243, 16896, v241
    v_lshlrev_b32 v12, 5, v10
    s_mul_i32 s12, s10, 2544
    s_add_u32 s12, s12, 103424
    v_lshl_add_u32 v13, v11, 4, v12
    v_add_u32 v244, s12, v13
    s_lshr_b32 s12, s10, 1
    s_lshl_b32 s12, s12, 6
    s_add_u32 s12, s12, s11
    v_lshl_add_u32 v13, v11, 3, v12
    v_add_u32 v245, s12, v13
    v_bfe_u32 v12, v0, 2, 2
    s_movk_i32 s12, 4224
    v_lshrrev_b32 v13, 1, v12
    v_lshlrev_b32 v13, 6, v13
    v_mad_u32_u24 v13, v12, s12, v13
    v_lshl_add_u32 v13, v11, 5, v13
    v_and_b32 v12, 3, v0
    v_lshl_add_u32 v13, v12, 3, v13
    s_lshl_b32 s12, s10, 7
    s_add_u32 s12, s12, 125952
    v_add_u32 v246, s12, v13
    s_mul_i32 s11, s10, 163840
    s_lshl_b32 s12, s50, 1
    s_add_u32 s11, s11, s12
    s_add_u32 s11, s11, 1280
    s_movk_i32 s12, 2560
    v_mov_b32 v247, s11
    v_mad_u32_u24 v247, v0, s12, v247
    v_sub_u32 v250, 1008, v8
    v_lshlrev_b32 v251, 3, v0
    v_sub_u32 v251, 1528, v251
    v_and_b32 v12, 1, v11
    v_mul_u32_u24 v12, 2112, v12
    v_lshl_add_u32 v252, v10, 2, v12
    v_lshlrev_b32 v248, 24, v0
    s_add_u32 s11, s50, s10
    s_lshr_b32 s12, s50, 3
    s_lshl_b32 s12, s12, 7
    s_add_u32 s99, s12, 204800
    s_mov_b32 s90, 0x80000000
    s_mov_b32 s91, 0x80000000
    s_mul_i32 s98, s50, 4224
    s_lshl_b32 s12, s10, 10
    s_add_u32 s98, s98, s12
    s_add_u32 s98, s98, 2883584
    s_mul_i32 s11, s10, 6144
    s_add_u32 s11, s11, 41984
    v_add_u32 v9, s11, v8
    s_lshr_b32 s11, s2, 3
    s_mul_i32 s11, s11, 81920
    s_and_b32 s12, s2, 7
    s_mul_i32 s12, s12, 160
    s_add_u32 s11, s11, s12
    s_mul_i32 s12, s10, 156
    s_add_u32 s11, s11, s12
    s_cmp_lt_u32 s10, 2
    s_cselect_b32 s11, s11, 0x80000000
    s_movk_i32 s12, 1280
    v_mov_b32 v154, s11
    v_mad_u32_u24 v154, v0, s12, v154
    v_and_b32 v20, 31, v0
    v_lshrrev_b32 v21, 5, v0
    v_and_b32 v22, 0x13, v20
    v_bfe_u32 v23, v20, 2, 1
    v_lshl_or_b32 v22, v23, 3, v22
    v_bfe_u32 v23, v20, 3, 1
    v_lshl_or_b32 v22, v23, 2, v22
    s_cmp_eq_u32 s5, 1
    s_cselect_b64 vcc, -1, 0
    v_cndmask_b32 v20, v20, v22, vcc
    s_and_b32 s10, s3, 1
    s_bfe_u32 s11, s3, 0x10001
    v_and_b32 v22, 15, v20
    v_xor_b32 v22, v22, v21
    v_lshlrev_b32 v22, 4, v22
    v_lshl_or_b32 v22, v20, 8, v22
    s_lshl_b32 s12, s10, 13
    s_lshl_b32 s13, s11, 7
    s_or_b32 s12, s12, s13
    v_xor_b32 v10, s12, v22
    v_xor_b32 v11, 32, v10
    v_xor_b32 v12, 64, v10
    v_xor_b32 v13, 96, v10
    v_bfe_u32 v22, v0, 2, 2
    v_lshl_add_u32 v22, v21, 3, v22
    v_mul_u32_u24 v22, 40, v22
    v_bfe_u32 v23, v0, 4, 1
    v_and_b32 v24, 3, v0
    v_lshl_add_u32 v23, v23, 2, v24
    v_cmp_lt_u32 vcc, 4, v23
    v_mov_b32 v24, 0x30000
    v_lshl_add_u32 v22, v23, 3, v22
    s_mul_i32 s12, s11, 2560
    s_add_u32 s12, s12, 110592
    v_cndmask_b32 v22, v22, v24, vcc
    v_add_u32 v14, s12, v22
    s_waitcnt vmcnt(0) lgkmcnt(0)
    s_barrier
    s_cmp_eq_u32 s5, 1
    s_cbranch_scc1 L_kv_V
    ds_read_b128 v[16:19], v10 offset:0
    ds_read_b64_tr_b16 v[20:21], v14 offset:0
    ds_read_b64_tr_b16 v[22:23], v14 offset:160
    ds_read_b128 v[24:27], v11 offset:0
    ds_read_b64_tr_b16 v[28:29], v14 offset:640
    ds_read_b64_tr_b16 v[30:31], v14 offset:800
    ds_read_b128 v[32:35], v12 offset:0
    ds_read_b64_tr_b16 v[36:37], v14 offset:1280
    ds_read_b64_tr_b16 v[38:39], v14 offset:1440
    ds_read_b128 v[40:43], v13 offset:0
    ds_read_b64_tr_b16 v[44:45], v14 offset:1920
    ds_read_b64_tr_b16 v[46:47], v14 offset:2080
    ds_read_b128 v[48:51], v10 offset:16384
    ds_read_b64_tr_b16 v[52:53], v14 offset:5120
    ds_read_b64_tr_b16 v[54:55], v14 offset:5280
    s_waitcnt lgkmcnt(12)
    v_mfma_f32_32x32x16_bf16 v[80:95], v[20:23], v[16:19], 0
    ds_read_b128 v[56:59], v11 offset:16384
    ds_read_b64_tr_b16 v[60:61], v14 offset:5760
    ds_read_b64_tr_b16 v[62:63], v14 offset:5920
    s_waitcnt lgkmcnt(12)
    v_mfma_f32_32x32x16_bf16 v[80:95], v[28:31], v[24:27], v[80:95]
    ds_read_b128 v[16:19], v12 offset:16384
    ds_read_b64_tr_b16 v[20:21], v14 offset:6400
    ds_read_b64_tr_b16 v[22:23], v14 offset:6560
    s_waitcnt lgkmcnt(12)
    v_mfma_f32_32x32x16_bf16 v[80:95], v[36:39], v[32:35], v[80:95]
    ds_read_b128 v[24:27], v13 offset:16384
    ds_read_b64_tr_b16 v[28:29], v14 offset:7040
    ds_read_b64_tr_b16 v[30:31], v14 offset:7200
    s_waitcnt lgkmcnt(12)
    v_mfma_f32_32x32x16_bf16 v[80:95], v[44:47], v[40:43], v[80:95]
    ds_read_b128 v[32:35], v10 offset:32768
    ds_read_b64_tr_b16 v[36:37], v14 offset:10240
    ds_read_b64_tr_b16 v[38:39], v14 offset:10400
    s_waitcnt lgkmcnt(12)
    v_mfma_f32_32x32x16_bf16 v[80:95], v[52:55], v[48:51], v[80:95]
    ds_read_b128 v[40:43], v11 offset:32768
    ds_read_b64_tr_b16 v[44:45], v14 offset:10880
    ds_read_b64_tr_b16 v[46:47], v14 offset:11040
    s_waitcnt lgkmcnt(12)
    v_mfma_f32_32x32x16_bf16 v[80:95], v[60:63], v[56:59], v[80:95]
    ds_read_b128 v[48:51], v12 offset:32768
    ds_read_b64_tr_b16 v[52:53], v14 offset:11520
    ds_read_b64_tr_b16 v[54:55], v14 offset:11680
    s_waitcnt lgkmcnt(12)
    v_mfma_f32_32x32x16_bf16 v[80:95], v[20:23], v[16:19], v[80:95]
    ds_read_b128 v[56:59], v13 offset:32768
    ds_read_b64_tr_b16 v[60:61], v14 offset:12160
    ds_read_b64_tr_b16 v[62:63], v14 offset:12320
    s_waitcnt lgkmcnt(12)
    v_mfma_f32_32x32x16_bf16 v[80:95], v[28:31], v[24:27], v[80:95]
    ds_read_b64_tr_b16 v[96:97], v14 offset:15360
    ds_read_b64_tr_b16 v[98:99], v14 offset:15520
    ds_read_b64_tr_b16 v[100:101], v14 offset:16000
    ds_read_b64_tr_b16 v[102:103], v14 offset:16160
    s_waitcnt lgkmcnt(13)
    v_mfma_f32_32x32x16_bf16 v[80:95], v[36:39], v[32:35], v[80:95]
    ds_read_b64_tr_b16 v[104:105], v14 offset:16640
    ds_read_b64_tr_b16 v[106:107], v14 offset:16800
    ds_read_b64_tr_b16 v[108:109], v14 offset:17280
    ds_read_b64_tr_b16 v[110:111], v14 offset:17440
    s_waitcnt lgkmcnt(14)
    v_mfma_f32_32x32x16_bf16 v[80:95], v[44:47], v[40:43], v[80:95]
    ds_read_b64_tr_b16 v[112:113], v14 offset:20480
    ds_read_b64_tr_b16 v[114:115], v14 offset:20640
    ds_read_b64_tr_b16 v[116:117], v14 offset:21120
    ds_read_b64_tr_b16 v[118:119], v14 offset:21280
    s_waitcnt lgkmcnt(15)
    v_mfma_f32_32x32x16_bf16 v[80:95], v[52:55], v[48:51], v[80:95]
    ds_read_b64_tr_b16 v[120:121], v14 offset:21760
    ds_read_b64_tr_b16 v[122:123], v14 offset:21920
    s_waitcnt lgkmcnt(14)
    v_mfma_f32_32x32x16_bf16 v[80:95], v[60:63], v[56:59], v[80:95]
    ds_read_b64_tr_b16 v[124:125], v14 offset:22400
    ds_read_b64_tr_b16 v[126:127], v14 offset:22560
    s_barrier
    ds_read_b128 v[160:163], v10 offset:49152
    ds_read_b128 v[164:167], v11 offset:49152
    ds_read_b128 v[168:171], v12 offset:49152
    ds_read_b128 v[172:175], v13 offset:49152
    v_add_u32 v10, 0x10000, v10
    v_add_u32 v11, 0x10000, v11
    v_add_u32 v12, 0x10000, v12
    v_add_u32 v13, 0x10000, v13
    ds_read_b128 v[176:179], v10 offset:0
    ds_read_b128 v[180:183], v11 offset:0
    ds_read_b128 v[184:187], v12 offset:0
    ds_read_b128 v[188:191], v13 offset:0
    s_waitcnt lgkmcnt(7)
    v_mfma_f32_32x32x16_bf16 v[80:95], v[96:99], v[160:163], v[80:95]
    s_waitcnt lgkmcnt(6)
    v_mfma_f32_32x32x16_bf16 v[80:95], v[100:103], v[164:167], v[80:95]
    s_waitcnt lgkmcnt(5)
    v_mfma_f32_32x32x16_bf16 v[80:95], v[104:107], v[168:171], v[80:95]
    s_waitcnt lgkmcnt(4)
    v_mfma_f32_32x32x16_bf16 v[80:95], v[108:111], v[172:175], v[80:95]
    s_waitcnt lgkmcnt(3)
    v_mfma_f32_32x32x16_bf16 v[80:95], v[112:115], v[176:179], v[80:95]
    s_waitcnt lgkmcnt(2)
    v_mfma_f32_32x32x16_bf16 v[80:95], v[116:119], v[180:183], v[80:95]
    s_waitcnt lgkmcnt(1)
    v_mfma_f32_32x32x16_bf16 v[80:95], v[120:123], v[184:187], v[80:95]
    s_waitcnt lgkmcnt(0)
    v_mfma_f32_32x32x16_bf16 v[80:95], v[124:127], v[188:191], v[80:95]
    s_branch L_kv_d
L_kv_V:
    ds_read_b128 v[16:19], v10 offset:0
    ds_read_b64_tr_b16 v[20:21], v14 offset:0
    ds_read_b64_tr_b16 v[22:23], v14 offset:160
    ds_read_b128 v[24:27], v11 offset:0
    ds_read_b64_tr_b16 v[28:29], v14 offset:640
    ds_read_b64_tr_b16 v[30:31], v14 offset:800
    ds_read_b128 v[32:35], v12 offset:0
    ds_read_b64_tr_b16 v[36:37], v14 offset:1280
    ds_read_b64_tr_b16 v[38:39], v14 offset:1440
    ds_read_b128 v[40:43], v13 offset:0
    ds_read_b64_tr_b16 v[44:45], v14 offset:1920
    ds_read_b64_tr_b16 v[46:47], v14 offset:2080
    ds_read_b128 v[48:51], v10 offset:16384
    ds_read_b64_tr_b16 v[52:53], v14 offset:5120
    ds_read_b64_tr_b16 v[54:55], v14 offset:5280
    s_waitcnt lgkmcnt(12)
    v_mfma_f32_32x32x16_bf16 v[80:95], v[16:19], v[20:23], 0
    ds_read_b128 v[56:59], v11 offset:16384
    ds_read_b64_tr_b16 v[60:61], v14 offset:5760
    ds_read_b64_tr_b16 v[62:63], v14 offset:5920
    s_waitcnt lgkmcnt(12)
    v_mfma_f32_32x32x16_bf16 v[80:95], v[24:27], v[28:31], v[80:95]
    ds_read_b128 v[16:19], v12 offset:16384
    ds_read_b64_tr_b16 v[20:21], v14 offset:6400
    ds_read_b64_tr_b16 v[22:23], v14 offset:6560
    s_waitcnt lgkmcnt(12)
    v_mfma_f32_32x32x16_bf16 v[80:95], v[32:35], v[36:39], v[80:95]
    ds_read_b128 v[24:27], v13 offset:16384
    ds_read_b64_tr_b16 v[28:29], v14 offset:7040
    ds_read_b64_tr_b16 v[30:31], v14 offset:7200
    s_waitcnt lgkmcnt(12)
    v_mfma_f32_32x32x16_bf16 v[80:95], v[40:43], v[44:47], v[80:95]
    ds_read_b128 v[32:35], v10 offset:32768
    ds_read_b64_tr_b16 v[36:37], v14 offset:10240
    ds_read_b64_tr_b16 v[38:39], v14 offset:10400
    s_waitcnt lgkmcnt(12)
    v_mfma_f32_32x32x16_bf16 v[80:95], v[48:51], v[52:55], v[80:95]
    ds_read_b128 v[40:43], v11 offset:32768
    ds_read_b64_tr_b16 v[44:45], v14 offset:10880
    ds_read_b64_tr_b16 v[46:47], v14 offset:11040
    s_waitcnt lgkmcnt(12)
    v_mfma_f32_32x32x16_bf16 v[80:95], v[56:59], v[60:63], v[80:95]
    ds_read_b128 v[48:51], v12 offset:32768
    ds_read_b64_tr_b16 v[52:53], v14 offset:11520
    ds_read_b64_tr_b16 v[54:55], v14 offset:11680
    s_waitcnt lgkmcnt(12)
    v_mfma_f32_32x32x16_bf16 v[80:95], v[16:19], v[20:23], v[80:95]
    ds_read_b128 v[56:59], v13 offset:32768
    ds_read_b64_tr_b16 v[60:61], v14 offset:12160
    ds_read_b64_tr_b16 v[62:63], v14 offset:12320
    s_waitcnt lgkmcnt(12)
    v_mfma_f32_32x32x16_bf16 v[80:95], v[24:27], v[28:31], v[80:95]
    ds_read_b64_tr_b16 v[96:97], v14 offset:15360
    ds_read_b64_tr_b16 v[98:99], v14 offset:15520
    ds_read_b64_tr_b16 v[100:101], v14 offset:16000
    ds_read_b64_tr_b16 v[102:103], v14 offset:16160
    s_waitcnt lgkmcnt(13)
    v_mfma_f32_32x32x16_bf16 v[80:95], v[32:35], v[36:39], v[80:95]
    ds_read_b64_tr_b16 v[104:105], v14 offset:16640
    ds_read_b64_tr_b16 v[106:107], v14 offset:16800
    ds_read_b64_tr_b16 v[108:109], v14 offset:17280
    ds_read_b64_tr_b16 v[110:111], v14 offset:17440
    s_waitcnt lgkmcnt(14)
    v_mfma_f32_32x32x16_bf16 v[80:95], v[40:43], v[44:47], v[80:95]
    ds_read_b64_tr_b16 v[112:113], v14 offset:20480
    ds_read_b64_tr_b16 v[114:115], v14 offset:20640
    ds_read_b64_tr_b16 v[116:117], v14 offset:21120
    ds_read_b64_tr_b16 v[118:119], v14 offset:21280
    s_waitcnt lgkmcnt(15)
    v_mfma_f32_32x32x16_bf16 v[80:95], v[48:51], v[52:55], v[80:95]
    ds_read_b64_tr_b16 v[120:121], v14 offset:21760
    ds_read_b64_tr_b16 v[122:123], v14 offset:21920
    s_waitcnt lgkmcnt(14)
    v_mfma_f32_32x32x16_bf16 v[80:95], v[56:59], v[60:63], v[80:95]
    ds_read_b64_tr_b16 v[124:125], v14 offset:22400
    ds_read_b64_tr_b16 v[126:127], v14 offset:22560
    s_barrier
    ds_read_b128 v[160:163], v10 offset:49152
    ds_read_b128 v[164:167], v11 offset:49152
    ds_read_b128 v[168:171], v12 offset:49152
    ds_read_b128 v[172:175], v13 offset:49152
    v_add_u32 v10, 0x10000, v10
    v_add_u32 v11, 0x10000, v11
    v_add_u32 v12, 0x10000, v12
    v_add_u32 v13, 0x10000, v13
    ds_read_b128 v[176:179], v10 offset:0
    ds_read_b128 v[180:183], v11 offset:0
    ds_read_b128 v[184:187], v12 offset:0
    ds_read_b128 v[188:191], v13 offset:0
    s_waitcnt lgkmcnt(7)
    v_mfma_f32_32x32x16_bf16 v[80:95], v[160:163], v[96:99], v[80:95]
    s_waitcnt lgkmcnt(6)
    v_mfma_f32_32x32x16_bf16 v[80:95], v[164:167], v[100:103], v[80:95]
    s_waitcnt lgkmcnt(5)
    v_mfma_f32_32x32x16_bf16 v[80:95], v[168:171], v[104:107], v[80:95]
    s_waitcnt lgkmcnt(4)
    v_mfma_f32_32x32x16_bf16 v[80:95], v[172:175], v[108:111], v[80:95]
    s_waitcnt lgkmcnt(3)
    v_mfma_f32_32x32x16_bf16 v[80:95], v[176:179], v[112:115], v[80:95]
    s_waitcnt lgkmcnt(2)
    v_mfma_f32_32x32x16_bf16 v[80:95], v[180:183], v[116:119], v[80:95]
    s_waitcnt lgkmcnt(1)
    v_mfma_f32_32x32x16_bf16 v[80:95], v[184:187], v[120:123], v[80:95]
    s_waitcnt lgkmcnt(0)
    v_mfma_f32_32x32x16_bf16 v[80:95], v[188:191], v[124:127], v[80:95]
L_kv_d:
    s_lshl_b32 s12, s10, 12
    s_add_u32 s12, s12, 102400
    v_add_u32 v15, s12, v8
    s_cmp_lt_u32 s3, 6
    s_cbranch_scc1 L_p_fin
    s_nop 9
    ds_write_b128 v15, v[80:83] offset:0
    ds_write_b128 v15, v[84:87] offset:1024
    ds_write_b128 v15, v[88:91] offset:2048
    ds_write_b128 v15, v[92:95] offset:3072
    s_waitcnt lgkmcnt(0)
    s_barrier
    v_mov_b32 v1, 0
    global_load_dwordx2 v[12:13], v1, s[46:47] sc1
    v_mov_b64 v[80:81], 0
    v_mov_b64 v[82:83], 0
    v_mov_b64 v[84:85], 0
    v_mov_b64 v[86:87], 0
    v_mov_b64 v[88:89], 0
    v_mov_b64 v[90:91], 0
    v_mov_b64 v[92:93], 0
    v_mov_b64 v[94:95], 0
    v_mov_b64 v[96:97], 0
    v_mov_b64 v[98:99], 0
    v_mov_b64 v[100:101], 0
    v_mov_b64 v[102:103], 0
    v_mov_b64 v[104:105], 0
    v_mov_b64 v[106:107], 0
    v_mov_b64 v[108:109], 0
    v_mov_b64 v[110:111], 0
    s_waitcnt vmcnt(0)
    s_mov_b32 s82, 0
Lnon_48:
    v_readfirstlane_b32 s80, v12
    v_readfirstlane_b32 s81, v13
    s_add_u32 s82, s82, 1
    s_bitcmp1_b32 s80, 0
    s_cbranch_scc1 Lnond_49
    s_cmp_gt_u32 s82, 20000
    s_cbranch_scc1 Lnond_49
    s_sleep 4
    global_load_dwordx2 v[12:13], v1, s[46:47] sc1
    s_waitcnt vmcnt(0)
    s_branch Lnon_48
Lnond_49:
    s_branch L_b_5
L_p_fin:
    v_mov_b32 v1, 0
    global_load_dwordx2 v[12:13], v1, s[46:47] sc1
    s_mul_i32 s12, s4, 5248
    v_and_b32 v40, 31, v0
    v_lshrrev_b32 v41, 5, v0
    v_bfrev_b32 v44, 1
    s_cmp_eq_u32 s5, 1
    s_cbranch_scc1 L_b_PV
    s_lshl_b32 s13, s10, 10
    s_add_u32 s13, s13, s12
    v_lshlrev_b32 v42, 3, v0
    v_cmp_gt_u32 vcc, 32, v0
    s_lshl_b32 s14, s10, 8
    s_add_u32 s14, s14, s12
    v_cndmask_b32 v42, v44, v42, vcc
    s_barrier
    ds_read_b128 v[16:19], v15 offset:0
    ds_read_b128 v[20:23], v15 offset:1024
    ds_read_b128 v[24:27], v15 offset:2048
    ds_read_b128 v[28:31], v15 offset:3072
    s_waitcnt lgkmcnt(0)
    v_add_f32 v80, v80, v16
    v_add_f32 v81, v81, v17
    v_add_f32 v82, v82, v18
    v_add_f32 v83, v83, v19
    v_add_f32 v84, v84, v20
    v_add_f32 v85, v85, v21
    v_add_f32 v86, v86, v22
    v_add_f32 v87, v87, v23
    v_add_f32 v88, v88, v24
    v_add_f32 v89, v89, v25
    v_add_f32 v90, v90, v26
    v_add_f32 v91, v91, v27
    v_cvt_pk_bf16_f32 v32, v80, v81
    v_cvt_pk_bf16_f32 v33, v82, v83
    v_cvt_pk_bf16_f32 v34, v84, v85
    v_cvt_pk_bf16_f32 v35, v86, v87
    v_cvt_pk_bf16_f32 v36, v88, v89
    v_cvt_pk_bf16_f32 v37, v90, v91
    buffer_store_dwordx4 v[32:35], v8, s[64:67], s13 offen sc1
    buffer_store_dwordx2 v[36:37], v42, s[64:67], s14 offen offset:2048 sc1
    s_branch L_p_2
L_b_PV:
    s_mul_i32 s13, s10, 1344
    s_add_u32 s13, s13, s12
    v_mul_u32_u24 v42, 0x150, v41
    v_lshl_add_u32 v42, v40, 4, v42
    v_cmp_gt_u32 vcc, 21, v40
    v_mov_b32 v43, 0x3f803f80
    s_nop 0
    v_cndmask_b32 v42, v44, v42, vcc
    v_cmp_eq_u32 vcc, 20, v40
    s_barrier
    ds_read_b128 v[16:19], v15 offset:0
    ds_read_b128 v[20:23], v15 offset:1024
    ds_read_b128 v[24:27], v15 offset:2048
    ds_read_b128 v[28:31], v15 offset:3072
    s_waitcnt lgkmcnt(0)
    v_add_f32 v80, v80, v16
    v_add_f32 v81, v81, v17
    v_add_f32 v82, v82, v18
    v_add_f32 v83, v83, v19
    v_add_f32 v84, v84, v20
    v_add_f32 v85, v85, v21
    v_add_f32 v86, v86, v22
    v_add_f32 v87, v87, v23
    v_add_f32 v88, v88, v24
    v_add_f32 v89, v89, v25
    v_add_f32 v90, v90, v26
    v_add_f32 v91, v91, v27
    v_add_f32 v92, v92, v28
    v_add_f32 v93, v93, v29
    v_add_f32 v94, v94, v30
    v_add_f32 v95, v95, v31
    v_cvt_pk_bf16_f32 v32, v80, v81
    v_cvt_pk_bf16_f32 v33, v82, v83
    v_cvt_pk_bf16_f32 v34, v84, v85
    v_cvt_pk_bf16_f32 v35, v86, v87
    v_cvt_pk_bf16_f32 v36, v88, v89
    v_cvt_pk_bf16_f32 v37, v90, v91
    v_cvt_pk_bf16_f32 v38, v92, v93
    v_cvt_pk_bf16_f32 v39, v94, v95
    v_cndmask_b32 v32, v32, v43, vcc
    v_cndmask_b32 v33, v33, v43, vcc
    v_cndmask_b32 v34, v34, v43, vcc
    v_cndmask_b32 v35, v35, v43, vcc
    v_cndmask_b32 v36, v36, v43, vcc
    v_cndmask_b32 v37, v37, v43, vcc
    v_cndmask_b32 v38, v38, v43, vcc
    v_cndmask_b32 v39, v39, v43, vcc
    buffer_store_dwordx4 v[32:35], v42, s[64:67], s13 offen offset:2560 sc1
    buffer_store_dwordx4 v[36:39], v42, s[64:67], s13 offen offset:3232 sc1
L_p_2:
    s_lshl_b32 s12, s4, 9
    s_lshl_b32 s13, s5, 8
    s_add_u32 s12, s12, s13
    s_lshl_b32 s13, s10, 7
    s_add_u32 s12, s12, s13
    s_add_u32 s12, s12, 5767168
    v_mov_b64 v[80:81], 0
    v_mov_b64 v[82:83], 0
    v_mov_b64 v[84:85], 0
    v_mov_b64 v[86:87], 0
    v_mov_b64 v[88:89], 0
    v_mov_b64 v[90:91], 0
    v_mov_b64 v[92:93], 0
    v_mov_b64 v[94:95], 0
    v_mov_b64 v[96:97], 0
    v_mov_b64 v[98:99], 0
    v_mov_b64 v[100:101], 0
    v_mov_b64 v[102:103], 0
    v_mov_b64 v[104:105], 0
    v_mov_b64 v[106:107], 0
    v_mov_b64 v[108:109], 0
    v_mov_b64 v[110:111], 0
    v_lshlrev_b32 v40, 14, v0
    s_waitcnt vmcnt(0)
    s_mov_b32 s82, 0
Lnon_50:
    v_readfirstlane_b32 s80, v12
    v_readfirstlane_b32 s81, v13
    s_add_u32 s82, s82, 1
    s_bitcmp1_b32 s80, 0
    s_cbranch_scc1 Lnond_51
    s_cmp_gt_u32 s82, 20000
    s_cbranch_scc1 Lnond_51
    s_sleep 4
    global_load_dwordx2 v[12:13], v1, s[46:47] sc1
    s_waitcnt vmcnt(0)
    s_branch Lnon_50
Lnond_51:
    s_mov_b64 exec, 0xff
    buffer_store_dwordx2 v[12:13], v40, s[64:67], s12 offen sc1
    s_mov_b64 exec, -1
L_b_5:
    v_mov_b32 v2, 0x30000
    v_mov_b32 v3, 0x30000
    v_mov_b32 v6, 0x30000
    v_mov_b32 v7, 0x30000
L_b_6:
    s_and_b32 s10, s3, 3
    s_mul_i32 s13, s10, 2560
    s_add_u32 s13, s13, 90112
    v_add_u32 v12, s13, v8
    v_lshl_add_u32 v13, v0, 3, s13
    s_waitcnt lgkmcnt(0)
    s_barrier
    ds_read_b64 v[120:121], v13 offset:2048
    ds_read_b128 v[112:115], v12
    ds_read_b128 v[116:119], v12 offset:1024
    ds_read_b64 v[122:123], v148 offset:0
    ds_read_b128 v[124:127], v145 offset:0
    ds_read_b128 v[128:131], v151 offset:0
    ds_read_b128 v[132:135], v151 offset:672
    s_waitcnt lgkmcnt(2)
    v_mfma_f32_32x32x4_2b_bf16 v[16:47], v[122:123], v[120:121], 0 cbsz:1 abid:0
    s_nop 15
    s_nop 1
    v_mfma_f32_32x32x16_bf16 v[16:31], v[124:127], v[112:115], v[16:31]
    v_mfma_f32_32x32x16_bf16 v[32:47], v[124:127], v[116:119], v[32:47]
    ds_read_b128 v[124:127], v145 offset:1024
    s_waitcnt lgkmcnt(1)
    s_nop 9
    s_setprio 3
    v_exp_f32 v16, v16
    v_exp_f32 v17, v17
    ds_read_b128 v[136:139], v151 offset:1344
    s_cmp_eq_u32 s3, 0
    s_cbranch_scc0 Lx_52
    s_mov_b32 m0, 82944
    s_mov_b32 s12, 82944
    buffer_load_dwordx4 v8, s[64:67], s12 offen sc1 lds
Lx_52:
    v_exp_f32 v18, v18
    v_exp_f32 v19, v19
    v_exp_f32 v20, v20
    v_exp_f32 v21, v21
    v_mfma_f32_32x32x4_2b_bf16 v[48:79], v[122:123], v[120:121], 0 cbsz:1 abid:1
    s_add_u32 m0, s51, 41984
    s_add_u32 s12, s51, 41984
    buffer_load_dwordx4 v8, s[64:67], s12 offen sc1 lds
    v_exp_f32 v22, v22
    v_exp_f32 v23, v23
    v_exp_f32 v24, v24
    v_exp_f32 v25, v25
    v_exp_f32 v26, v26
    v_exp_f32 v27, v27
    v_exp_f32 v28, v28
    v_exp_f32 v29, v29
    v_smfmac_f32_32x32x32_bf16 v[80:95], v[128:131], v[16:23], v144
    ds_read_b128 v[140:143], v151 offset:2016
    v_exp_f32 v30, v30
    v_exp_f32 v31, v31
    v_exp_f32 v32, v32
    v_exp_f32 v33, v33
    v_smfmac_f32_32x32x32_bf16 v[80:95], v[132:135], v[24:31], v144
    s_waitcnt lgkmcnt(2)
    ds_read_b64 v[122:123], v148 offset:10496
    v_exp_f32 v34, v34
    v_exp_f32 v35, v35
    v_exp_f32 v36, v36
    v_exp_f32 v37, v37
    v_mfma_f32_32x32x16_bf16 v[48:63], v[124:127], v[112:115], v[48:63]
    s_add_u32 m0, s51, 50176
    s_add_u32 s12, s51, 50176
    buffer_load_dwordx4 v8, s[64:67], s12 offen sc1 lds
    v_exp_f32 v38, v38
    v_exp_f32 v39, v39
    v_exp_f32 v40, v40
    v_exp_f32 v41, v41
    v_mfma_f32_32x32x16_bf16 v[64:79], v[124:127], v[116:119], v[64:79]
    ds_read_b128 v[124:127], v145 offset:10496
    s_setprio 2
    v_exp_f32 v42, v42
    v_exp_f32 v43, v43
    v_exp_f32 v44, v44
    v_exp_f32 v45, v45
    v_smfmac_f32_32x32x32_bf16 v[96:111], v[128:131], v[32:39], v144
    s_waitcnt lgkmcnt(1)
    v_exp_f32 v46, v46
    v_exp_f32 v47, v47
    v_exp_f32 v48, v48
    v_exp_f32 v49, v49
    v_smfmac_f32_32x32x32_bf16 v[96:111], v[132:135], v[40:47], v144
    ds_read_b128 v[128:131], v151 offset:10496
    s_add_u32 m0, s51, 58368
    s_add_u32 s12, s51, 58368
    buffer_load_dwordx4 v8, s[64:67], s12 offen sc1 lds
    v_exp_f32 v50, v50
    v_exp_f32 v51, v51
    v_exp_f32 v52, v52
    v_exp_f32 v53, v53
    v_mfma_f32_32x32x4_2b_bf16 v[16:47], v[122:123], v[120:121], 0 cbsz:1 abid:0
    s_add_u32 m0, s51, 66560
    s_add_u32 s12, s51, 66560
    buffer_load_dwordx4 v8, s[64:67], s12 offen sc1 lds
    v_exp_f32 v54, v54
    v_exp_f32 v55, v55
    v_exp_f32 v56, v56
    v_exp_f32 v57, v57
    v_exp_f32 v58, v58
    v_exp_f32 v59, v59
    v_exp_f32 v60, v60
    v_exp_f32 v61, v61
    v_smfmac_f32_32x32x32_bf16 v[80:95], v[136:139], v[48:55], v144
    ds_read_b128 v[132:135], v151 offset:11168
    v_exp_f32 v62, v62
    v_exp_f32 v63, v63
    v_exp_f32 v64, v64
    v_exp_f32 v65, v65
    v_smfmac_f32_32x32x32_bf16 v[80:95], v[140:143], v[56:63], v144
    s_waitcnt lgkmcnt(2)
    v_exp_f32 v66, v66
    v_exp_f32 v67, v67
    v_exp_f32 v68, v68
    v_exp_f32 v69, v69
    v_mfma_f32_32x32x16_bf16 v[16:31], v[124:127], v[112:115], v[16:31]
    s_add_u32 m0, s51, 74752
    s_add_u32 s12, s51, 74752
    buffer_load_dwordx4 v8, s[64:67], s12 offen sc1 lds
    v_exp_f32 v70, v70
    v_exp_f32 v71, v71
    v_exp_f32 v72, v72
    v_exp_f32 v73, v73
    v_mfma_f32_32x32x16_bf16 v[32:47], v[124:127], v[116:119], v[32:47]
    ds_read_b128 v[124:127], v145 offset:11520
    v_exp_f32 v74, v74
    v_exp_f32 v75, v75
    v_exp_f32 v76, v76
    v_exp_f32 v77, v77
    v_smfmac_f32_32x32x32_bf16 v[96:111], v[136:139], v[64:71], v144
    s_waitcnt lgkmcnt(1)
    s_barrier
    s_setprio 3
    v_exp_f32 v78, v78
    v_exp_f32 v79, v79
    v_exp_f32 v16, v16
    v_exp_f32 v17, v17
    v_smfmac_f32_32x32x32_bf16 v[96:111], v[140:143], v[72:79], v144
    ds_read_b128 v[136:139], v151 offset:11840
    s_cmp_eq_u32 s3, 0
    s_cbranch_scc0 Lx_53
    s_mov_b32 m0, 124928
    s_mov_b32 s12, 124928
    buffer_load_dwordx4 v8, s[64:67], s12 offen sc1 lds
Lx_53:
    v_exp_f32 v18, v18
    v_exp_f32 v19, v19
    v_exp_f32 v20, v20
    v_exp_f32 v21, v21
    v_mfma_f32_32x32x4_2b_bf16 v[48:79], v[122:123], v[120:121], 0 cbsz:1 abid:1
    s_add_u32 m0, s51, 83968
    s_add_u32 s12, s51, 83968
    buffer_load_dwordx4 v8, s[64:67], s12 offen sc1 lds
    v_exp_f32 v22, v22
    v_exp_f32 v23, v23
    v_exp_f32 v24, v24
    v_exp_f32 v25, v25
    v_exp_f32 v26, v26
    v_exp_f32 v27, v27
    v_exp_f32 v28, v28
    v_exp_f32 v29, v29
    v_smfmac_f32_32x32x32_bf16 v[80:95], v[128:131], v[16:23], v144
    ds_read_b128 v[140:143], v151 offset:12512
    v_exp_f32 v30, v30
    v_exp_f32 v31, v31
    v_exp_f32 v32, v32
    v_exp_f32 v33, v33
    v_smfmac_f32_32x32x32_bf16 v[80:95], v[132:135], v[24:31], v144
    s_waitcnt lgkmcnt(2)
    ds_read_b64 v[122:123], v148 offset:20992
    v_exp_f32 v34, v34
    v_exp_f32 v35, v35
    v_exp_f32 v36, v36
    v_exp_f32 v37, v37
    v_mfma_f32_32x32x16_bf16 v[48:63], v[124:127], v[112:115], v[48:63]
    s_add_u32 m0, s51, 92160
    s_add_u32 s12, s51, 92160
    buffer_load_dwordx4 v8, s[64:67], s12 offen sc1 lds
    v_exp_f32 v38, v38
    v_exp_f32 v39, v39
    v_exp_f32 v40, v40
    v_exp_f32 v41, v41
    v_mfma_f32_32x32x16_bf16 v[64:79], v[124:127], v[116:119], v[64:79]
    ds_read_b128 v[124:127], v145 offset:20992
    s_setprio 2
    v_exp_f32 v42, v42
    v_exp_f32 v43, v43
    v_exp_f32 v44, v44
    v_exp_f32 v45, v45
    v_smfmac_f32_32x32x32_bf16 v[96:111], v[128:131], v[32:39], v144
    s_waitcnt lgkmcnt(1)
    v_exp_f32 v46, v46
    v_exp_f32 v47, v47
    v_exp_f32 v48, v48
    v_exp_f32 v49, v49
    v_smfmac_f32_32x32x32_bf16 v[96:111], v[132:135], v[40:47], v144
    ds_read_b128 v[128:131], v151 offset:20992
    s_add_u32 m0, s51, 100352
    s_add_u32 s12, s51, 100352
    buffer_load_dwordx4 v8, s[64:67], s12 offen sc1 lds
    v_exp_f32 v50, v50
    v_exp_f32 v51, v51
    v_exp_f32 v52, v52
    v_exp_f32 v53, v53
    v_mfma_f32_32x32x4_2b_bf16 v[16:47], v[122:123], v[120:121], 0 cbsz:1 abid:0
    s_add_u32 m0, s51, 108544
    s_add_u32 s12, s51, 108544
    buffer_load_dwordx4 v8, s[64:67], s12 offen sc1 lds
    ds_write_b128 v2, v[224:227]
    v_exp_f32 v54, v54
    v_exp_f32 v55, v55
    v_exp_f32 v56, v56
    v_exp_f32 v57, v57
    v_exp_f32 v58, v58
    v_exp_f32 v59, v59
    v_exp_f32 v60, v60
    v_exp_f32 v61, v61
    v_smfmac_f32_32x32x32_bf16 v[80:95], v[136:139], v[48:55], v144
    ds_read_b128 v[132:135], v151 offset:21664
    v_exp_f32 v62, v62
    v_exp_f32 v63, v63
    v_exp_f32 v64, v64
    v_exp_f32 v65, v65
    v_smfmac_f32_32x32x32_bf16 v[80:95], v[140:143], v[56:63], v144
    s_waitcnt lgkmcnt(3)
    v_exp_f32 v66, v66
    v_exp_f32 v67, v67
    v_exp_f32 v68, v68
    v_exp_f32 v69, v69
    v_mfma_f32_32x32x16_bf16 v[16:31], v[124:127], v[112:115], v[16:31]
    s_add_u32 m0, s51, 116736
    s_add_u32 s12, s51, 116736
    buffer_load_dwordx4 v8, s[64:67], s12 offen sc1 lds
    v_exp_f32 v70, v70
    v_exp_f32 v71, v71
    v_exp_f32 v72, v72
    v_exp_f32 v73, v73
    v_mfma_f32_32x32x16_bf16 v[32:47], v[124:127], v[116:119], v[32:47]
    ds_read_b128 v[124:127], v145 offset:22016
    s_setprio 1
    v_exp_f32 v74, v74
    v_exp_f32 v75, v75
    v_exp_f32 v76, v76
    v_exp_f32 v77, v77
    v_smfmac_f32_32x32x32_bf16 v[96:111], v[136:139], v[64:71], v144
    s_waitcnt lgkmcnt(1)
    v_exp_f32 v78, v78
    v_exp_f32 v79, v79
    v_exp_f32 v16, v16
    v_exp_f32 v17, v17
    v_smfmac_f32_32x32x32_bf16 v[96:111], v[140:143], v[72:79], v144
    ds_read_b128 v[136:139], v151 offset:22336
    buffer_store_dwordx4 v[196:199], v250, s[64:67], s90 offen sc1
    v_exp_f32 v18, v18
    v_exp_f32 v19, v19
    v_exp_f32 v20, v20
    v_exp_f32 v21, v21
    v_mfma_f32_32x32x4_2b_bf16 v[48:79], v[122:123], v[120:121], 0 cbsz:1 abid:1
    ds_write_b128 v2, v[228:231] offset:16
    v_exp_f32 v22, v22
    v_exp_f32 v23, v23
    v_exp_f32 v24, v24
    v_exp_f32 v25, v25
    v_exp_f32 v26, v26
    v_exp_f32 v27, v27
    v_exp_f32 v28, v28
    v_exp_f32 v29, v29
    v_smfmac_f32_32x32x32_bf16 v[80:95], v[128:131], v[16:23], v144
    ds_read_b128 v[140:143], v151 offset:23008
    buffer_store_dwordx4 v[200:203], v250, s[64:67], s90 offen offset:2112 sc1
    v_exp_f32 v30, v30
    v_exp_f32 v31, v31
    v_exp_f32 v32, v32
    v_exp_f32 v33, v33
    v_smfmac_f32_32x32x32_bf16 v[80:95], v[132:135], v[24:31], v144
    s_waitcnt lgkmcnt(3)
    ds_read_b64 v[122:123], v148 offset:31488
    v_exp_f32 v34, v34
    v_exp_f32 v35, v35
    v_exp_f32 v36, v36
    v_exp_f32 v37, v37
    v_mfma_f32_32x32x16_bf16 v[48:63], v[124:127], v[112:115], v[48:63]
    buffer_store_dwordx2 v[204:205], v251, s[64:67], s90 offen sc1
    v_exp_f32 v38, v38
    v_exp_f32 v39, v39
    v_exp_f32 v40, v40
    v_exp_f32 v41, v41
    v_mfma_f32_32x32x16_bf16 v[64:79], v[124:127], v[116:119], v[64:79]
    ds_read_b128 v[124:127], v145 offset:31488
    s_setprio 0
    v_exp_f32 v42, v42
    v_exp_f32 v43, v43
    v_exp_f32 v44, v44
    v_exp_f32 v45, v45
    v_smfmac_f32_32x32x32_bf16 v[96:111], v[128:131], v[32:39], v144
    s_waitcnt lgkmcnt(1)
    v_exp_f32 v46, v46
    v_exp_f32 v47, v47
    v_exp_f32 v48, v48
    v_exp_f32 v49, v49
    v_smfmac_f32_32x32x32_bf16 v[96:111], v[132:135], v[40:47], v144
    ds_read_b128 v[128:131], v151 offset:31488
    buffer_store_dwordx2 v[206:207], v251, s[64:67], s90 offen offset:2112 sc1
    v_mov_b32 v220, s80
    v_mov_b32 v221, s81
    v_exp_f32 v50, v50
    v_exp_f32 v51, v51
    v_exp_f32 v52, v52
    v_exp_f32 v53, v53
    v_mfma_f32_32x32x4_2b_bf16 v[16:47], v[122:123], v[120:121], 0 cbsz:1 abid:0
    buffer_store_dwordx2 v[208:209], v251, s[64:67], s90 offen offset:512 sc1
    ds_write_b128 v2, v[232:235] offset:4160
    v_exp_f32 v54, v54
    v_exp_f32 v55, v55
    v_exp_f32 v56, v56
    v_exp_f32 v57, v57
    v_exp_f32 v58, v58
    v_exp_f32 v59, v59
    v_exp_f32 v60, v60
    v_exp_f32 v61, v61
    v_smfmac_f32_32x32x32_bf16 v[80:95], v[136:139], v[48:55], v144
    ds_read_b128 v[132:135], v151 offset:32160
    buffer_store_dwordx2 v[210:211], v251, s[64:67], s90 offen offset:2624 sc1
    v_exp_f32 v62, v62
    v_exp_f32 v63, v63
    v_exp_f32 v64, v64
    v_exp_f32 v65, v65
    v_smfmac_f32_32x32x32_bf16 v[80:95], v[140:143], v[56:63], v144
    s_waitcnt lgkmcnt(3)
    v_exp_f32 v66, v66
    v_exp_f32 v67, v67
    v_exp_f32 v68, v68
    v_exp_f32 v69, v69
    v_mfma_f32_32x32x16_bf16 v[16:31], v[124:127], v[112:115], v[16:31]
    buffer_store_dword v4, v252, s[64:67], s90 offen offset:2048 sc1
    v_exp_f32 v70, v70
    v_exp_f32 v71, v71
    v_exp_f32 v72, v72
    v_exp_f32 v73, v73
    v_mfma_f32_32x32x16_bf16 v[32:47], v[124:127], v[116:119], v[32:47]
    ds_read_b128 v[124:127], v145 offset:32512
    v_exp_f32 v74, v74
    v_exp_f32 v75, v75
    v_exp_f32 v76, v76
    v_exp_f32 v77, v77
    v_smfmac_f32_32x32x32_bf16 v[96:111], v[136:139], v[64:71], v144
    s_waitcnt vmcnt(7) lgkmcnt(0)
    s_barrier
    s_setprio 3
    v_exp_f32 v78, v78
    v_exp_f32 v79, v79
    v_exp_f32 v16, v16
    v_exp_f32 v17, v17
    v_smfmac_f32_32x32x32_bf16 v[96:111], v[140:143], v[72:79], v144
    ds_read_b128 v[136:139], v151 offset:32832
    s_lshl_b32 s13, s10, 4
    s_lshr_b64 s[92:93], s[92:93], s13
    s_lshr_b64 s[94:95], s[94:95], s13
    s_and_b32 s92, s92, 0xffff
    s_and_b32 s94, s94, 0xffff
    v_and_b32 v10, 1, v0
    v_lshlrev_b32 v10, 4, v10
    v_exp_f32 v18, v18
    v_exp_f32 v19, v19
    v_exp_f32 v20, v20
    v_exp_f32 v21, v21
    v_mfma_f32_32x32x4_2b_bf16 v[48:79], v[122:123], v[120:121], 0 cbsz:1 abid:1
    ds_write_b128 v2, v[236:239] offset:4176
    v_exp_f32 v22, v22
    v_exp_f32 v23, v23
    v_exp_f32 v24, v24
    v_exp_f32 v25, v25
    v_exp_f32 v26, v26
    v_exp_f32 v27, v27
    v_exp_f32 v28, v28
    v_exp_f32 v29, v29
    v_smfmac_f32_32x32x32_bf16 v[80:95], v[128:131], v[16:23], v144
    ds_read_b128 v[140:143], v151 offset:33504
    v_lshlrev_b32 v11, v10, s94
    v_lshlrev_b32 v10, v10, s92
    s_mov_b32 vcc_lo, 0
    v_exp_f32 v30, v30
    v_exp_f32 v31, v31
    v_exp_f32 v32, v32
    v_exp_f32 v33, v33
    v_smfmac_f32_32x32x32_bf16 v[80:95], v[132:135], v[24:31], v144
    s_waitcnt lgkmcnt(3)
    ds_read_b64 v[122:123], v149 offset:0
    v_exp_f32 v34, v34
    v_exp_f32 v35, v35
    v_exp_f32 v36, v36
    v_exp_f32 v37, v37
    v_mfma_f32_32x32x16_bf16 v[48:63], v[124:127], v[112:115], v[48:63]
    s_add_u32 m0, s51, 0
    s_add_u32 s12, s51, 125952
    buffer_load_dwordx4 v8, s[64:67], s12 offen sc1 lds
    v_exp_f32 v38, v38
    v_exp_f32 v39, v39
    v_exp_f32 v40, v40
    v_exp_f32 v41, v41
    v_mfma_f32_32x32x16_bf16 v[64:79], v[124:127], v[116:119], v[64:79]
    ds_read_b128 v[124:127], v146 offset:0
    v_exp_f32 v42, v42
    v_exp_f32 v43, v43
    v_exp_f32 v44, v44
    v_exp_f32 v45, v45
    v_smfmac_f32_32x32x32_bf16 v[96:111], v[128:131], v[32:39], v144
    s_waitcnt lgkmcnt(1)
    v_exp_f32 v46, v46
    v_exp_f32 v47, v47
    v_exp_f32 v48, v48
    v_exp_f32 v49, v49
    v_smfmac_f32_32x32x32_bf16 v[96:111], v[132:135], v[40:47], v144
    ds_read_b128 v[128:131], v152 offset:0
    s_mov_b32 vcc_hi, 0x3000003
    v_cndmask_b32 v192, 0, v10, vcc
    v_cndmask_b32 v212, 0, v11, vcc
    v_exp_f32 v50, v50
    v_exp_f32 v51, v51
    v_exp_f32 v52, v52
    v_exp_f32 v53, v53
    v_mfma_f32_32x32x4_2b_bf16 v[16:47], v[122:123], v[120:121], 0 cbsz:1 abid:0
    ds_write_b128 v3, v[196:199]
    v_exp_f32 v54, v54
    v_exp_f32 v55, v55
    v_exp_f32 v56, v56
    v_exp_f32 v57, v57
    v_exp_f32 v58, v58
    v_exp_f32 v59, v59
    v_exp_f32 v60, v60
    v_exp_f32 v61, v61
    v_smfmac_f32_32x32x32_bf16 v[80:95], v[136:139], v[48:55], v144
    ds_read_b128 v[132:135], v152 offset:672
    s_mov_b32 vcc_hi, 0xc00000c
    v_cndmask_b32 v193, 0, v10, vcc
    v_cndmask_b32 v213, 0, v11, vcc
    v_exp_f32 v62, v62
    v_exp_f32 v63, v63
    v_exp_f32 v64, v64
    v_exp_f32 v65, v65
    v_smfmac_f32_32x32x32_bf16 v[80:95], v[140:143], v[56:63], v144
    s_waitcnt lgkmcnt(3)
    v_exp_f32 v66, v66
    v_exp_f32 v67, v67
    v_exp_f32 v68, v68
    v_exp_f32 v69, v69
    v_mfma_f32_32x32x16_bf16 v[16:31], v[124:127], v[112:115], v[16:31]
    s_add_u32 m0, s51, 8192
    s_add_u32 s12, s51, 134144
    buffer_load_dwordx4 v8, s[64:67], s12 offen sc1 lds
    v_exp_f32 v70, v70
    v_exp_f32 v71, v71
    v_exp_f32 v72, v72
    v_exp_f32 v73, v73
    v_mfma_f32_32x32x16_bf16 v[32:47], v[124:127], v[116:119], v[32:47]
    ds_read_b128 v[124:127], v146 offset:1024
    v_exp_f32 v74, v74
    v_exp_f32 v75, v75
    v_exp_f32 v76, v76
    v_exp_f32 v77, v77
    v_smfmac_f32_32x32x32_bf16 v[96:111], v[136:139], v[64:71], v144
    s_waitcnt lgkmcnt(1)
    v_exp_f32 v78, v78
    v_exp_f32 v79, v79
    v_exp_f32 v16, v16
    v_exp_f32 v17, v17
    v_smfmac_f32_32x32x32_bf16 v[96:111], v[140:143], v[72:79], v144
    ds_read_b128 v[136:139], v152 offset:1344
    s_mov_b32 vcc_hi, 0x30000030
    v_cndmask_b32 v194, 0, v10, vcc
    v_cndmask_b32 v214, 0, v11, vcc
    v_exp_f32 v18, v18
    v_exp_f32 v19, v19
    v_exp_f32 v20, v20
    v_exp_f32 v21, v21
    v_mfma_f32_32x32x4_2b_bf16 v[48:79], v[122:123], v[120:121], 0 cbsz:1 abid:1
    ds_write_b128 v3, v[200:203] offset:4160
    v_exp_f32 v22, v22
    v_exp_f32 v23, v23
    v_exp_f32 v24, v24
    v_exp_f32 v25, v25
    v_exp_f32 v26, v26
    v_exp_f32 v27, v27
    v_exp_f32 v28, v28
    v_exp_f32 v29, v29
    v_smfmac_f32_32x32x32_bf16 v[80:95], v[128:131], v[16:23], v144
    ds_read_b128 v[140:143], v152 offset:2016
    s_mov_b32 vcc_hi, 0xc00000c0
    v_cndmask_b32 v195, 0, v10, vcc
    v_cndmask_b32 v215, 0, v11, vcc
    v_exp_f32 v30, v30
    v_exp_f32 v31, v31
    v_exp_f32 v32, v32
    v_exp_f32 v33, v33
    v_smfmac_f32_32x32x32_bf16 v[80:95], v[132:135], v[24:31], v144
    s_waitcnt lgkmcnt(3)
    ds_read_b64 v[122:123], v149 offset:10496
    v_exp_f32 v34, v34
    v_exp_f32 v35, v35
    v_exp_f32 v36, v36
    v_exp_f32 v37, v37
    v_mfma_f32_32x32x16_bf16 v[48:63], v[124:127], v[112:115], v[48:63]
    s_add_u32 m0, s51, 16384
    s_add_u32 s12, s51, 142336
    buffer_load_dwordx4 v8, s[64:67], s12 offen sc1 lds
    v_exp_f32 v38, v38
    v_exp_f32 v39, v39
    v_exp_f32 v40, v40
    v_exp_f32 v41, v41
    v_mfma_f32_32x32x16_bf16 v[64:79], v[124:127], v[116:119], v[64:79]
    ds_read_b128 v[124:127], v146 offset:10496
    s_setprio 2
    v_exp_f32 v42, v42
    v_exp_f32 v43, v43
    v_exp_f32 v44, v44
    v_exp_f32 v45, v45
    v_smfmac_f32_32x32x32_bf16 v[96:111], v[128:131], v[32:39], v144
    s_waitcnt lgkmcnt(1)
    v_exp_f32 v46, v46
    v_exp_f32 v47, v47
    v_exp_f32 v48, v48
    v_exp_f32 v49, v49
    v_smfmac_f32_32x32x32_bf16 v[96:111], v[132:135], v[40:47], v144
    s_waitcnt vmcnt(3)
    buffer_store_dwordx2 v[220:221], v248, s[64:67], s91 offen sc1
    ds_read_b128 v[128:131], v152 offset:10496
    v_exp_f32 v50, v50
    v_exp_f32 v51, v51
    v_exp_f32 v52, v52
    v_exp_f32 v53, v53
    v_mfma_f32_32x32x4_2b_bf16 v[16:47], v[122:123], v[120:121], 0 cbsz:1 abid:0
    ds_write_b64 v6, v[204:205]
    v_exp_f32 v54, v54
    v_exp_f32 v55, v55
    v_exp_f32 v56, v56
    v_exp_f32 v57, v57
    v_exp_f32 v58, v58
    v_exp_f32 v59, v59
    v_exp_f32 v60, v60
    v_exp_f32 v61, v61
    v_smfmac_f32_32x32x32_bf16 v[80:95], v[136:139], v[48:55], v144
    ds_read_b128 v[132:135], v152 offset:11168
    v_exp_f32 v62, v62
    v_exp_f32 v63, v63
    v_exp_f32 v64, v64
    v_exp_f32 v65, v65
    v_smfmac_f32_32x32x32_bf16 v[80:95], v[140:143], v[56:63], v144
    s_waitcnt lgkmcnt(3)
    v_exp_f32 v66, v66
    v_exp_f32 v67, v67
    v_exp_f32 v68, v68
    v_exp_f32 v69, v69
    v_mfma_f32_32x32x16_bf16 v[16:31], v[124:127], v[112:115], v[16:31]
    s_add_u32 m0, s51, 24576
    s_add_u32 s12, s51, 150528
    buffer_load_dwordx4 v8, s[64:67], s12 offen sc1 lds
    v_exp_f32 v70, v70
    v_exp_f32 v71, v71
    v_exp_f32 v72, v72
    v_exp_f32 v73, v73
    v_mfma_f32_32x32x16_bf16 v[32:47], v[124:127], v[116:119], v[32:47]
    ds_read_b128 v[124:127], v146 offset:11520
    v_exp_f32 v74, v74
    v_exp_f32 v75, v75
    v_exp_f32 v76, v76
    v_exp_f32 v77, v77
    v_smfmac_f32_32x32x32_bf16 v[96:111], v[136:139], v[64:71], v144
    s_waitcnt lgkmcnt(1)
    v_exp_f32 v78, v78
    v_exp_f32 v79, v79
    v_exp_f32 v16, v16
    v_exp_f32 v17, v17
    v_smfmac_f32_32x32x32_bf16 v[96:111], v[140:143], v[72:79], v144
    ds_read_b128 v[136:139], v152 offset:11840
    v_exp_f32 v18, v18
    v_exp_f32 v19, v19
    v_exp_f32 v20, v20
    v_exp_f32 v21, v21
    v_mfma_f32_32x32x4_2b_bf16 v[48:79], v[122:123], v[120:121], 0 cbsz:1 abid:1
    ds_write_b64 v6, v[206:207] offset:4160
    v_exp_f32 v22, v22
    v_exp_f32 v23, v23
    v_exp_f32 v24, v24
    v_exp_f32 v25, v25
    v_exp_f32 v26, v26
    v_exp_f32 v27, v27
    v_exp_f32 v28, v28
    v_exp_f32 v29, v29
    v_smfmac_f32_32x32x32_bf16 v[80:95], v[128:131], v[16:23], v144
    ds_read_b128 v[140:143], v152 offset:12512
    v_exp_f32 v30, v30
    v_exp_f32 v31, v31
    v_exp_f32 v32, v32
    v_exp_f32 v33, v33
    v_smfmac_f32_32x32x32_bf16 v[80:95], v[132:135], v[24:31], v144
    s_waitcnt lgkmcnt(3)
    ds_read_b64 v[122:123], v149 offset:20992
    v_exp_f32 v34, v34
    v_exp_f32 v35, v35
    v_exp_f32 v36, v36
    v_exp_f32 v37, v37
    v_mfma_f32_32x32x16_bf16 v[48:63], v[124:127], v[112:115], v[48:63]
    buffer_load_dword v255, v154, s[76:79], 0 offen
    v_exp_f32 v38, v38
    v_exp_f32 v39, v39
    v_exp_f32 v40, v40
    v_exp_f32 v41, v41
    v_mfma_f32_32x32x16_bf16 v[64:79], v[124:127], v[116:119], v[64:79]
    ds_read_b128 v[124:127], v146 offset:20992
    s_setprio 1
    v_exp_f32 v42, v42
    v_exp_f32 v43, v43
    v_exp_f32 v44, v44
    v_exp_f32 v45, v45
    v_smfmac_f32_32x32x32_bf16 v[96:111], v[128:131], v[32:39], v144
    s_waitcnt lgkmcnt(1)
    v_exp_f32 v46, v46
    v_exp_f32 v47, v47
    v_exp_f32 v48, v48
    v_exp_f32 v49, v49
    v_smfmac_f32_32x32x32_bf16 v[96:111], v[132:135], v[40:47], v144
    ds_read_b128 v[128:131], v152 offset:20992
    v_exp_f32 v50, v50
    v_exp_f32 v51, v51
    v_exp_f32 v52, v52
    v_exp_f32 v53, v53
    v_mfma_f32_32x32x4_2b_bf16 v[16:47], v[122:123], v[120:121], 0 cbsz:1 abid:0
    ds_write_b64 v6, v[208:209] offset:512
    v_exp_f32 v54, v54
    v_exp_f32 v55, v55
    v_exp_f32 v56, v56
    v_exp_f32 v57, v57
    v_exp_f32 v58, v58
    v_exp_f32 v59, v59
    v_exp_f32 v60, v60
    v_exp_f32 v61, v61
    v_smfmac_f32_32x32x32_bf16 v[80:95], v[136:139], v[48:55], v144
    ds_read_b128 v[132:135], v152 offset:21664
    v_exp_f32 v62, v62
    v_exp_f32 v63, v63
    v_exp_f32 v64, v64
    v_exp_f32 v65, v65
    v_smfmac_f32_32x32x32_bf16 v[80:95], v[140:143], v[56:63], v144
    s_waitcnt lgkmcnt(3)
    v_exp_f32 v66, v66
    v_exp_f32 v67, v67
    v_exp_f32 v68, v68
    v_exp_f32 v69, v69
    v_mfma_f32_32x32x16_bf16 v[16:31], v[124:127], v[112:115], v[16:31]
    v_exp_f32 v70, v70
    v_exp_f32 v71, v71
    v_exp_f32 v72, v72
    v_exp_f32 v73, v73
    v_mfma_f32_32x32x16_bf16 v[32:47], v[124:127], v[116:119], v[32:47]
    ds_read_b128 v[124:127], v146 offset:22016
    v_exp_f32 v74, v74
    v_exp_f32 v75, v75
    v_exp_f32 v76, v76
    v_exp_f32 v77, v77
    v_smfmac_f32_32x32x32_bf16 v[96:111], v[136:139], v[64:71], v144
    s_waitcnt lgkmcnt(1)
    v_exp_f32 v78, v78
    v_exp_f32 v79, v79
    v_exp_f32 v16, v16
    v_exp_f32 v17, v17
    v_smfmac_f32_32x32x32_bf16 v[96:111], v[140:143], v[72:79], v144
    ds_read_b128 v[136:139], v152 offset:22336
    v_exp_f32 v18, v18
    v_exp_f32 v19, v19
    v_exp_f32 v20, v20
    v_exp_f32 v21, v21
    v_mfma_f32_32x32x4_2b_bf16 v[48:79], v[122:123], v[120:121], 0 cbsz:1 abid:1
    ds_write_b64 v6, v[210:211] offset:4672
    v_exp_f32 v22, v22
    v_exp_f32 v23, v23
    v_exp_f32 v24, v24
    v_exp_f32 v25, v25
    v_exp_f32 v26, v26
    v_exp_f32 v27, v27
    v_exp_f32 v28, v28
    v_exp_f32 v29, v29
    v_smfmac_f32_32x32x32_bf16 v[80:95], v[128:131], v[16:23], v144
    ds_read_b128 v[140:143], v152 offset:23008
    v_exp_f32 v30, v30
    v_exp_f32 v31, v31
    v_exp_f32 v32, v32
    v_exp_f32 v33, v33
    v_smfmac_f32_32x32x32_bf16 v[80:95], v[132:135], v[24:31], v144
    s_waitcnt lgkmcnt(3)
    ds_read_b64 v[122:123], v149 offset:31488
    v_exp_f32 v34, v34
    v_exp_f32 v35, v35
    v_exp_f32 v36, v36
    v_exp_f32 v37, v37
    v_mfma_f32_32x32x16_bf16 v[48:63], v[124:127], v[112:115], v[48:63]
    v_exp_f32 v38, v38
    v_exp_f32 v39, v39
    v_exp_f32 v40, v40
    v_exp_f32 v41, v41
    v_mfma_f32_32x32x16_bf16 v[64:79], v[124:127], v[116:119], v[64:79]
    ds_read_b128 v[124:127], v146 offset:31488
    s_setprio 0
    v_exp_f32 v42, v42
    v_exp_f32 v43, v43
    v_exp_f32 v44, v44
    v_exp_f32 v45, v45
    v_smfmac_f32_32x32x32_bf16 v[96:111], v[128:131], v[32:39], v144
    s_waitcnt lgkmcnt(1)
    v_exp_f32 v46, v46
    v_exp_f32 v47, v47
    v_exp_f32 v48, v48
    v_exp_f32 v49, v49
    v_smfmac_f32_32x32x32_bf16 v[96:111], v[132:135], v[40:47], v144
    ds_read_b128 v[128:131], v152 offset:31488
    v_exp_f32 v50, v50
    v_exp_f32 v51, v51
    v_exp_f32 v52, v52
    v_exp_f32 v53, v53
    v_mfma_f32_32x32x4_2b_bf16 v[16:47], v[122:123], v[120:121], 0 cbsz:1 abid:0
    ds_write_b32 v7, v4 offset:4096
    v_exp_f32 v54, v54
    v_exp_f32 v55, v55
    v_exp_f32 v56, v56
    v_exp_f32 v57, v57
    v_exp_f32 v58, v58
    v_exp_f32 v59, v59
    v_exp_f32 v60, v60
    v_exp_f32 v61, v61
    v_smfmac_f32_32x32x32_bf16 v[80:95], v[136:139], v[48:55], v144
    ds_read_b128 v[132:135], v152 offset:32160
    v_exp_f32 v62, v62
    v_exp_f32 v63, v63
    v_exp_f32 v64, v64
    v_exp_f32 v65, v65
    v_smfmac_f32_32x32x32_bf16 v[80:95], v[140:143], v[56:63], v144
    s_waitcnt lgkmcnt(3)
    v_exp_f32 v66, v66
    v_exp_f32 v67, v67
    v_exp_f32 v68, v68
    v_exp_f32 v69, v69
    v_mfma_f32_32x32x16_bf16 v[16:31], v[124:127], v[112:115], v[16:31]
    v_exp_f32 v70, v70
    v_exp_f32 v71, v71
    v_exp_f32 v72, v72
    v_exp_f32 v73, v73
    v_mfma_f32_32x32x16_bf16 v[32:47], v[124:127], v[116:119], v[32:47]
    ds_read_b128 v[124:127], v146 offset:32512
    v_exp_f32 v74, v74
    v_exp_f32 v75, v75
    v_exp_f32 v76, v76
    v_exp_f32 v77, v77
    v_smfmac_f32_32x32x32_bf16 v[96:111], v[136:139], v[64:71], v144
    s_waitcnt lgkmcnt(1)
    v_exp_f32 v78, v78
    v_exp_f32 v79, v79
    v_exp_f32 v16, v16
    v_exp_f32 v17, v17
    v_smfmac_f32_32x32x32_bf16 v[96:111], v[140:143], v[72:79], v144
    ds_read_b128 v[136:139], v152 offset:32832
    v_and_b32 v222, 48, v8
    v_exp_f32 v18, v18
    v_exp_f32 v19, v19
    v_exp_f32 v20, v20
    v_exp_f32 v21, v21
    v_mfma_f32_32x32x4_2b_bf16 v[48:79], v[122:123], v[120:121], 0 cbsz:1 abid:1
    v_exp_f32 v22, v22
    v_exp_f32 v23, v23
    v_exp_f32 v24, v24
    v_exp_f32 v25, v25
    v_exp_f32 v26, v26
    v_exp_f32 v27, v27
    v_exp_f32 v28, v28
    v_exp_f32 v29, v29
    v_smfmac_f32_32x32x32_bf16 v[80:95], v[128:131], v[16:23], v144
    ds_read_b128 v[140:143], v152 offset:33504
    v_exp_f32 v30, v30
    v_exp_f32 v31, v31
    v_exp_f32 v32, v32
    v_exp_f32 v33, v33
    v_smfmac_f32_32x32x32_bf16 v[80:95], v[132:135], v[24:31], v144
    s_waitcnt lgkmcnt(2)
    ds_read_b64 v[122:123], v150 offset:0
    v_exp_f32 v34, v34
    v_exp_f32 v35, v35
    v_exp_f32 v36, v36
    v_exp_f32 v37, v37
    v_mfma_f32_32x32x16_bf16 v[48:63], v[124:127], v[112:115], v[48:63]
    v_exp_f32 v38, v38
    v_exp_f32 v39, v39
    v_exp_f32 v40, v40
    v_exp_f32 v41, v41
    v_mfma_f32_32x32x16_bf16 v[64:79], v[124:127], v[116:119], v[64:79]
    ds_read_b128 v[124:127], v147 offset:0
    v_exp_f32 v42, v42
    v_exp_f32 v43, v43
    v_exp_f32 v44, v44
    v_exp_f32 v45, v45
    v_smfmac_f32_32x32x32_bf16 v[96:111], v[128:131], v[32:39], v144
    s_waitcnt vmcnt(1) lgkmcnt(1)
    s_barrier
    s_setprio 3
    v_exp_f32 v46, v46
    v_exp_f32 v47, v47
    v_exp_f32 v48, v48
    v_exp_f32 v49, v49
    v_smfmac_f32_32x32x32_bf16 v[96:111], v[132:135], v[40:47], v144
    s_cmp_eq_u32 s3, 0
    s_cbranch_scc0 Lx_54
    s_mov_b32 m0, 40960
    s_mov_b32 s12, 166912
    buffer_load_dwordx4 v8, s[64:67], s12 offen sc1 lds
Lx_54:
    ds_read_b128 v[128:131], v153 offset:0
    s_add_u32 m0, s51, 32768
    s_add_u32 s12, s51, 158720
    buffer_load_dwordx4 v8, s[64:67], s12 offen sc1 lds
    buffer_load_dwordx4 v[216:219], v222, s[64:67], s99 offen sc1
    v_exp_f32 v50, v50
    v_exp_f32 v51, v51
    v_exp_f32 v52, v52
    v_exp_f32 v53, v53
    v_mfma_f32_32x32x4_2b_bf16 v[16:47], v[122:123], v[120:121], 0 cbsz:1 abid:0
    s_mov_b32 s12, 0
    buffer_load_dwordx2 v[160:161], v155, s[76:79], s12 offen
    v_exp_f32 v54, v54
    v_exp_f32 v55, v55
    v_exp_f32 v56, v56
    v_exp_f32 v57, v57
    v_exp_f32 v58, v58
    v_exp_f32 v59, v59
    v_exp_f32 v60, v60
    v_exp_f32 v61, v61
    v_smfmac_f32_32x32x32_bf16 v[80:95], v[136:139], v[48:55], v144
    ds_read_b128 v[132:135], v153 offset:672
    v_exp_f32 v62, v62
    v_exp_f32 v63, v63
    v_exp_f32 v64, v64
    v_exp_f32 v65, v65
    v_smfmac_f32_32x32x32_bf16 v[80:95], v[140:143], v[56:63], v144
    s_waitcnt lgkmcnt(2)
    v_exp_f32 v66, v66
    v_exp_f32 v67, v67
    v_exp_f32 v68, v68
    v_exp_f32 v69, v69
    v_mfma_f32_32x32x16_bf16 v[16:31], v[124:127], v[112:115], v[16:31]
    v_exp_f32 v70, v70
    v_exp_f32 v71, v71
    v_exp_f32 v72, v72
    v_exp_f32 v73, v73
    v_mfma_f32_32x32x16_bf16 v[32:47], v[124:127], v[116:119], v[32:47]
    ds_read_b128 v[124:127], v147 offset:1024
    v_exp_f32 v74, v74
    v_exp_f32 v75, v75
    v_exp_f32 v76, v76
    v_exp_f32 v77, v77
    v_smfmac_f32_32x32x32_bf16 v[96:111], v[136:139], v[64:71], v144
    s_waitcnt lgkmcnt(1)
    v_exp_f32 v78, v78
    v_exp_f32 v79, v79
    v_exp_f32 v16, v16
    v_exp_f32 v17, v17
    v_smfmac_f32_32x32x32_bf16 v[96:111], v[140:143], v[72:79], v144
    ds_read_b128 v[136:139], v153 offset:1344
    v_exp_f32 v18, v18
    v_exp_f32 v19, v19
    v_exp_f32 v20, v20
    v_exp_f32 v21, v21
    v_mfma_f32_32x32x4_2b_bf16 v[48:79], v[122:123], v[120:121], 0 cbsz:1 abid:1
    s_mov_b32 s12, 81920
    buffer_load_dwordx2 v[162:163], v155, s[76:79], s12 offen
    v_exp_f32 v22, v22
    v_exp_f32 v23, v23
    v_exp_f32 v24, v24
    v_exp_f32 v25, v25
    v_exp_f32 v26, v26
    v_exp_f32 v27, v27
    v_exp_f32 v28, v28
    v_exp_f32 v29, v29
    v_smfmac_f32_32x32x32_bf16 v[80:95], v[128:131], v[16:23], v144
    ds_read_b128 v[140:143], v153 offset:2016
    v_exp_f32 v30, v30
    v_exp_f32 v31, v31
    v_exp_f32 v32, v32
    v_exp_f32 v33, v33
    v_smfmac_f32_32x32x32_bf16 v[80:95], v[132:135], v[24:31], v144
    s_waitcnt lgkmcnt(2)
    ds_read_b64 v[122:123], v150 offset:10496
    v_exp_f32 v34, v34
    v_exp_f32 v35, v35
    v_exp_f32 v36, v36
    v_exp_f32 v37, v37
    v_mfma_f32_32x32x16_bf16 v[48:63], v[124:127], v[112:115], v[48:63]
    v_exp_f32 v38, v38
    v_exp_f32 v39, v39
    v_exp_f32 v40, v40
    v_exp_f32 v41, v41
    v_mfma_f32_32x32x16_bf16 v[64:79], v[124:127], v[116:119], v[64:79]
    ds_read_b128 v[124:127], v147 offset:10496
    s_setprio 2
    v_exp_f32 v42, v42
    v_exp_f32 v43, v43
    v_exp_f32 v44, v44
    v_exp_f32 v45, v45
    v_smfmac_f32_32x32x32_bf16 v[96:111], v[128:131], v[32:39], v144
    s_waitcnt lgkmcnt(1)
    v_exp_f32 v46, v46
    v_exp_f32 v47, v47
    v_exp_f32 v48, v48
    v_exp_f32 v49, v49
    v_smfmac_f32_32x32x32_bf16 v[96:111], v[132:135], v[40:47], v144
    ds_read_b128 v[128:131], v153 offset:10496
    s_cmp_lt_u32 s2, 80
    s_waitcnt vmcnt(2)
    s_cbranch_scc0 L_kin0
    v_cmp_eq_u64 vcc, s[80:81], v[216:217]
    v_cmp_eq_u64 s[84:85], s[80:81], v[218:219]
    s_lshl_b32 s13, s10, 10
    s_and_b64 vcc, vcc, s[84:85]
    s_cmp_eq_u64 vcc, -1
    s_cbranch_scc0 L_kpoll
L_kin0:
    v_exp_f32 v50, v50
    v_exp_f32 v51, v51
    v_exp_f32 v52, v52
    v_exp_f32 v53, v53
    v_mfma_f32_32x32x4_2b_bf16 v[16:47], v[122:123], v[120:121], 0 cbsz:1 abid:0
    s_mov_b32 s12, 163840
    buffer_load_dwordx2 v[164:165], v155, s[76:79], s12 offen
    v_exp_f32 v54, v54
    v_exp_f32 v55, v55
    v_exp_f32 v56, v56
    v_exp_f32 v57, v57
    v_exp_f32 v58, v58
    v_exp_f32 v59, v59
    v_exp_f32 v60, v60
    v_exp_f32 v61, v61
    v_smfmac_f32_32x32x32_bf16 v[80:95], v[136:139], v[48:55], v144
    ds_read_b128 v[132:135], v153 offset:11168
    v_exp_f32 v62, v62
    v_exp_f32 v63, v63
    v_exp_f32 v64, v64
    v_exp_f32 v65, v65
    v_smfmac_f32_32x32x32_bf16 v[80:95], v[140:143], v[56:63], v144
    s_waitcnt lgkmcnt(2)
    v_exp_f32 v66, v66
    v_exp_f32 v67, v67
    v_exp_f32 v68, v68
    v_exp_f32 v69, v69
    v_mfma_f32_32x32x16_bf16 v[16:31], v[124:127], v[112:115], v[16:31]
    s_cmp_lt_u32 s2, 80
    s_cbranch_scc0 L_kin1
    s_add_u32 m0, s13, 125952
    s_add_u32 s12, s98, 0
    buffer_load_dwordx4 v8, s[64:67], s12 offen sc1 lds
    s_add_u32 m0, s13, 130048
    s_add_u32 s12, s98, 4096
    buffer_load_dwordx4 v8, s[64:67], s12 offen sc1 lds
    s_add_u32 m0, s13, 134144
    s_add_u32 s12, s98, 8192
    buffer_load_dwordx4 v8, s[64:67], s12 offen sc1 lds
L_kin1:
    v_exp_f32 v70, v70
    v_exp_f32 v71, v71
    v_exp_f32 v72, v72
    v_exp_f32 v73, v73
    v_mfma_f32_32x32x16_bf16 v[32:47], v[124:127], v[116:119], v[32:47]
    ds_read_b128 v[124:127], v147 offset:11520
    v_exp_f32 v74, v74
    v_exp_f32 v75, v75
    v_exp_f32 v76, v76
    v_exp_f32 v77, v77
    v_smfmac_f32_32x32x32_bf16 v[96:111], v[136:139], v[64:71], v144
    s_waitcnt lgkmcnt(1)
    v_exp_f32 v78, v78
    v_exp_f32 v79, v79
    v_exp_f32 v16, v16
    v_exp_f32 v17, v17
    v_smfmac_f32_32x32x32_bf16 v[96:111], v[140:143], v[72:79], v144
    ds_read_b128 v[136:139], v153 offset:11840
    v_exp_f32 v18, v18
    v_exp_f32 v19, v19
    v_exp_f32 v20, v20
    v_exp_f32 v21, v21
    v_mfma_f32_32x32x4_2b_bf16 v[48:79], v[122:123], v[120:121], 0 cbsz:1 abid:1
    s_mov_b32 s12, 245760
    buffer_load_dwordx2 v[166:167], v155, s[76:79], s12 offen
    v_exp_f32 v22, v22
    v_exp_f32 v23, v23
    v_exp_f32 v24, v24
    v_exp_f32 v25, v25
    v_exp_f32 v26, v26
    v_exp_f32 v27, v27
    v_exp_f32 v28, v28
    v_exp_f32 v29, v29
    v_smfmac_f32_32x32x32_bf16 v[80:95], v[128:131], v[16:23], v144
    ds_read_b128 v[140:143], v153 offset:12512
    v_exp_f32 v30, v30
    v_exp_f32 v31, v31
    v_exp_f32 v32, v32
    v_exp_f32 v33, v33
    v_smfmac_f32_32x32x32_bf16 v[80:95], v[132:135], v[24:31], v144
    s_waitcnt lgkmcnt(2)
    ds_read_b64 v[122:123], v150 offset:20992
    v_exp_f32 v34, v34
    v_exp_f32 v35, v35
    v_exp_f32 v36, v36
    v_exp_f32 v37, v37
    v_mfma_f32_32x32x16_bf16 v[48:63], v[124:127], v[112:115], v[48:63]
    v_exp_f32 v38, v38
    v_exp_f32 v39, v39
    v_exp_f32 v40, v40
    v_exp_f32 v41, v41
    v_mfma_f32_32x32x16_bf16 v[64:79], v[124:127], v[116:119], v[64:79]
    ds_read_b128 v[124:127], v147 offset:20992
    s_setprio 1
    v_exp_f32 v42, v42
    v_exp_f32 v43, v43
    v_exp_f32 v44, v44
    v_exp_f32 v45, v45
    v_smfmac_f32_32x32x32_bf16 v[96:111], v[128:131], v[32:39], v144
    s_waitcnt lgkmcnt(1)
    v_exp_f32 v46, v46
    v_exp_f32 v47, v47
    v_exp_f32 v48, v48
    v_exp_f32 v49, v49
    v_smfmac_f32_32x32x32_bf16 v[96:111], v[132:135], v[40:47], v144
    ds_read_b128 v[128:131], v153 offset:20992
    v_exp_f32 v50, v50
    v_exp_f32 v51, v51
    v_exp_f32 v52, v52
    v_exp_f32 v53, v53
    v_mfma_f32_32x32x4_2b_bf16 v[16:47], v[122:123], v[120:121], 0 cbsz:1 abid:0
    s_mov_b32 s12, 327680
    buffer_load_dwordx2 v[168:169], v155, s[76:79], s12 offen
    v_exp_f32 v54, v54
    v_exp_f32 v55, v55
    v_exp_f32 v56, v56
    v_exp_f32 v57, v57
    v_exp_f32 v58, v58
    v_exp_f32 v59, v59
    v_exp_f32 v60, v60
    v_exp_f32 v61, v61
    v_smfmac_f32_32x32x32_bf16 v[80:95], v[136:139], v[48:55], v144
    ds_read_b128 v[132:135], v153 offset:21664
    v_exp_f32 v62, v62
    v_exp_f32 v63, v63
    v_exp_f32 v64, v64
    v_exp_f32 v65, v65
    v_smfmac_f32_32x32x32_bf16 v[80:95], v[140:143], v[56:63], v144
    s_waitcnt lgkmcnt(2)
    v_exp_f32 v66, v66
    v_exp_f32 v67, v67
    v_exp_f32 v68, v68
    v_exp_f32 v69, v69
    v_mfma_f32_32x32x16_bf16 v[16:31], v[124:127], v[112:115], v[16:31]
    s_cmp_lt_u32 s2, 80
    s_cbranch_scc0 L_kin2
    s_add_u32 m0, s13, 138240
    s_add_u32 s12, s98, 12288
    buffer_load_dwordx4 v8, s[64:67], s12 offen sc1 lds
    s_add_u32 m0, s13, 142336
    s_add_u32 s12, s98, 16384
    buffer_load_dwordx4 v8, s[64:67], s12 offen sc1 lds
    s_add_u32 m0, s13, 146432
    s_add_u32 s12, s98, 20480
    buffer_load_dwordx4 v8, s[64:67], s12 offen sc1 lds
L_kin2:
    v_exp_f32 v70, v70
    v_exp_f32 v71, v71
    v_exp_f32 v72, v72
    v_exp_f32 v73, v73
    v_mfma_f32_32x32x16_bf16 v[32:47], v[124:127], v[116:119], v[32:47]
    ds_read_b128 v[124:127], v147 offset:22016
    v_exp_f32 v74, v74
    v_exp_f32 v75, v75
    v_exp_f32 v76, v76
    v_exp_f32 v77, v77
    v_smfmac_f32_32x32x32_bf16 v[96:111], v[136:139], v[64:71], v144
    s_waitcnt lgkmcnt(1)
    v_exp_f32 v78, v78
    v_exp_f32 v79, v79
    v_exp_f32 v16, v16
    v_exp_f32 v17, v17
    v_smfmac_f32_32x32x32_bf16 v[96:111], v[140:143], v[72:79], v144
    ds_read_b128 v[136:139], v153 offset:22336
    v_exp_f32 v18, v18
    v_exp_f32 v19, v19
    v_exp_f32 v20, v20
    v_exp_f32 v21, v21
    v_mfma_f32_32x32x4_2b_bf16 v[48:79], v[122:123], v[120:121], 0 cbsz:1 abid:1
    s_mov_b32 s12, 409600
    buffer_load_dwordx2 v[170:171], v155, s[76:79], s12 offen
    v_exp_f32 v22, v22
    v_exp_f32 v23, v23
    v_exp_f32 v24, v24
    v_exp_f32 v25, v25
    v_exp_f32 v26, v26
    v_exp_f32 v27, v27
    v_exp_f32 v28, v28
    v_exp_f32 v29, v29
    v_smfmac_f32_32x32x32_bf16 v[80:95], v[128:131], v[16:23], v144
    ds_read_b128 v[140:143], v153 offset:23008
    v_exp_f32 v30, v30
    v_exp_f32 v31, v31
    v_exp_f32 v32, v32
    v_exp_f32 v33, v33
    v_smfmac_f32_32x32x32_bf16 v[80:95], v[132:135], v[24:31], v144
    s_waitcnt lgkmcnt(2)
    ds_read_b64 v[122:123], v150 offset:31488
    v_exp_f32 v34, v34
    v_exp_f32 v35, v35
    v_exp_f32 v36, v36
    v_exp_f32 v37, v37
    v_mfma_f32_32x32x16_bf16 v[48:63], v[124:127], v[112:115], v[48:63]
    v_exp_f32 v38, v38
    v_exp_f32 v39, v39
    v_exp_f32 v40, v40
    v_exp_f32 v41, v41
    v_mfma_f32_32x32x16_bf16 v[64:79], v[124:127], v[116:119], v[64:79]
    ds_read_b128 v[124:127], v147 offset:31488
    s_setprio 0
    v_exp_f32 v42, v42
    v_exp_f32 v43, v43
    v_exp_f32 v44, v44
    v_exp_f32 v45, v45
    v_smfmac_f32_32x32x32_bf16 v[96:111], v[128:131], v[32:39], v144
    s_waitcnt lgkmcnt(1)
    v_exp_f32 v46, v46
    v_exp_f32 v47, v47
    v_exp_f32 v48, v48
    v_exp_f32 v49, v49
    v_smfmac_f32_32x32x32_bf16 v[96:111], v[132:135], v[40:47], v144
    ds_read_b128 v[128:131], v153 offset:31488
    v_exp_f32 v50, v50
    v_exp_f32 v51, v51
    v_exp_f32 v52, v52
    v_exp_f32 v53, v53
    v_mfma_f32_32x32x4_2b_bf16 v[16:47], v[122:123], v[120:121], 0 cbsz:1 abid:0
    s_mov_b32 s12, 491520
    buffer_load_dwordx2 v[172:173], v155, s[76:79], s12 offen
    v_exp_f32 v54, v54
    v_exp_f32 v55, v55
    v_exp_f32 v56, v56
    v_exp_f32 v57, v57
    v_exp_f32 v58, v58
    v_exp_f32 v59, v59
    v_exp_f32 v60, v60
    v_exp_f32 v61, v61
    v_smfmac_f32_32x32x32_bf16 v[80:95], v[136:139], v[48:55], v144
    ds_read_b128 v[132:135], v153 offset:32160
    v_exp_f32 v62, v62
    v_exp_f32 v63, v63
    v_exp_f32 v64, v64
    v_exp_f32 v65, v65
    v_smfmac_f32_32x32x32_bf16 v[80:95], v[140:143], v[56:63], v144
    s_waitcnt lgkmcnt(2)
    v_exp_f32 v66, v66
    v_exp_f32 v67, v67
    v_exp_f32 v68, v68
    v_exp_f32 v69, v69
    v_mfma_f32_32x32x16_bf16 v[16:31], v[124:127], v[112:115], v[16:31]
    s_cmp_lt_u32 s2, 80
    s_cbranch_scc0 L_kin3
    s_add_u32 m0, s13, 150528
    s_add_u32 s12, s98, 24576
    buffer_load_dwordx4 v8, s[64:67], s12 offen sc1 lds
    s_add_u32 m0, s13, 154624
    s_add_u32 s12, s98, 28672
    buffer_load_dwordx4 v8, s[64:67], s12 offen sc1 lds
    s_add_u32 m0, s13, 158720
    s_add_u32 s12, s98, 32768
    buffer_load_dwordx4 v8, s[64:67], s12 offen sc1 lds
L_kin3:
    v_exp_f32 v70, v70
    v_exp_f32 v71, v71
    v_exp_f32 v72, v72
    v_exp_f32 v73, v73
    v_mfma_f32_32x32x16_bf16 v[32:47], v[124:127], v[116:119], v[32:47]
    ds_read_b128 v[124:127], v147 offset:32512
    v_exp_f32 v74, v74
    v_exp_f32 v75, v75
    v_exp_f32 v76, v76
    v_exp_f32 v77, v77
    v_smfmac_f32_32x32x32_bf16 v[96:111], v[136:139], v[64:71], v144
    s_waitcnt lgkmcnt(1)
    v_exp_f32 v78, v78
    v_exp_f32 v79, v79
    v_exp_f32 v16, v16
    v_exp_f32 v17, v17
    v_smfmac_f32_32x32x32_bf16 v[96:111], v[140:143], v[72:79], v144
    ds_read_b128 v[136:139], v153 offset:32832
    v_exp_f32 v18, v18
    v_exp_f32 v19, v19
    v_exp_f32 v20, v20
    v_exp_f32 v21, v21
    v_mfma_f32_32x32x4_2b_bf16 v[48:79], v[122:123], v[120:121], 0 cbsz:1 abid:1
    s_mov_b32 s12, 573440
    buffer_load_dwordx2 v[174:175], v155, s[76:79], s12 offen
    v_exp_f32 v22, v22
    v_exp_f32 v23, v23
    v_exp_f32 v24, v24
    v_exp_f32 v25, v25
    v_exp_f32 v26, v26
    v_exp_f32 v27, v27
    v_exp_f32 v28, v28
    v_exp_f32 v29, v29
    v_smfmac_f32_32x32x32_bf16 v[80:95], v[128:131], v[16:23], v144
    ds_read_b128 v[140:143], v153 offset:33504
    v_exp_f32 v30, v30
    v_exp_f32 v31, v31
    v_exp_f32 v32, v32
    v_exp_f32 v33, v33
    v_smfmac_f32_32x32x32_bf16 v[80:95], v[132:135], v[24:31], v144
    s_waitcnt lgkmcnt(2)
    ds_read_b64 v[122:123], v148 offset:0
    v_exp_f32 v34, v34
    v_exp_f32 v35, v35
    v_exp_f32 v36, v36
    v_exp_f32 v37, v37
    v_mfma_f32_32x32x16_bf16 v[48:63], v[124:127], v[112:115], v[48:63]
    v_exp_f32 v38, v38
    v_exp_f32 v39, v39
    v_exp_f32 v40, v40
    v_exp_f32 v41, v41
    v_mfma_f32_32x32x16_bf16 v[64:79], v[124:127], v[116:119], v[64:79]
    ds_read_b128 v[124:127], v145 offset:0
    v_exp_f32 v42, v42
    v_exp_f32 v43, v43
    v_exp_f32 v44, v44
    v_exp_f32 v45, v45
    v_smfmac_f32_32x32x32_bf16 v[96:111], v[128:131], v[32:39], v144
    s_waitcnt lgkmcnt(1)
    s_barrier
    s_setprio 3
    v_exp_f32 v46, v46
    v_exp_f32 v47, v47
    v_exp_f32 v48, v48
    v_exp_f32 v49, v49
    v_smfmac_f32_32x32x32_bf16 v[96:111], v[132:135], v[40:47], v144
    ds_read_b128 v[128:131], v151 offset:0
    v_exp_f32 v50, v50
    v_exp_f32 v51, v51
    v_exp_f32 v52, v52
    v_exp_f32 v53, v53
    v_mfma_f32_32x32x4_2b_bf16 v[16:47], v[122:123], v[120:121], 0 cbsz:1 abid:0
    s_add_u32 s96, s6, L_tabA-L_pc+5120
    s_addc_u32 s97, s7, 0
    global_load_dwordx4 v[224:227], v8, s[96:97]
    global_load_dword v228, v8, s[96:97] offset:1024
    v_exp_f32 v54, v54
    v_exp_f32 v55, v55
    v_exp_f32 v56, v56
    v_exp_f32 v57, v57
    v_exp_f32 v58, v58
    v_exp_f32 v59, v59
    v_exp_f32 v60, v60
    v_exp_f32 v61, v61
    v_smfmac_f32_32x32x32_bf16 v[80:95], v[136:139], v[48:55], v144
    ds_read_b128 v[132:135], v151 offset:672
    v_exp_f32 v62, v62
    v_exp_f32 v63, v63
    v_exp_f32 v64, v64
    v_exp_f32 v65, v65
    v_smfmac_f32_32x32x32_bf16 v[80:95], v[140:143], v[56:63], v144
    s_waitcnt lgkmcnt(2)
    v_exp_f32 v66, v66
    v_exp_f32 v67, v67
    v_exp_f32 v68, v68
    v_exp_f32 v69, v69
    v_mfma_f32_32x32x16_bf16 v[16:31], v[124:127], v[112:115], v[16:31]
    v_exp_f32 v70, v70
    v_exp_f32 v71, v71
    v_exp_f32 v72, v72
    v_exp_f32 v73, v73
    v_mfma_f32_32x32x16_bf16 v[32:47], v[124:127], v[116:119], v[32:47]
    ds_read_b128 v[124:127], v145 offset:1024
    v_exp_f32 v74, v74
    v_exp_f32 v75, v75
    v_exp_f32 v76, v76
    v_exp_f32 v77, v77
    v_smfmac_f32_32x32x32_bf16 v[96:111], v[136:139], v[64:71], v144
    s_waitcnt lgkmcnt(1)
    v_exp_f32 v78, v78
    v_exp_f32 v79, v79
    v_exp_f32 v16, v16
    v_exp_f32 v17, v17
    v_smfmac_f32_32x32x32_bf16 v[96:111], v[140:143], v[72:79], v144
    ds_read_b128 v[136:139], v151 offset:1344
    ds_write_b64 v159, v[4:5]
    v_exp_f32 v18, v18
    v_exp_f32 v19, v19
    v_exp_f32 v20, v20
    v_exp_f32 v21, v21
    v_mfma_f32_32x32x4_2b_bf16 v[48:79], v[122:123], v[120:121], 0 cbsz:1 abid:1
    v_exp_f32 v22, v22
    v_exp_f32 v23, v23
    v_exp_f32 v24, v24
    v_exp_f32 v25, v25
    v_exp_f32 v26, v26
    v_exp_f32 v27, v27
    v_exp_f32 v28, v28
    v_exp_f32 v29, v29
    v_smfmac_f32_32x32x32_bf16 v[80:95], v[128:131], v[16:23], v144
    ds_read_b128 v[140:143], v151 offset:2016
    ds_write_b64 v249, v[4:5]
    v_exp_f32 v30, v30
    v_exp_f32 v31, v31
    v_exp_f32 v32, v32
    v_exp_f32 v33, v33
    v_smfmac_f32_32x32x32_bf16 v[80:95], v[132:135], v[24:31], v144
    s_waitcnt lgkmcnt(4)
    ds_read_b64 v[122:123], v148 offset:10496
    v_exp_f32 v34, v34
    v_exp_f32 v35, v35
    v_exp_f32 v36, v36
    v_exp_f32 v37, v37
    v_mfma_f32_32x32x16_bf16 v[48:63], v[124:127], v[112:115], v[48:63]
    v_exp_f32 v38, v38
    v_exp_f32 v39, v39
    v_exp_f32 v40, v40
    v_exp_f32 v41, v41
    v_mfma_f32_32x32x16_bf16 v[64:79], v[124:127], v[116:119], v[64:79]
    ds_read_b128 v[124:127], v145 offset:10496
    s_setprio 2
    v_exp_f32 v42, v42
    v_exp_f32 v43, v43
    v_exp_f32 v44, v44
    v_exp_f32 v45, v45
    v_smfmac_f32_32x32x32_bf16 v[96:111], v[128:131], v[32:39], v144
    s_waitcnt lgkmcnt(1)
    v_exp_f32 v46, v46
    v_exp_f32 v47, v47
    v_exp_f32 v48, v48
    v_exp_f32 v49, v49
    v_smfmac_f32_32x32x32_bf16 v[96:111], v[132:135], v[40:47], v144
    s_waitcnt vmcnt(0)
    ds_read_b128 v[128:131], v151 offset:10496
    ds_write_b64 v156, v[160:161]
    ds_read_b64_tr_b16 v[176:177], v157
    v_exp_f32 v50, v50
    v_exp_f32 v51, v51
    v_exp_f32 v52, v52
    v_exp_f32 v53, v53
    v_mfma_f32_32x32x4_2b_bf16 v[16:47], v[122:123], v[120:121], 0 cbsz:1 abid:0
    v_exp_f32 v54, v54
    v_exp_f32 v55, v55
    v_exp_f32 v56, v56
    v_exp_f32 v57, v57
    v_exp_f32 v58, v58
    v_exp_f32 v59, v59
    v_exp_f32 v60, v60
    v_exp_f32 v61, v61
    v_smfmac_f32_32x32x32_bf16 v[80:95], v[136:139], v[48:55], v144
    ds_read_b128 v[132:135], v151 offset:11168
    ds_write_b64 v156, v[162:163]
    ds_read_b64_tr_b16 v[178:179], v157
    v_exp_f32 v62, v62
    v_exp_f32 v63, v63
    v_exp_f32 v64, v64
    v_exp_f32 v65, v65
    v_smfmac_f32_32x32x32_bf16 v[80:95], v[140:143], v[56:63], v144
    s_waitcnt lgkmcnt(6)
    v_exp_f32 v66, v66
    v_exp_f32 v67, v67
    v_exp_f32 v68, v68
    v_exp_f32 v69, v69
    v_mfma_f32_32x32x16_bf16 v[16:31], v[124:127], v[112:115], v[16:31]
    v_exp_f32 v70, v70
    v_exp_f32 v71, v71
    v_exp_f32 v72, v72
    v_exp_f32 v73, v73
    v_mfma_f32_32x32x16_bf16 v[32:47], v[124:127], v[116:119], v[32:47]
    ds_read_b128 v[124:127], v145 offset:11520
    v_exp_f32 v74, v74
    v_exp_f32 v75, v75
    v_exp_f32 v76, v76
    v_exp_f32 v77, v77
    v_smfmac_f32_32x32x32_bf16 v[96:111], v[136:139], v[64:71], v144
    s_waitcnt lgkmcnt(1)
    v_exp_f32 v78, v78
    v_exp_f32 v79, v79
    v_exp_f32 v16, v16
    v_exp_f32 v17, v17
    v_smfmac_f32_32x32x32_bf16 v[96:111], v[140:143], v[72:79], v144
    ds_read_b128 v[136:139], v151 offset:11840
    ds_write_b64 v156, v[164:165]
    ds_read_b64_tr_b16 v[180:181], v157
    v_exp_f32 v18, v18
    v_exp_f32 v19, v19
    v_exp_f32 v20, v20
    v_exp_f32 v21, v21
    v_mfma_f32_32x32x4_2b_bf16 v[48:79], v[122:123], v[120:121], 0 cbsz:1 abid:1
    ds_write_b64 v158, v[176:177] offset:0
    v_exp_f32 v22, v22
    v_exp_f32 v23, v23
    v_exp_f32 v24, v24
    v_exp_f32 v25, v25
    v_exp_f32 v26, v26
    v_exp_f32 v27, v27
    v_exp_f32 v28, v28
    v_exp_f32 v29, v29
    v_smfmac_f32_32x32x32_bf16 v[80:95], v[128:131], v[16:23], v144
    ds_read_b128 v[140:143], v151 offset:12512
    ds_write_b64 v156, v[166:167]
    ds_read_b64_tr_b16 v[182:183], v157
    v_exp_f32 v30, v30
    v_exp_f32 v31, v31
    v_exp_f32 v32, v32
    v_exp_f32 v33, v33
    v_smfmac_f32_32x32x32_bf16 v[80:95], v[132:135], v[24:31], v144
    s_waitcnt lgkmcnt(7)
    ds_read_b64 v[122:123], v148 offset:20992
    v_exp_f32 v34, v34
    v_exp_f32 v35, v35
    v_exp_f32 v36, v36
    v_exp_f32 v37, v37
    v_mfma_f32_32x32x16_bf16 v[48:63], v[124:127], v[112:115], v[48:63]
    ds_write_b64 v158, v[178:179] offset:128
    v_exp_f32 v38, v38
    v_exp_f32 v39, v39
    v_exp_f32 v40, v40
    v_exp_f32 v41, v41
    v_mfma_f32_32x32x16_bf16 v[64:79], v[124:127], v[116:119], v[64:79]
    ds_read_b128 v[124:127], v145 offset:20992
    s_setprio 1
    v_exp_f32 v42, v42
    v_exp_f32 v43, v43
    v_exp_f32 v44, v44
    v_exp_f32 v45, v45
    v_smfmac_f32_32x32x32_bf16 v[96:111], v[128:131], v[32:39], v144
    s_waitcnt lgkmcnt(1)
    v_exp_f32 v46, v46
    v_exp_f32 v47, v47
    v_exp_f32 v48, v48
    v_exp_f32 v49, v49
    v_smfmac_f32_32x32x32_bf16 v[96:111], v[132:135], v[40:47], v144
    ds_read_b128 v[128:131], v151 offset:20992
    ds_write_b64 v156, v[168:169]
    ds_read_b64_tr_b16 v[184:185], v157
    v_exp_f32 v50, v50
    v_exp_f32 v51, v51
    v_exp_f32 v52, v52
    v_exp_f32 v53, v53
    v_mfma_f32_32x32x4_2b_bf16 v[16:47], v[122:123], v[120:121], 0 cbsz:1 abid:0
    ds_write_b64 v158, v[180:181] offset:256
    v_exp_f32 v54, v54
    v_exp_f32 v55, v55
    v_exp_f32 v56, v56
    v_exp_f32 v57, v57
    v_exp_f32 v58, v58
    v_exp_f32 v59, v59
    v_exp_f32 v60, v60
    v_exp_f32 v61, v61
    v_smfmac_f32_32x32x32_bf16 v[80:95], v[136:139], v[48:55], v144
    ds_read_b128 v[132:135], v151 offset:21664
    ds_write_b64 v156, v[170:171]
    ds_read_b64_tr_b16 v[186:187], v157
    v_exp_f32 v62, v62
    v_exp_f32 v63, v63
    v_exp_f32 v64, v64
    v_exp_f32 v65, v65
    v_smfmac_f32_32x32x32_bf16 v[80:95], v[140:143], v[56:63], v144
    s_waitcnt lgkmcnt(7)
    v_exp_f32 v66, v66
    v_exp_f32 v67, v67
    v_exp_f32 v68, v68
    v_exp_f32 v69, v69
    v_mfma_f32_32x32x16_bf16 v[16:31], v[124:127], v[112:115], v[16:31]
    ds_write_b64 v158, v[182:183] offset:384
    v_exp_f32 v70, v70
    v_exp_f32 v71, v71
    v_exp_f32 v72, v72
    v_exp_f32 v73, v73
    v_mfma_f32_32x32x16_bf16 v[32:47], v[124:127], v[116:119], v[32:47]
    ds_read_b128 v[124:127], v145 offset:22016
    v_exp_f32 v74, v74
    v_exp_f32 v75, v75
    v_exp_f32 v76, v76
    v_exp_f32 v77, v77
    v_smfmac_f32_32x32x32_bf16 v[96:111], v[136:139], v[64:71], v144
    s_waitcnt lgkmcnt(1)
    v_exp_f32 v78, v78
    v_exp_f32 v79, v79
    v_exp_f32 v16, v16
    v_exp_f32 v17, v17
    v_smfmac_f32_32x32x32_bf16 v[96:111], v[140:143], v[72:79], v144
    ds_read_b128 v[136:139], v151 offset:22336
    ds_write_b64 v156, v[172:173]
    ds_read_b64_tr_b16 v[188:189], v157
    v_exp_f32 v18, v18
    v_exp_f32 v19, v19
    v_exp_f32 v20, v20
    v_exp_f32 v21, v21
    v_mfma_f32_32x32x4_2b_bf16 v[48:79], v[122:123], v[120:121], 0 cbsz:1 abid:1
    ds_write_b64 v158, v[184:185] offset:512
    v_exp_f32 v22, v22
    v_exp_f32 v23, v23
    v_exp_f32 v24, v24
    v_exp_f32 v25, v25
    v_exp_f32 v26, v26
    v_exp_f32 v27, v27
    v_exp_f32 v28, v28
    v_exp_f32 v29, v29
    v_smfmac_f32_32x32x32_bf16 v[80:95], v[128:131], v[16:23], v144
    ds_read_b128 v[140:143], v151 offset:23008
    ds_write_b64 v156, v[174:175]
    ds_read_b64_tr_b16 v[190:191], v157
    v_exp_f32 v30, v30
    v_exp_f32 v31, v31
    v_exp_f32 v32, v32
    v_exp_f32 v33, v33
    v_smfmac_f32_32x32x32_bf16 v[80:95], v[132:135], v[24:31], v144
    s_waitcnt lgkmcnt(7)
    ds_read_b64 v[122:123], v148 offset:31488
    v_exp_f32 v34, v34
    v_exp_f32 v35, v35
    v_exp_f32 v36, v36
    v_exp_f32 v37, v37
    v_mfma_f32_32x32x16_bf16 v[48:63], v[124:127], v[112:115], v[48:63]
    s_cmp_lt_u32 s5, 3
    s_cselect_b32 s13, 8128, 0
    v_add_u32 v230, s13, v244
    ds_write_b64 v158, v[186:187] offset:640
    v_exp_f32 v38, v38
    v_exp_f32 v39, v39
    v_exp_f32 v40, v40
    v_exp_f32 v41, v41
    v_mfma_f32_32x32x16_bf16 v[64:79], v[124:127], v[116:119], v[64:79]
    ds_read_b128 v[124:127], v145 offset:31488
    s_setprio 0
    v_exp_f32 v42, v42
    v_exp_f32 v43, v43
    v_exp_f32 v44, v44
    v_exp_f32 v45, v45
    v_smfmac_f32_32x32x32_bf16 v[96:111], v[128:131], v[32:39], v144
    s_waitcnt lgkmcnt(1)
    v_exp_f32 v46, v46
    v_exp_f32 v47, v47
    v_exp_f32 v48, v48
    v_exp_f32 v49, v49
    v_smfmac_f32_32x32x32_bf16 v[96:111], v[132:135], v[40:47], v144
    ds_read_b128 v[128:131], v151 offset:31488
    v_exp_f32 v50, v50
    v_exp_f32 v51, v51
    v_exp_f32 v52, v52
    v_exp_f32 v53, v53
    v_mfma_f32_32x32x4_2b_bf16 v[16:47], v[122:123], v[120:121], 0 cbsz:1 abid:0
    ds_write_b64 v158, v[188:189] offset:768
    v_exp_f32 v54, v54
    v_exp_f32 v55, v55
    v_exp_f32 v56, v56
    v_exp_f32 v57, v57
    v_exp_f32 v58, v58
    v_exp_f32 v59, v59
    v_exp_f32 v60, v60
    v_exp_f32 v61, v61
    v_smfmac_f32_32x32x32_bf16 v[80:95], v[136:139], v[48:55], v144
    ds_read_b128 v[132:135], v151 offset:32160
    v_exp_f32 v62, v62
    v_exp_f32 v63, v63
    v_exp_f32 v64, v64
    v_exp_f32 v65, v65
    v_smfmac_f32_32x32x32_bf16 v[80:95], v[140:143], v[56:63], v144
    s_waitcnt lgkmcnt(3)
    v_exp_f32 v66, v66
    v_exp_f32 v67, v67
    v_exp_f32 v68, v68
    v_exp_f32 v69, v69
    v_mfma_f32_32x32x16_bf16 v[16:31], v[124:127], v[112:115], v[16:31]
    s_mul_i32 s93, s10, 81920
    s_mul_i32 s13, s5, 160
    s_add_u32 s93, s93, s13
    s_add_u32 s94, s93, 40960
    s_mul_i32 s95, s10, 10240
    s_add_u32 s95, s95, 2048
    ds_write_b64 v158, v[190:191] offset:896
    v_exp_f32 v70, v70
    v_exp_f32 v71, v71
    v_exp_f32 v72, v72
    v_exp_f32 v73, v73
    v_mfma_f32_32x32x16_bf16 v[32:47], v[124:127], v[116:119], v[32:47]
    ds_read_b128 v[124:127], v145 offset:32512
    v_exp_f32 v74, v74
    v_exp_f32 v75, v75
    v_exp_f32 v76, v76
    v_exp_f32 v77, v77
    v_smfmac_f32_32x32x32_bf16 v[96:111], v[136:139], v[64:71], v144
    s_waitcnt lgkmcnt(1)
    v_exp_f32 v78, v78
    v_exp_f32 v79, v79
    v_exp_f32 v16, v16
    v_exp_f32 v17, v17
    v_smfmac_f32_32x32x32_bf16 v[96:111], v[140:143], v[72:79], v144
    ds_read_b128 v[136:139], v151 offset:32832
    v_exp_f32 v18, v18
    v_exp_f32 v19, v19
    v_exp_f32 v20, v20
    v_exp_f32 v21, v21
    v_mfma_f32_32x32x4_2b_bf16 v[48:79], v[122:123], v[120:121], 0 cbsz:1 abid:1
    v_exp_f32 v22, v22
    v_exp_f32 v23, v23
    v_exp_f32 v24, v24
    v_exp_f32 v25, v25
    v_exp_f32 v26, v26
    v_exp_f32 v27, v27
    v_exp_f32 v28, v28
    v_exp_f32 v29, v29
    v_smfmac_f32_32x32x32_bf16 v[80:95], v[128:131], v[16:23], v144
    ds_read_b128 v[140:143], v151 offset:33504
    v_exp_f32 v30, v30
    v_exp_f32 v31, v31
    v_exp_f32 v32, v32
    v_exp_f32 v33, v33
    v_smfmac_f32_32x32x32_bf16 v[80:95], v[132:135], v[24:31], v144
    s_waitcnt lgkmcnt(2)
    v_exp_f32 v34, v34
    v_exp_f32 v35, v35
    v_exp_f32 v36, v36
    v_exp_f32 v37, v37
    v_mfma_f32_32x32x16_bf16 v[48:63], v[124:127], v[112:115], v[48:63]
    s_lshl_b32 s13, s10, 3
    v_mov_b32 v2, 163828
    v_lshlrev_b32 v3, s13, 1
    v_exp_f32 v38, v38
    v_exp_f32 v39, v39
    v_exp_f32 v40, v40
    v_exp_f32 v41, v41
    v_mfma_f32_32x32x16_bf16 v[64:79], v[124:127], v[116:119], v[64:79]
    v_exp_f32 v42, v42
    v_exp_f32 v43, v43
    v_exp_f32 v44, v44
    v_exp_f32 v45, v45
    v_smfmac_f32_32x32x32_bf16 v[96:111], v[128:131], v[32:39], v144
    s_waitcnt lgkmcnt(0)
    s_barrier
    s_setprio 3
    v_exp_f32 v46, v46
    v_exp_f32 v47, v47
    v_exp_f32 v48, v48
    v_exp_f32 v49, v49
    v_smfmac_f32_32x32x32_bf16 v[96:111], v[132:135], v[40:47], v144
    ds_read_b128 v[216:219], v230 offset:2496
    ds_read_b128 v[220:223], v230 offset:3008
    ds_read_b128 v[232:235], v230 offset:3520
    ds_read_b128 v[236:239], v230 offset:4032
    ds_read_b128 v[196:199], v244 offset:448
    ds_read_b128 v[200:203], v244 offset:960
    v_exp_f32 v50, v50
    v_exp_f32 v51, v51
    v_exp_f32 v52, v52
    v_exp_f32 v53, v53
    ds_read_b128 v[204:207], v244 offset:1472
    ds_read_b128 v[208:211], v244 offset:1984
    ds_read2_b32 v[16:17], v240 offset0:240 offset1:241
    ds_read2_b32 v[18:19], v240 offset0:242 offset1:243
    ds_read2_b32 v[20:21], v240 offset0:112 offset1:113
    ds_read2_b32 v[22:23], v240 offset0:114 offset1:115
    v_exp_f32 v54, v54
    v_exp_f32 v55, v55
    v_exp_f32 v56, v56
    v_exp_f32 v57, v57
    v_exp_f32 v58, v58
    v_exp_f32 v59, v59
    v_exp_f32 v60, v60
    v_exp_f32 v61, v61
    v_smfmac_f32_32x32x32_bf16 v[80:95], v[136:139], v[48:55], v144
    ds_read2_b32 v[24:25], v241 offset0:240 offset1:241
    ds_read2_b32 v[26:27], v241 offset0:242 offset1:243
    ds_read2_b32 v[28:29], v241 offset0:112 offset1:113
    ds_read2_b32 v[30:31], v241 offset0:114 offset1:115
    ds_read2_b32 v[32:33], v242 offset0:240 offset1:241
    ds_read2_b32 v[34:35], v242 offset0:242 offset1:243
    v_exp_f32 v62, v62
    v_exp_f32 v63, v63
    v_exp_f32 v64, v64
    v_exp_f32 v65, v65
    v_smfmac_f32_32x32x32_bf16 v[80:95], v[140:143], v[56:63], v144
    v_exp_f32 v66, v66
    v_exp_f32 v67, v67
    v_exp_f32 v68, v68
    v_exp_f32 v69, v69
    ds_read2_b32 v[36:37], v242 offset0:112 offset1:113
    ds_read2_b32 v[38:39], v242 offset0:114 offset1:115
    ds_read2_b32 v[40:41], v243 offset0:240 offset1:241
    ds_read2_b32 v[42:43], v243 offset0:242 offset1:243
    ds_read2_b32 v[44:45], v243 offset0:112 offset1:113
    ds_read2_b32 v[46:47], v243 offset0:114 offset1:115
    v_exp_f32 v70, v70
    v_exp_f32 v71, v71
    v_exp_f32 v72, v72
    v_exp_f32 v73, v73
    v_exp_f32 v74, v74
    v_exp_f32 v75, v75
    v_exp_f32 v76, v76
    v_exp_f32 v77, v77
    v_smfmac_f32_32x32x32_bf16 v[96:111], v[136:139], v[64:71], v144
    v_exp_f32 v78, v78
    v_exp_f32 v79, v79
    s_nop 1
    v_smfmac_f32_32x32x32_bf16 v[96:111], v[140:143], v[72:79], v144
    ds_write_b128 v9, v[80:83] offset:0
    ds_write_b128 v9, v[84:87] offset:1024
    ds_write_b128 v9, v[88:91] offset:2048
    s_nop 8
    ds_write_b128 v9, v[96:99] offset:3072
    ds_write_b128 v9, v[100:103] offset:4096
    ds_write_b128 v9, v[104:107] offset:5120
    s_mov_b64 exec, 1
    ds_add_u32 v2, v3
    s_mov_b64 exec, -1
    s_cmp_lt_u32 s5, 3
    s_cbranch_scc1 L_tailP
    s_setprio 1
    s_waitcnt lgkmcnt(15)
    v_mfma_f32_16x16x32_bf16 v[160:163], v[192:195], v[216:219], 0
    s_waitcnt lgkmcnt(15)
    s_sub_u32 m0, s95, 1024
    v_mfma_f32_16x16x32_bf16 v[164:167], v[192:195], v[220:223], 0
    buffer_load_dwordx4 v224, s[72:75], s93 offen lds
    ds_read2_b32 v[80:81], v240 offset0:224 offset1:225
    s_waitcnt lgkmcnt(15)
    v_mfma_f32_16x16x32_bf16 v[168:171], v[192:195], v[232:235], 0
    ds_read2_b32 v[82:83], v240 offset0:226 offset1:227
    s_waitcnt lgkmcnt(15)
    s_add_u32 m0, s95, 0
    v_mfma_f32_16x16x32_bf16 v[172:175], v[192:195], v[236:239], 0
    buffer_load_dwordx4 v225, s[72:75], s93 offen lds
    ds_read_b128 v[128:131], v244 offset:2432
    s_waitcnt lgkmcnt(15)
    v_mfma_f32_16x16x32_bf16 v[160:163], v[16:19], v[216:219], v[160:163]
    ds_read_b128 v[132:135], v244 offset:2944
    s_add_u32 m0, s95, 1024
    v_mfma_f32_16x16x32_bf16 v[164:167], v[16:19], v[220:223], v[164:167]
    buffer_load_dwordx4 v226, s[72:75], s93 offen lds
    ds_read_b128 v[136:139], v244 offset:3456
    v_mfma_f32_16x16x32_bf16 v[168:171], v[16:19], v[232:235], v[168:171]
    ds_read_b128 v[140:143], v244 offset:3968
    s_add_u32 m0, s95, 2048
    v_mfma_f32_16x16x32_bf16 v[172:175], v[16:19], v[236:239], v[172:175]
    buffer_load_dwordx4 v227, s[72:75], s93 offen lds
    ds_read2_b32 v[84:85], v240 offset0:96 offset1:97
    s_waitcnt lgkmcnt(15)
    v_mfma_f32_16x16x32_bf16 v[160:163], v[20:23], v[208:211], v[160:163]
    ds_read2_b32 v[86:87], v240 offset0:98 offset1:99
    s_add_u32 m0, s95, 3072
    v_mfma_f32_16x16x32_bf16 v[164:167], v[20:23], v[216:219], v[164:167]
    buffer_load_dwordx4 v228, s[72:75], s93 offen lds
    ds_read_b128 v[124:127], v244 offset:1920
    v_mfma_f32_16x16x32_bf16 v[168:171], v[20:23], v[220:223], v[168:171]
    ds_read2_b32 v[88:89], v241 offset0:224 offset1:225
    s_add_u32 m0, s95, 4096
    v_mfma_f32_16x16x32_bf16 v[172:175], v[20:23], v[232:235], v[172:175]
    buffer_load_dwordx4 v224, s[72:75], s94 offen lds
    ds_read2_b32 v[90:91], v241 offset0:226 offset1:227
    s_waitcnt lgkmcnt(15)
    v_mfma_f32_16x16x32_bf16 v[160:163], v[24:27], v[204:207], v[160:163]
    ds_read_b128 v[120:123], v244 offset:1408
    s_add_u32 m0, s95, 5120
    v_mfma_f32_16x16x32_bf16 v[164:167], v[24:27], v[208:211], v[164:167]
    buffer_load_dwordx4 v225, s[72:75], s94 offen lds
    ds_read2_b32 v[92:93], v241 offset0:96 offset1:97
    v_mfma_f32_16x16x32_bf16 v[168:171], v[24:27], v[216:219], v[168:171]
    ds_read2_b32 v[94:95], v241 offset0:98 offset1:99
    s_add_u32 m0, s95, 6144
    v_mfma_f32_16x16x32_bf16 v[172:175], v[24:27], v[220:223], v[172:175]
    buffer_load_dwordx4 v226, s[72:75], s94 offen lds
    ds_read_b128 v[116:119], v244 offset:896
    s_waitcnt lgkmcnt(15)
    v_mfma_f32_16x16x32_bf16 v[160:163], v[28:31], v[200:203], v[160:163]
    ds_read2_b32 v[96:97], v242 offset0:224 offset1:225
    s_add_u32 m0, s95, 7168
    v_mfma_f32_16x16x32_bf16 v[164:167], v[28:31], v[204:207], v[164:167]
    buffer_load_dwordx4 v227, s[72:75], s94 offen lds
    ds_read2_b32 v[98:99], v242 offset0:226 offset1:227
    v_mfma_f32_16x16x32_bf16 v[168:171], v[28:31], v[208:211], v[168:171]
    ds_read_b128 v[112:115], v244 offset:384
    s_add_u32 m0, s95, 8192
    v_mfma_f32_16x16x32_bf16 v[172:175], v[28:31], v[216:219], v[172:175]
    buffer_load_dwordx4 v228, s[72:75], s94 offen lds
    ds_read2_b32 v[100:101], v242 offset0:96 offset1:97
    s_waitcnt lgkmcnt(15)
    v_mfma_f32_16x16x32_bf16 v[160:163], v[32:35], v[196:199], v[160:163]
    ds_read2_b32 v[102:103], v242 offset0:98 offset1:99
    v_mfma_f32_16x16x32_bf16 v[164:167], v[32:35], v[200:203], v[164:167]
    ds_read2_b32 v[104:105], v243 offset0:224 offset1:225
    v_mfma_f32_16x16x32_bf16 v[168:171], v[32:35], v[204:207], v[168:171]
    ds_read2_b32 v[106:107], v243 offset0:226 offset1:227
    v_mfma_f32_16x16x32_bf16 v[172:175], v[32:35], v[208:211], v[172:175]
    ds_read2_b32 v[108:109], v243 offset0:96 offset1:97
    s_waitcnt lgkmcnt(15)
    v_mfma_f32_16x16x32_bf16 v[164:167], v[36:39], v[196:199], v[164:167]
    ds_read2_b32 v[110:111], v243 offset0:98 offset1:99
    v_mfma_f32_16x16x32_bf16 v[168:171], v[36:39], v[200:203], v[168:171]
    v_mfma_f32_16x16x32_bf16 v[172:175], v[36:39], v[204:207], v[172:175]
    s_waitcnt lgkmcnt(15)
    v_mfma_f32_16x16x32_bf16 v[168:171], v[40:43], v[196:199], v[168:171]
    v_mfma_f32_16x16x32_bf16 v[172:175], v[40:43], v[200:203], v[172:175]
    s_waitcnt lgkmcnt(15)
    v_mfma_f32_16x16x32_bf16 v[172:175], v[44:47], v[196:199], v[172:175]
    s_waitcnt lgkmcnt(15)
    v_mfma_f32_16x16x32_bf16 v[160:163], v[80:83], v[128:131], v[160:163]
    s_waitcnt lgkmcnt(15)
    v_mfma_f32_16x16x32_bf16 v[164:167], v[80:83], v[132:135], v[164:167]
    ds_read2_b32 v[16:17], v240 offset0:208 offset1:209
    s_waitcnt lgkmcnt(15)
    v_mfma_f32_16x16x32_bf16 v[168:171], v[80:83], v[136:139], v[168:171]
    ds_read2_b32 v[18:19], v240 offset0:210 offset1:211
    s_waitcnt lgkmcnt(15)
    v_mfma_f32_16x16x32_bf16 v[172:175], v[80:83], v[140:143], v[172:175]
    ds_read_b128 v[64:67], v244 offset:2368
    s_waitcnt lgkmcnt(15)
    v_mfma_f32_16x16x32_bf16 v[160:163], v[84:87], v[124:127], v[160:163]
    ds_read_b128 v[68:71], v244 offset:2880
    v_mfma_f32_16x16x32_bf16 v[164:167], v[84:87], v[128:131], v[164:167]
    ds_read_b128 v[72:75], v244 offset:3392
    v_mfma_f32_16x16x32_bf16 v[168:171], v[84:87], v[132:135], v[168:171]
    ds_read_b128 v[76:79], v244 offset:3904
    v_mfma_f32_16x16x32_bf16 v[172:175], v[84:87], v[136:139], v[172:175]
    ds_read2_b32 v[20:21], v240 offset0:80 offset1:81
    s_waitcnt lgkmcnt(15)
    v_mfma_f32_16x16x32_bf16 v[160:163], v[88:91], v[120:123], v[160:163]
    ds_read2_b32 v[22:23], v240 offset0:82 offset1:83
    v_mfma_f32_16x16x32_bf16 v[164:167], v[88:91], v[124:127], v[164:167]
    ds_read_b128 v[60:63], v244 offset:1856
    v_mfma_f32_16x16x32_bf16 v[168:171], v[88:91], v[128:131], v[168:171]
    ds_read2_b32 v[24:25], v241 offset0:208 offset1:209
    v_mfma_f32_16x16x32_bf16 v[172:175], v[88:91], v[132:135], v[172:175]
    ds_read2_b32 v[26:27], v241 offset0:210 offset1:211
    s_waitcnt lgkmcnt(15)
    v_mfma_f32_16x16x32_bf16 v[160:163], v[92:95], v[116:119], v[160:163]
    ds_read_b128 v[56:59], v244 offset:1344
    v_mfma_f32_16x16x32_bf16 v[164:167], v[92:95], v[120:123], v[164:167]
    ds_read2_b32 v[28:29], v241 offset0:80 offset1:81
    v_mfma_f32_16x16x32_bf16 v[168:171], v[92:95], v[124:127], v[168:171]
    ds_read2_b32 v[30:31], v241 offset0:82 offset1:83
    v_mfma_f32_16x16x32_bf16 v[172:175], v[92:95], v[128:131], v[172:175]
    ds_read_b128 v[52:55], v244 offset:832
    s_waitcnt lgkmcnt(15)
    v_mfma_f32_16x16x32_bf16 v[160:163], v[96:99], v[112:115], v[160:163]
    ds_read2_b32 v[32:33], v242 offset0:208 offset1:209
    v_mfma_f32_16x16x32_bf16 v[164:167], v[96:99], v[116:119], v[164:167]
    ds_read2_b32 v[34:35], v242 offset0:210 offset1:211
    v_mfma_f32_16x16x32_bf16 v[168:171], v[96:99], v[120:123], v[168:171]
    ds_read_b128 v[48:51], v244 offset:320
    v_mfma_f32_16x16x32_bf16 v[172:175], v[96:99], v[124:127], v[172:175]
    ds_read2_b32 v[36:37], v242 offset0:80 offset1:81
    s_waitcnt lgkmcnt(15)
    v_mfma_f32_16x16x32_bf16 v[164:167], v[100:103], v[112:115], v[164:167]
    ds_read2_b32 v[38:39], v242 offset0:82 offset1:83
    v_mfma_f32_16x16x32_bf16 v[168:171], v[100:103], v[116:119], v[168:171]
    ds_read2_b32 v[40:41], v243 offset0:208 offset1:209
    v_mfma_f32_16x16x32_bf16 v[172:175], v[100:103], v[120:123], v[172:175]
    ds_read2_b32 v[42:43], v243 offset0:210 offset1:211
    s_waitcnt lgkmcnt(15)
    v_mfma_f32_16x16x32_bf16 v[168:171], v[104:107], v[112:115], v[168:171]
    ds_read2_b32 v[44:45], v243 offset0:80 offset1:81
    v_mfma_f32_16x16x32_bf16 v[172:175], v[104:107], v[116:119], v[172:175]
    ds_read2_b32 v[46:47], v243 offset0:82 offset1:83
    s_waitcnt lgkmcnt(15)
    v_mfma_f32_16x16x32_bf16 v[172:175], v[108:111], v[112:115], v[172:175]
    s_waitcnt lgkmcnt(15)
    v_mfma_f32_16x16x32_bf16 v[160:163], v[16:19], v[64:67], v[160:163]
    s_waitcnt lgkmcnt(15)
    v_mfma_f32_16x16x32_bf16 v[164:167], v[16:19], v[68:71], v[164:167]
    ds_read2_b32 v[80:81], v240 offset0:192 offset1:193
    s_waitcnt lgkmcnt(15)
    v_mfma_f32_16x16x32_bf16 v[168:171], v[16:19], v[72:75], v[168:171]
    ds_read2_b32 v[82:83], v240 offset0:194 offset1:195
    s_waitcnt lgkmcnt(15)
    v_mfma_f32_16x16x32_bf16 v[172:175], v[16:19], v[76:79], v[172:175]
    ds_read_b128 v[128:131], v244 offset:2304
    s_waitcnt lgkmcnt(15)
    v_mfma_f32_16x16x32_bf16 v[160:163], v[20:23], v[60:63], v[160:163]
    ds_read_b128 v[132:135], v244 offset:2816
    v_mfma_f32_16x16x32_bf16 v[164:167], v[20:23], v[64:67], v[164:167]
    ds_read_b128 v[136:139], v244 offset:3328
    v_mfma_f32_16x16x32_bf16 v[168:171], v[20:23], v[68:71], v[168:171]
    ds_read_b128 v[140:143], v244 offset:3840
    v_mfma_f32_16x16x32_bf16 v[172:175], v[20:23], v[72:75], v[172:175]
    ds_read2_b32 v[84:85], v240 offset0:64 offset1:65
    s_waitcnt lgkmcnt(15)
    v_mfma_f32_16x16x32_bf16 v[160:163], v[24:27], v[56:59], v[160:163]
    ds_read2_b32 v[86:87], v240 offset0:66 offset1:67
    v_mfma_f32_16x16x32_bf16 v[164:167], v[24:27], v[60:63], v[164:167]
    ds_read_b128 v[124:127], v244 offset:1792
    v_mfma_f32_16x16x32_bf16 v[168:171], v[24:27], v[64:67], v[168:171]
    ds_read2_b32 v[88:89], v241 offset0:192 offset1:193
    v_mfma_f32_16x16x32_bf16 v[172:175], v[24:27], v[68:71], v[172:175]
    ds_read2_b32 v[90:91], v241 offset0:194 offset1:195
    s_waitcnt lgkmcnt(15)
    v_mfma_f32_16x16x32_bf16 v[160:163], v[28:31], v[52:55], v[160:163]
    ds_read_b128 v[120:123], v244 offset:1280
    v_mfma_f32_16x16x32_bf16 v[164:167], v[28:31], v[56:59], v[164:167]
    ds_read2_b32 v[92:93], v241 offset0:64 offset1:65
    v_mfma_f32_16x16x32_bf16 v[168:171], v[28:31], v[60:63], v[168:171]
    ds_read2_b32 v[94:95], v241 offset0:66 offset1:67
    v_mfma_f32_16x16x32_bf16 v[172:175], v[28:31], v[64:67], v[172:175]
    ds_read_b128 v[116:119], v244 offset:768
    s_waitcnt lgkmcnt(15)
    v_mfma_f32_16x16x32_bf16 v[160:163], v[32:35], v[48:51], v[160:163]
    ds_read2_b32 v[96:97], v242 offset0:192 offset1:193
    v_mfma_f32_16x16x32_bf16 v[164:167], v[32:35], v[52:55], v[164:167]
    ds_read2_b32 v[98:99], v242 offset0:194 offset1:195
    v_mfma_f32_16x16x32_bf16 v[168:171], v[32:35], v[56:59], v[168:171]
    ds_read_b128 v[112:115], v244 offset:256
    v_mfma_f32_16x16x32_bf16 v[172:175], v[32:35], v[60:63], v[172:175]
    ds_read2_b32 v[100:101], v242 offset0:64 offset1:65
    s_waitcnt lgkmcnt(15)
    v_mfma_f32_16x16x32_bf16 v[164:167], v[36:39], v[48:51], v[164:167]
    ds_read2_b32 v[102:103], v242 offset0:66 offset1:67
    v_mfma_f32_16x16x32_bf16 v[168:171], v[36:39], v[52:55], v[168:171]
    ds_read2_b32 v[104:105], v243 offset0:192 offset1:193
    v_mfma_f32_16x16x32_bf16 v[172:175], v[36:39], v[56:59], v[172:175]
    ds_read2_b32 v[106:107], v243 offset0:194 offset1:195
    s_waitcnt lgkmcnt(15)
    v_mfma_f32_16x16x32_bf16 v[168:171], v[40:43], v[48:51], v[168:171]
    ds_read2_b32 v[108:109], v243 offset0:64 offset1:65
    v_mfma_f32_16x16x32_bf16 v[172:175], v[40:43], v[52:55], v[172:175]
    ds_read2_b32 v[110:111], v243 offset0:66 offset1:67
    s_waitcnt lgkmcnt(15)
    v_mfma_f32_16x16x32_bf16 v[172:175], v[44:47], v[48:51], v[172:175]
    s_waitcnt vmcnt(0)
    v_mov_b32 v2, 163808
    v_mov_b32 v3, 1
    s_mov_b64 exec, 1
    ds_add_u32 v2, v3
    s_mov_b64 exec, -1
    s_waitcnt lgkmcnt(15)
    v_mfma_f32_16x16x32_bf16 v[160:163], v[80:83], v[128:131], v[160:163]
    s_waitcnt lgkmcnt(15)
    v_mfma_f32_16x16x32_bf16 v[164:167], v[80:83], v[132:135], v[164:167]
    ds_read2_b32 v[16:17], v240 offset0:176 offset1:177
    s_waitcnt lgkmcnt(15)
    v_mfma_f32_16x16x32_bf16 v[168:171], v[80:83], v[136:139], v[168:171]
    ds_read2_b32 v[18:19], v240 offset0:178 offset1:179
    s_waitcnt lgkmcnt(15)
    v_mfma_f32_16x16x32_bf16 v[172:175], v[80:83], v[140:143], v[172:175]
    ds_read_b128 v[64:67], v244 offset:2240
    s_waitcnt lgkmcnt(15)
    v_mfma_f32_16x16x32_bf16 v[160:163], v[84:87], v[124:127], v[160:163]
    ds_read_b128 v[68:71], v244 offset:2752
    v_mfma_f32_16x16x32_bf16 v[164:167], v[84:87], v[128:131], v[164:167]
    ds_read_b128 v[72:75], v244 offset:3264
    v_mfma_f32_16x16x32_bf16 v[168:171], v[84:87], v[132:135], v[168:171]
    ds_read_b128 v[76:79], v244 offset:3776
    v_mfma_f32_16x16x32_bf16 v[172:175], v[84:87], v[136:139], v[172:175]
    ds_read2_b32 v[20:21], v240 offset0:48 offset1:49
    s_waitcnt lgkmcnt(15)
    v_mfma_f32_16x16x32_bf16 v[160:163], v[88:91], v[120:123], v[160:163]
    ds_read2_b32 v[22:23], v240 offset0:50 offset1:51
    v_mfma_f32_16x16x32_bf16 v[164:167], v[88:91], v[124:127], v[164:167]
    ds_read_b128 v[60:63], v244 offset:1728
    v_mfma_f32_16x16x32_bf16 v[168:171], v[88:91], v[128:131], v[168:171]
    ds_read2_b32 v[24:25], v241 offset0:176 offset1:177
    v_mfma_f32_16x16x32_bf16 v[172:175], v[88:91], v[132:135], v[172:175]
    ds_read2_b32 v[26:27], v241 offset0:178 offset1:179
    s_waitcnt lgkmcnt(15)
    v_mfma_f32_16x16x32_bf16 v[160:163], v[92:95], v[116:119], v[160:163]
    ds_read_b128 v[56:59], v244 offset:1216
    v_mfma_f32_16x16x32_bf16 v[164:167], v[92:95], v[120:123], v[164:167]
    ds_read2_b32 v[28:29], v241 offset0:48 offset1:49
    v_mfma_f32_16x16x32_bf16 v[168:171], v[92:95], v[124:127], v[168:171]
    ds_read2_b32 v[30:31], v241 offset0:50 offset1:51
    v_mfma_f32_16x16x32_bf16 v[172:175], v[92:95], v[128:131], v[172:175]
    ds_read_b128 v[52:55], v244 offset:704
    s_waitcnt lgkmcnt(15)
    v_mfma_f32_16x16x32_bf16 v[160:163], v[96:99], v[112:115], v[160:163]
    ds_read2_b32 v[32:33], v242 offset0:176 offset1:177
    v_mfma_f32_16x16x32_bf16 v[164:167], v[96:99], v[116:119], v[164:167]
    ds_read2_b32 v[34:35], v242 offset0:178 offset1:179
    v_mfma_f32_16x16x32_bf16 v[168:171], v[96:99], v[120:123], v[168:171]
    ds_read_b128 v[48:51], v244 offset:192
    v_mfma_f32_16x16x32_bf16 v[172:175], v[96:99], v[124:127], v[172:175]
    ds_read2_b32 v[36:37], v242 offset0:48 offset1:49
    s_waitcnt lgkmcnt(15)
    v_mfma_f32_16x16x32_bf16 v[164:167], v[100:103], v[112:115], v[164:167]
    ds_read2_b32 v[38:39], v242 offset0:50 offset1:51
    v_mfma_f32_16x16x32_bf16 v[168:171], v[100:103], v[116:119], v[168:171]
    ds_read2_b32 v[40:41], v243 offset0:176 offset1:177
    v_mfma_f32_16x16x32_bf16 v[172:175], v[100:103], v[120:123], v[172:175]
    ds_read2_b32 v[42:43], v243 offset0:178 offset1:179
    s_waitcnt lgkmcnt(15)
    v_mfma_f32_16x16x32_bf16 v[168:171], v[104:107], v[112:115], v[168:171]
    ds_read2_b32 v[44:45], v243 offset0:48 offset1:49
    v_mfma_f32_16x16x32_bf16 v[172:175], v[104:107], v[116:119], v[172:175]
    ds_read2_b32 v[46:47], v243 offset0:50 offset1:51
    s_waitcnt lgkmcnt(15)
    v_mfma_f32_16x16x32_bf16 v[172:175], v[108:111], v[112:115], v[172:175]
    s_waitcnt lgkmcnt(15)
    v_mfma_f32_16x16x32_bf16 v[160:163], v[16:19], v[64:67], v[160:163]
    s_waitcnt lgkmcnt(15)
    v_mfma_f32_16x16x32_bf16 v[164:167], v[16:19], v[68:71], v[164:167]
    ds_read2_b32 v[80:81], v240 offset0:160 offset1:161
    s_waitcnt lgkmcnt(15)
    v_mfma_f32_16x16x32_bf16 v[168:171], v[16:19], v[72:75], v[168:171]
    ds_read2_b32 v[82:83], v240 offset0:162 offset1:163
    s_waitcnt lgkmcnt(15)
    v_mfma_f32_16x16x32_bf16 v[172:175], v[16:19], v[76:79], v[172:175]
    ds_read_b128 v[128:131], v244 offset:2176
    s_waitcnt lgkmcnt(15)
    v_mfma_f32_16x16x32_bf16 v[160:163], v[20:23], v[60:63], v[160:163]
    ds_read_b128 v[132:135], v244 offset:2688
    v_mfma_f32_16x16x32_bf16 v[164:167], v[20:23], v[64:67], v[164:167]
    ds_read_b128 v[136:139], v244 offset:3200
    v_mfma_f32_16x16x32_bf16 v[168:171], v[20:23], v[68:71], v[168:171]
    ds_read_b128 v[140:143], v244 offset:3712
    v_mfma_f32_16x16x32_bf16 v[172:175], v[20:23], v[72:75], v[172:175]
    ds_read2_b32 v[84:85], v240 offset0:32 offset1:33
    s_waitcnt lgkmcnt(15)
    v_mfma_f32_16x16x32_bf16 v[160:163], v[24:27], v[56:59], v[160:163]
    ds_read2_b32 v[86:87], v240 offset0:34 offset1:35
    v_mfma_f32_16x16x32_bf16 v[164:167], v[24:27], v[60:63], v[164:167]
    ds_read_b128 v[124:127], v244 offset:1664
    v_mfma_f32_16x16x32_bf16 v[168:171], v[24:27], v[64:67], v[168:171]
    ds_read2_b32 v[88:89], v241 offset0:160 offset1:161
    v_mfma_f32_16x16x32_bf16 v[172:175], v[24:27], v[68:71], v[172:175]
    ds_read2_b32 v[90:91], v241 offset0:162 offset1:163
    s_waitcnt lgkmcnt(15)
    v_mfma_f32_16x16x32_bf16 v[160:163], v[28:31], v[52:55], v[160:163]
    ds_read_b128 v[120:123], v244 offset:1152
    v_mfma_f32_16x16x32_bf16 v[164:167], v[28:31], v[56:59], v[164:167]
    ds_read2_b32 v[92:93], v241 offset0:32 offset1:33
    v_mfma_f32_16x16x32_bf16 v[168:171], v[28:31], v[60:63], v[168:171]
    ds_read2_b32 v[94:95], v241 offset0:34 offset1:35
    v_mfma_f32_16x16x32_bf16 v[172:175], v[28:31], v[64:67], v[172:175]
    ds_read_b128 v[116:119], v244 offset:640
    s_waitcnt lgkmcnt(15)
    v_mfma_f32_16x16x32_bf16 v[160:163], v[32:35], v[48:51], v[160:163]
    ds_read2_b32 v[96:97], v242 offset0:160 offset1:161
    v_mfma_f32_16x16x32_bf16 v[164:167], v[32:35], v[52:55], v[164:167]
    ds_read2_b32 v[98:99], v242 offset0:162 offset1:163
    v_mfma_f32_16x16x32_bf16 v[168:171], v[32:35], v[56:59], v[168:171]
    ds_read_b128 v[112:115], v244 offset:128
    v_mfma_f32_16x16x32_bf16 v[172:175], v[32:35], v[60:63], v[172:175]
    ds_read2_b32 v[100:101], v242 offset0:32 offset1:33
    s_waitcnt lgkmcnt(15)
    v_mfma_f32_16x16x32_bf16 v[164:167], v[36:39], v[48:51], v[164:167]
    ds_read2_b32 v[102:103], v242 offset0:34 offset1:35
    v_mfma_f32_16x16x32_bf16 v[168:171], v[36:39], v[52:55], v[168:171]
    ds_read2_b32 v[104:105], v243 offset0:160 offset1:161
    v_mfma_f32_16x16x32_bf16 v[172:175], v[36:39], v[56:59], v[172:175]
    ds_read2_b32 v[106:107], v243 offset0:162 offset1:163
    s_waitcnt lgkmcnt(15)
    v_mfma_f32_16x16x32_bf16 v[168:171], v[40:43], v[48:51], v[168:171]
    ds_read2_b32 v[108:109], v243 offset0:32 offset1:33
    v_mfma_f32_16x16x32_bf16 v[172:175], v[40:43], v[52:55], v[172:175]
    ds_read2_b32 v[110:111], v243 offset0:34 offset1:35
    s_waitcnt lgkmcnt(15)
    v_mfma_f32_16x16x32_bf16 v[172:175], v[44:47], v[48:51], v[172:175]
    s_waitcnt lgkmcnt(15)
    v_mfma_f32_16x16x32_bf16 v[160:163], v[80:83], v[128:131], v[160:163]
    s_waitcnt lgkmcnt(15)
    v_mfma_f32_16x16x32_bf16 v[164:167], v[80:83], v[132:135], v[164:167]
    ds_read2_b32 v[16:17], v240 offset0:144 offset1:145
    s_waitcnt lgkmcnt(15)
    v_mfma_f32_16x16x32_bf16 v[168:171], v[80:83], v[136:139], v[168:171]
    ds_read2_b32 v[18:19], v240 offset0:146 offset1:147
    s_waitcnt lgkmcnt(15)
    v_mfma_f32_16x16x32_bf16 v[172:175], v[80:83], v[140:143], v[172:175]
    ds_read_b128 v[64:67], v244 offset:2112
    s_waitcnt lgkmcnt(15)
    v_mfma_f32_16x16x32_bf16 v[160:163], v[84:87], v[124:127], v[160:163]
    ds_read_b128 v[68:71], v244 offset:2624
    v_mfma_f32_16x16x32_bf16 v[164:167], v[84:87], v[128:131], v[164:167]
    ds_read_b128 v[72:75], v244 offset:3136
    v_mfma_f32_16x16x32_bf16 v[168:171], v[84:87], v[132:135], v[168:171]
    ds_read_b128 v[76:79], v244 offset:3648
    v_mfma_f32_16x16x32_bf16 v[172:175], v[84:87], v[136:139], v[172:175]
    ds_read2_b32 v[20:21], v240 offset0:16 offset1:17
    s_waitcnt lgkmcnt(15)
    v_mfma_f32_16x16x32_bf16 v[160:163], v[88:91], v[120:123], v[160:163]
    ds_read2_b32 v[22:23], v240 offset0:18 offset1:19
    v_mfma_f32_16x16x32_bf16 v[164:167], v[88:91], v[124:127], v[164:167]
    ds_read_b128 v[60:63], v244 offset:1600
    v_mfma_f32_16x16x32_bf16 v[168:171], v[88:91], v[128:131], v[168:171]
    ds_read2_b32 v[24:25], v241 offset0:144 offset1:145
    v_mfma_f32_16x16x32_bf16 v[172:175], v[88:91], v[132:135], v[172:175]
    ds_read2_b32 v[26:27], v241 offset0:146 offset1:147
    s_waitcnt lgkmcnt(15)
    v_mfma_f32_16x16x32_bf16 v[160:163], v[92:95], v[116:119], v[160:163]
    ds_read_b128 v[56:59], v244 offset:1088
    v_mfma_f32_16x16x32_bf16 v[164:167], v[92:95], v[120:123], v[164:167]
    ds_read2_b32 v[28:29], v241 offset0:16 offset1:17
    v_mfma_f32_16x16x32_bf16 v[168:171], v[92:95], v[124:127], v[168:171]
    ds_read2_b32 v[30:31], v241 offset0:18 offset1:19
    v_mfma_f32_16x16x32_bf16 v[172:175], v[92:95], v[128:131], v[172:175]
    ds_read_b128 v[52:55], v244 offset:576
    s_waitcnt lgkmcnt(15)
    v_mfma_f32_16x16x32_bf16 v[160:163], v[96:99], v[112:115], v[160:163]
    ds_read2_b32 v[32:33], v242 offset0:144 offset1:145
    v_mfma_f32_16x16x32_bf16 v[164:167], v[96:99], v[116:119], v[164:167]
    ds_read2_b32 v[34:35], v242 offset0:146 offset1:147
    v_mfma_f32_16x16x32_bf16 v[168:171], v[96:99], v[120:123], v[168:171]
    ds_read_b128 v[48:51], v244 offset:64
    v_mfma_f32_16x16x32_bf16 v[172:175], v[96:99], v[124:127], v[172:175]
    ds_read2_b32 v[36:37], v242 offset0:16 offset1:17
    s_waitcnt lgkmcnt(15)
    v_mfma_f32_16x16x32_bf16 v[164:167], v[100:103], v[112:115], v[164:167]
    ds_read2_b32 v[38:39], v242 offset0:18 offset1:19
    v_mfma_f32_16x16x32_bf16 v[168:171], v[100:103], v[116:119], v[168:171]
    ds_read2_b32 v[40:41], v243 offset0:144 offset1:145
    v_mfma_f32_16x16x32_bf16 v[172:175], v[100:103], v[120:123], v[172:175]
    ds_read2_b32 v[42:43], v243 offset0:146 offset1:147
    s_waitcnt lgkmcnt(15)
    v_mfma_f32_16x16x32_bf16 v[168:171], v[104:107], v[112:115], v[168:171]
    ds_read2_b32 v[44:45], v243 offset0:16 offset1:17
    v_mfma_f32_16x16x32_bf16 v[172:175], v[104:107], v[116:119], v[172:175]
    ds_read2_b32 v[46:47], v243 offset0:18 offset1:19
    s_waitcnt lgkmcnt(15)
    v_mfma_f32_16x16x32_bf16 v[172:175], v[108:111], v[112:115], v[172:175]
    s_waitcnt lgkmcnt(15)
    v_mfma_f32_16x16x32_bf16 v[160:163], v[16:19], v[64:67], v[160:163]
    s_waitcnt lgkmcnt(15)
    v_mfma_f32_16x16x32_bf16 v[164:167], v[16:19], v[68:71], v[164:167]
    ds_read2_b32 v[80:81], v240 offset0:128 offset1:129
    s_waitcnt lgkmcnt(15)
    v_mfma_f32_16x16x32_bf16 v[168:171], v[16:19], v[72:75], v[168:171]
    ds_read2_b32 v[82:83], v240 offset0:130 offset1:131
    s_waitcnt lgkmcnt(15)
    v_mfma_f32_16x16x32_bf16 v[172:175], v[16:19], v[76:79], v[172:175]
    ds_read_b128 v[128:131], v244 offset:2048
    s_waitcnt lgkmcnt(15)
    v_mfma_f32_16x16x32_bf16 v[160:163], v[20:23], v[60:63], v[160:163]
    ds_read_b128 v[132:135], v244 offset:2560
    v_mfma_f32_16x16x32_bf16 v[164:167], v[20:23], v[64:67], v[164:167]
    ds_read_b128 v[136:139], v244 offset:3072
    v_mfma_f32_16x16x32_bf16 v[168:171], v[20:23], v[68:71], v[168:171]
    ds_read_b128 v[140:143], v244 offset:3584
    v_mfma_f32_16x16x32_bf16 v[172:175], v[20:23], v[72:75], v[172:175]
    ds_read2_b32 v[84:85], v240 offset0:0 offset1:1
    s_waitcnt lgkmcnt(15)
    v_mfma_f32_16x16x32_bf16 v[160:163], v[24:27], v[56:59], v[160:163]
    ds_read2_b32 v[86:87], v240 offset0:2 offset1:3
    v_mfma_f32_16x16x32_bf16 v[164:167], v[24:27], v[60:63], v[164:167]
    ds_read_b128 v[124:127], v244 offset:1536
    v_mfma_f32_16x16x32_bf16 v[168:171], v[24:27], v[64:67], v[168:171]
    ds_read2_b32 v[88:89], v241 offset0:128 offset1:129
    v_mfma_f32_16x16x32_bf16 v[172:175], v[24:27], v[68:71], v[172:175]
    ds_read2_b32 v[90:91], v241 offset0:130 offset1:131
    s_waitcnt lgkmcnt(15)
    v_mfma_f32_16x16x32_bf16 v[160:163], v[28:31], v[52:55], v[160:163]
    ds_read_b128 v[120:123], v244 offset:1024
    v_mfma_f32_16x16x32_bf16 v[164:167], v[28:31], v[56:59], v[164:167]
    ds_read2_b32 v[92:93], v241 offset0:0 offset1:1
    v_mfma_f32_16x16x32_bf16 v[168:171], v[28:31], v[60:63], v[168:171]
    ds_read2_b32 v[94:95], v241 offset0:2 offset1:3
    v_mfma_f32_16x16x32_bf16 v[172:175], v[28:31], v[64:67], v[172:175]
    ds_read_b128 v[116:119], v244 offset:512
    s_waitcnt lgkmcnt(15)
    v_mfma_f32_16x16x32_bf16 v[160:163], v[32:35], v[48:51], v[160:163]
    ds_read2_b32 v[96:97], v242 offset0:128 offset1:129
    v_mfma_f32_16x16x32_bf16 v[164:167], v[32:35], v[52:55], v[164:167]
    ds_read2_b32 v[98:99], v242 offset0:130 offset1:131
    v_mfma_f32_16x16x32_bf16 v[168:171], v[32:35], v[56:59], v[168:171]
    ds_read_b128 v[112:115], v244 offset:0
    v_mfma_f32_16x16x32_bf16 v[172:175], v[32:35], v[60:63], v[172:175]
    ds_read2_b32 v[100:101], v242 offset0:0 offset1:1
    s_waitcnt lgkmcnt(15)
    v_mfma_f32_16x16x32_bf16 v[164:167], v[36:39], v[48:51], v[164:167]
    ds_read2_b32 v[102:103], v242 offset0:2 offset1:3
    v_mfma_f32_16x16x32_bf16 v[168:171], v[36:39], v[52:55], v[168:171]
    ds_read2_b32 v[104:105], v243 offset0:128 offset1:129
    v_mfma_f32_16x16x32_bf16 v[172:175], v[36:39], v[56:59], v[172:175]
    ds_read2_b32 v[106:107], v243 offset0:130 offset1:131
    s_waitcnt lgkmcnt(15)
    v_mfma_f32_16x16x32_bf16 v[168:171], v[40:43], v[48:51], v[168:171]
    ds_read2_b32 v[108:109], v243 offset0:0 offset1:1
    v_mfma_f32_16x16x32_bf16 v[172:175], v[40:43], v[52:55], v[172:175]
    ds_read2_b32 v[110:111], v243 offset0:2 offset1:3
    s_waitcnt lgkmcnt(15)
    v_mfma_f32_16x16x32_bf16 v[172:175], v[44:47], v[48:51], v[172:175]
    s_waitcnt lgkmcnt(15)
    v_mfma_f32_16x16x32_bf16 v[160:163], v[80:83], v[128:131], v[160:163]
    s_waitcnt lgkmcnt(15)
    v_mfma_f32_16x16x32_bf16 v[164:167], v[80:83], v[132:135], v[164:167]
    s_waitcnt lgkmcnt(15)
    v_mfma_f32_16x16x32_bf16 v[168:171], v[80:83], v[136:139], v[168:171]
    s_waitcnt lgkmcnt(15)
    v_mfma_f32_16x16x32_bf16 v[160:163], v[84:87], v[124:127], v[160:163]
    v_mfma_f32_16x16x32_bf16 v[164:167], v[84:87], v[128:131], v[164:167]
    v_mfma_f32_16x16x32_bf16 v[168:171], v[84:87], v[132:135], v[168:171]
    s_waitcnt lgkmcnt(12)
    v_mfma_f32_16x16x32_bf16 v[160:163], v[88:91], v[120:123], v[160:163]
    v_mfma_f32_16x16x32_bf16 v[164:167], v[88:91], v[124:127], v[164:167]
    v_mfma_f32_16x16x32_bf16 v[168:171], v[88:91], v[128:131], v[168:171]
    s_waitcnt lgkmcnt(9)
    v_mfma_f32_16x16x32_bf16 v[160:163], v[92:95], v[116:119], v[160:163]
    v_mfma_f32_16x16x32_bf16 v[164:167], v[92:95], v[120:123], v[164:167]
    v_mfma_f32_16x16x32_bf16 v[168:171], v[92:95], v[124:127], v[168:171]
    s_waitcnt lgkmcnt(6)
    v_mfma_f32_16x16x32_bf16 v[160:163], v[96:99], v[112:115], v[160:163]
    v_mfma_f32_16x16x32_bf16 v[164:167], v[96:99], v[116:119], v[164:167]
    v_mfma_f32_16x16x32_bf16 v[168:171], v[96:99], v[120:123], v[168:171]
    s_waitcnt lgkmcnt(4)
    v_mfma_f32_16x16x32_bf16 v[164:167], v[100:103], v[112:115], v[164:167]
    v_mfma_f32_16x16x32_bf16 v[168:171], v[100:103], v[116:119], v[168:171]
    s_nop 2
    v_cvt_pk_bf16_f32 v24, v160, v161
    s_nop 1
    v_cvt_pk_bf16_f32 v25, v162, v163
    s_waitcnt lgkmcnt(2)
    v_mfma_f32_16x16x32_bf16 v[168:171], v[104:107], v[112:115], v[168:171]
    ds_write_b64 v245, v[24:25] offset:2048
    v_mfma_f32_16x16x32_bf16 v[172:175], v[80:83], v[140:143], v[172:175]
    v_mfma_f32_16x16x32_bf16 v[172:175], v[84:87], v[136:139], v[172:175]
    v_cvt_pk_bf16_f32 v26, v164, v165
    v_cvt_pk_bf16_f32 v27, v166, v167
    v_mfma_f32_16x16x32_bf16 v[172:175], v[88:91], v[132:135], v[172:175]
    ds_write_b64 v245, v[26:27] offset:2560
    v_mfma_f32_16x16x32_bf16 v[172:175], v[92:95], v[128:131], v[172:175]
    v_cvt_pk_bf16_f32 v28, v168, v169
    v_cvt_pk_bf16_f32 v29, v170, v171
    v_mfma_f32_16x16x32_bf16 v[172:175], v[96:99], v[124:127], v[172:175]
    ds_write_b64 v245, v[28:29] offset:3072
    v_mfma_f32_16x16x32_bf16 v[172:175], v[100:103], v[120:123], v[172:175]
    v_mfma_f32_16x16x32_bf16 v[172:175], v[104:107], v[116:119], v[172:175]
    s_waitcnt lgkmcnt(3)
    v_mfma_f32_16x16x32_bf16 v[172:175], v[108:111], v[112:115], v[172:175]
    s_nop 7
    v_cvt_pk_bf16_f32 v30, v172, v173
    s_nop 6
    v_cvt_pk_bf16_f32 v31, v174, v175
    ds_write_b64 v245, v[30:31] offset:3584
    v_mov_b32 v2, 163816
    v_mov_b32 v3, 1
    s_mov_b64 exec, 1
    ds_add_u32 v2, v3
    s_mov_b64 exec, -1
    s_mov_b32 s82, 0
Lsy_57:
    ds_read_b32 v3, v2
    s_add_u32 s82, s82, 1
    s_waitcnt lgkmcnt(0)
    v_readfirstlane_b32 s83, v3
    s_cmp_gt_u32 s82, 0x40000
    s_cbranch_scc1 Lsyd_58
    s_cmp_lt_u32 s83, 4
    s_cbranch_scc1 Lsy_57
Lsyd_58:
    ds_read_b64_tr_b16 v[40:41], v246 offset:2048
    ds_read_b64_tr_b16 v[42:43], v246 offset:2560
    ds_read_b64_tr_b16 v[44:45], v246 offset:3072
    ds_read_b64_tr_b16 v[46:47], v246 offset:3584
    s_mov_b32 s12, 2621440
    s_waitcnt lgkmcnt(3)
    buffer_store_dwordx2 v[40:41], v247, s[68:71], s12 offen
    s_mov_b32 s12, 3276800
    s_waitcnt lgkmcnt(2)
    buffer_store_dwordx2 v[42:43], v247, s[68:71], s12 offen
    s_mov_b32 s12, 3932160
    s_waitcnt lgkmcnt(1)
    buffer_store_dwordx2 v[44:45], v247, s[68:71], s12 offen
    s_mov_b32 s12, 4587520
    s_waitcnt lgkmcnt(0)
    buffer_store_dwordx2 v[46:47], v247, s[68:71], s12 offen
    s_branch L_fin
L_tailP:
    s_setprio 1
    s_cmp_lt_u32 s2, 80
    s_cbranch_scc0 L_idle
    s_waitcnt lgkmcnt(15)
    v_mfma_f32_16x16x32_bf16 v[144:147], v[192:195], v[196:199], 0
    s_waitcnt lgkmcnt(15)
    s_sub_u32 m0, s95, 1024
    v_mfma_f32_16x16x32_bf16 v[148:151], v[192:195], v[200:203], 0
    buffer_load_dwordx4 v224, s[72:75], s93 offen lds
    ds_read2_b32 v[80:81], v240 offset0:224 offset1:225
    s_waitcnt lgkmcnt(15)
    v_mfma_f32_16x16x32_bf16 v[152:155], v[192:195], v[204:207], 0
    ds_read2_b32 v[82:83], v240 offset0:226 offset1:227
    s_waitcnt lgkmcnt(15)
    s_add_u32 m0, s95, 0
    v_mfma_f32_16x16x32_bf16 v[156:159], v[192:195], v[208:211], 0
    buffer_load_dwordx4 v225, s[72:75], s93 offen lds
    ds_read_b128 v[112:115], v244 offset:384
    s_waitcnt lgkmcnt(15)
    v_mfma_f32_16x16x32_bf16 v[144:147], v[16:19], v[196:199], v[144:147]
    ds_read_b128 v[116:119], v244 offset:896
    s_add_u32 m0, s95, 1024
    v_mfma_f32_16x16x32_bf16 v[148:151], v[16:19], v[200:203], v[148:151]
    buffer_load_dwordx4 v226, s[72:75], s93 offen lds
    ds_read_b128 v[120:123], v244 offset:1408
    v_mfma_f32_16x16x32_bf16 v[152:155], v[16:19], v[204:207], v[152:155]
    ds_read_b128 v[124:127], v244 offset:1920
    s_add_u32 m0, s95, 2048
    v_mfma_f32_16x16x32_bf16 v[156:159], v[16:19], v[208:211], v[156:159]
    buffer_load_dwordx4 v227, s[72:75], s93 offen lds
    ds_read2_b32 v[84:85], v240 offset0:96 offset1:97
    s_waitcnt lgkmcnt(15)
    v_mfma_f32_16x16x32_bf16 v[148:151], v[20:23], v[196:199], v[148:151]
    ds_read2_b32 v[86:87], v240 offset0:98 offset1:99
    s_add_u32 m0, s95, 3072
    v_mfma_f32_16x16x32_bf16 v[152:155], v[20:23], v[200:203], v[152:155]
    buffer_load_dwordx4 v228, s[72:75], s93 offen lds
    ds_read2_b32 v[88:89], v241 offset0:224 offset1:225
    v_mfma_f32_16x16x32_bf16 v[156:159], v[20:23], v[204:207], v[156:159]
    ds_read2_b32 v[90:91], v241 offset0:226 offset1:227
    s_waitcnt lgkmcnt(15)
    s_add_u32 m0, s95, 4096
    v_mfma_f32_16x16x32_bf16 v[152:155], v[24:27], v[196:199], v[152:155]
    buffer_load_dwordx4 v224, s[72:75], s94 offen lds
    ds_read2_b32 v[92:93], v241 offset0:96 offset1:97
    v_mfma_f32_16x16x32_bf16 v[156:159], v[24:27], v[200:203], v[156:159]
    ds_read2_b32 v[94:95], v241 offset0:98 offset1:99
    s_waitcnt lgkmcnt(15)
    s_add_u32 m0, s95, 5120
    v_mfma_f32_16x16x32_bf16 v[156:159], v[28:31], v[196:199], v[156:159]
    buffer_load_dwordx4 v225, s[72:75], s94 offen lds
    ds_read2_b32 v[96:97], v242 offset0:224 offset1:225
    v_mfma_f32_16x16x32_bf16 v[160:163], v[212:215], v[216:219], 0
    ds_read2_b32 v[98:99], v242 offset0:226 offset1:227
    s_add_u32 m0, s95, 6144
    v_mfma_f32_16x16x32_bf16 v[164:167], v[212:215], v[220:223], 0
    buffer_load_dwordx4 v226, s[72:75], s94 offen lds
    ds_read_b128 v[128:131], v244 offset:10560
    v_mfma_f32_16x16x32_bf16 v[168:171], v[212:215], v[232:235], 0
    ds_read_b128 v[132:135], v244 offset:11072
    s_add_u32 m0, s95, 7168
    v_mfma_f32_16x16x32_bf16 v[172:175], v[212:215], v[236:239], 0
    buffer_load_dwordx4 v227, s[72:75], s94 offen lds
    ds_read_b128 v[136:139], v244 offset:11584
    s_waitcnt lgkmcnt(15)
    v_mfma_f32_16x16x32_bf16 v[160:163], v[32:35], v[216:219], v[160:163]
    ds_read_b128 v[140:143], v244 offset:12096
    s_add_u32 m0, s95, 8192
    v_mfma_f32_16x16x32_bf16 v[164:167], v[32:35], v[220:223], v[164:167]
    buffer_load_dwordx4 v228, s[72:75], s94 offen lds
    ds_read2_b32 v[100:101], v242 offset0:96 offset1:97
    v_mfma_f32_16x16x32_bf16 v[168:171], v[32:35], v[232:235], v[168:171]
    ds_read2_b32 v[102:103], v242 offset0:98 offset1:99
    v_mfma_f32_16x16x32_bf16 v[172:175], v[32:35], v[236:239], v[172:175]
    ds_read2_b32 v[104:105], v243 offset0:224 offset1:225
    s_waitcnt lgkmcnt(15)
    v_mfma_f32_16x16x32_bf16 v[164:167], v[36:39], v[216:219], v[164:167]
    ds_read2_b32 v[106:107], v243 offset0:226 offset1:227
    v_mfma_f32_16x16x32_bf16 v[168:171], v[36:39], v[220:223], v[168:171]
    ds_read2_b32 v[108:109], v243 offset0:96 offset1:97
    v_mfma_f32_16x16x32_bf16 v[172:175], v[36:39], v[232:235], v[172:175]
    ds_read2_b32 v[110:111], v243 offset0:98 offset1:99
    s_waitcnt lgkmcnt(15)
    v_mfma_f32_16x16x32_bf16 v[168:171], v[40:43], v[216:219], v[168:171]
    v_mfma_f32_16x16x32_bf16 v[172:175], v[40:43], v[220:223], v[172:175]
    s_waitcnt lgkmcnt(15)
    v_mfma_f32_16x16x32_bf16 v[172:175], v[44:47], v[216:219], v[172:175]
    s_waitcnt lgkmcnt(15)
    v_mfma_f32_16x16x32_bf16 v[144:147], v[80:83], v[112:115], v[144:147]
    s_waitcnt lgkmcnt(15)
    v_mfma_f32_16x16x32_bf16 v[148:151], v[80:83], v[116:119], v[148:151]
    ds_read2_b32 v[16:17], v240 offset0:208 offset1:209
    ds_read2_b32 v[18:19], v240 offset0:210 offset1:211
    s_waitcnt lgkmcnt(15)
    v_mfma_f32_16x16x32_bf16 v[152:155], v[80:83], v[120:123], v[152:155]
    ds_read_b128 v[48:51], v244 offset:320
    ds_read_b128 v[52:55], v244 offset:832
    s_waitcnt lgkmcnt(15)
    v_mfma_f32_16x16x32_bf16 v[156:159], v[80:83], v[124:127], v[156:159]
    ds_read_b128 v[56:59], v244 offset:1344
    ds_read_b128 v[60:63], v244 offset:1856
    s_waitcnt lgkmcnt(15)
    v_mfma_f32_16x16x32_bf16 v[148:151], v[84:87], v[112:115], v[148:151]
    ds_read2_b32 v[20:21], v240 offset0:80 offset1:81
    ds_read2_b32 v[22:23], v240 offset0:82 offset1:83
    v_mfma_f32_16x16x32_bf16 v[152:155], v[84:87], v[116:119], v[152:155]
    ds_read2_b32 v[24:25], v241 offset0:208 offset1:209
    ds_read2_b32 v[26:27], v241 offset0:210 offset1:211
    v_mfma_f32_16x16x32_bf16 v[156:159], v[84:87], v[120:123], v[156:159]
    ds_read2_b32 v[28:29], v241 offset0:80 offset1:81
    s_waitcnt lgkmcnt(15)
    v_mfma_f32_16x16x32_bf16 v[152:155], v[88:91], v[112:115], v[152:155]
    ds_read2_b32 v[30:31], v241 offset0:82 offset1:83
    v_mfma_f32_16x16x32_bf16 v[156:159], v[88:91], v[116:119], v[156:159]
    ds_read2_b32 v[32:33], v242 offset0:208 offset1:209
    s_waitcnt lgkmcnt(15)
    v_mfma_f32_16x16x32_bf16 v[156:159], v[92:95], v[112:115], v[156:159]
    ds_read2_b32 v[34:35], v242 offset0:210 offset1:211
    s_waitcnt lgkmcnt(15)
    v_mfma_f32_16x16x32_bf16 v[160:163], v[96:99], v[128:131], v[160:163]
    ds_read_b128 v[64:67], v244 offset:10496
    s_waitcnt lgkmcnt(15)
    v_mfma_f32_16x16x32_bf16 v[164:167], v[96:99], v[132:135], v[164:167]
    ds_read_b128 v[68:71], v244 offset:11008
    s_waitcnt lgkmcnt(15)
    v_mfma_f32_16x16x32_bf16 v[168:171], v[96:99], v[136:139], v[168:171]
    ds_read_b128 v[72:75], v244 offset:11520
    s_waitcnt lgkmcnt(15)
    v_mfma_f32_16x16x32_bf16 v[172:175], v[96:99], v[140:143], v[172:175]
    ds_read_b128 v[76:79], v244 offset:12032
    s_waitcnt lgkmcnt(15)
    v_mfma_f32_16x16x32_bf16 v[164:167], v[100:103], v[128:131], v[164:167]
    ds_read2_b32 v[36:37], v242 offset0:80 offset1:81
    v_mfma_f32_16x16x32_bf16 v[168:171], v[100:103], v[132:135], v[168:171]
    ds_read2_b32 v[38:39], v242 offset0:82 offset1:83
    v_mfma_f32_16x16x32_bf16 v[172:175], v[100:103], v[136:139], v[172:175]
    ds_read2_b32 v[40:41], v243 offset0:208 offset1:209
    s_waitcnt lgkmcnt(15)
    v_mfma_f32_16x16x32_bf16 v[168:171], v[104:107], v[128:131], v[168:171]
    ds_read2_b32 v[42:43], v243 offset0:210 offset1:211
    v_mfma_f32_16x16x32_bf16 v[172:175], v[104:107], v[132:135], v[172:175]
    ds_read2_b32 v[44:45], v243 offset0:80 offset1:81
    s_waitcnt lgkmcnt(15)
    v_mfma_f32_16x16x32_bf16 v[172:175], v[108:111], v[128:131], v[172:175]
    ds_read2_b32 v[46:47], v243 offset0:82 offset1:83
    s_waitcnt lgkmcnt(15)
    v_mfma_f32_16x16x32_bf16 v[144:147], v[16:19], v[48:51], v[144:147]
    s_waitcnt lgkmcnt(15)
    v_mfma_f32_16x16x32_bf16 v[148:151], v[16:19], v[52:55], v[148:151]
    ds_read2_b32 v[80:81], v240 offset0:192 offset1:193
    ds_read2_b32 v[82:83], v240 offset0:194 offset1:195
    s_waitcnt lgkmcnt(15)
    v_mfma_f32_16x16x32_bf16 v[152:155], v[16:19], v[56:59], v[152:155]
    ds_read_b128 v[112:115], v244 offset:256
    ds_read_b128 v[116:119], v244 offset:768
    s_waitcnt lgkmcnt(15)
    v_mfma_f32_16x16x32_bf16 v[156:159], v[16:19], v[60:63], v[156:159]
    ds_read_b128 v[120:123], v244 offset:1280
    ds_read_b128 v[124:127], v244 offset:1792
    s_waitcnt lgkmcnt(15)
    v_mfma_f32_16x16x32_bf16 v[148:151], v[20:23], v[48:51], v[148:151]
    ds_read2_b32 v[84:85], v240 offset0:64 offset1:65
    ds_read2_b32 v[86:87], v240 offset0:66 offset1:67
    v_mfma_f32_16x16x32_bf16 v[152:155], v[20:23], v[52:55], v[152:155]
    ds_read2_b32 v[88:89], v241 offset0:192 offset1:193
    ds_read2_b32 v[90:91], v241 offset0:194 offset1:195
    v_mfma_f32_16x16x32_bf16 v[156:159], v[20:23], v[56:59], v[156:159]
    ds_read2_b32 v[92:93], v241 offset0:64 offset1:65
    s_waitcnt lgkmcnt(15)
    v_mfma_f32_16x16x32_bf16 v[152:155], v[24:27], v[48:51], v[152:155]
    ds_read2_b32 v[94:95], v241 offset0:66 offset1:67
    v_mfma_f32_16x16x32_bf16 v[156:159], v[24:27], v[52:55], v[156:159]
    ds_read2_b32 v[96:97], v242 offset0:192 offset1:193
    s_waitcnt lgkmcnt(15)
    v_mfma_f32_16x16x32_bf16 v[156:159], v[28:31], v[48:51], v[156:159]
    ds_read2_b32 v[98:99], v242 offset0:194 offset1:195
    s_waitcnt lgkmcnt(15)
    v_mfma_f32_16x16x32_bf16 v[160:163], v[32:35], v[64:67], v[160:163]
    ds_read_b128 v[128:131], v244 offset:10432
    s_waitcnt lgkmcnt(15)
    v_mfma_f32_16x16x32_bf16 v[164:167], v[32:35], v[68:71], v[164:167]
    ds_read_b128 v[132:135], v244 offset:10944
    s_waitcnt lgkmcnt(15)
    v_mfma_f32_16x16x32_bf16 v[168:171], v[32:35], v[72:75], v[168:171]
    ds_read_b128 v[136:139], v244 offset:11456
    s_waitcnt lgkmcnt(15)
    v_mfma_f32_16x16x32_bf16 v[172:175], v[32:35], v[76:79], v[172:175]
    ds_read_b128 v[140:143], v244 offset:11968
    s_waitcnt lgkmcnt(15)
    v_mfma_f32_16x16x32_bf16 v[164:167], v[36:39], v[64:67], v[164:167]
    ds_read2_b32 v[100:101], v242 offset0:64 offset1:65
    v_mfma_f32_16x16x32_bf16 v[168:171], v[36:39], v[68:71], v[168:171]
    ds_read2_b32 v[102:103], v242 offset0:66 offset1:67
    v_mfma_f32_16x16x32_bf16 v[172:175], v[36:39], v[72:75], v[172:175]
    ds_read2_b32 v[104:105], v243 offset0:192 offset1:193
    s_waitcnt lgkmcnt(15)
    v_mfma_f32_16x16x32_bf16 v[168:171], v[40:43], v[64:67], v[168:171]
    ds_read2_b32 v[106:107], v243 offset0:194 offset1:195
    v_mfma_f32_16x16x32_bf16 v[172:175], v[40:43], v[68:71], v[172:175]
    ds_read2_b32 v[108:109], v243 offset0:64 offset1:65
    s_waitcnt lgkmcnt(15)
    v_mfma_f32_16x16x32_bf16 v[172:175], v[44:47], v[64:67], v[172:175]
    ds_read2_b32 v[110:111], v243 offset0:66 offset1:67
    s_waitcnt vmcnt(0)
    v_mov_b32 v2, 163808
    v_mov_b32 v3, 1
    s_mov_b64 exec, 1
    ds_add_u32 v2, v3
    s_mov_b64 exec, -1
    s_waitcnt lgkmcnt(15)
    v_mfma_f32_16x16x32_bf16 v[144:147], v[80:83], v[112:115], v[144:147]
    s_waitcnt lgkmcnt(15)
    v_mfma_f32_16x16x32_bf16 v[148:151], v[80:83], v[116:119], v[148:151]
    ds_read2_b32 v[16:17], v240 offset0:176 offset1:177
    ds_read2_b32 v[18:19], v240 offset0:178 offset1:179
    s_waitcnt lgkmcnt(15)
    v_mfma_f32_16x16x32_bf16 v[152:155], v[80:83], v[120:123], v[152:155]
    ds_read_b128 v[48:51], v244 offset:192
    ds_read_b128 v[52:55], v244 offset:704
    s_waitcnt lgkmcnt(15)
    v_mfma_f32_16x16x32_bf16 v[156:159], v[80:83], v[124:127], v[156:159]
    ds_read_b128 v[56:59], v244 offset:1216
    ds_read_b128 v[60:63], v244 offset:1728
    s_waitcnt lgkmcnt(15)
    v_mfma_f32_16x16x32_bf16 v[148:151], v[84:87], v[112:115], v[148:151]
    ds_read2_b32 v[20:21], v240 offset0:48 offset1:49
    ds_read2_b32 v[22:23], v240 offset0:50 offset1:51
    v_mfma_f32_16x16x32_bf16 v[152:155], v[84:87], v[116:119], v[152:155]
    ds_read2_b32 v[24:25], v241 offset0:176 offset1:177
    ds_read2_b32 v[26:27], v241 offset0:178 offset1:179
    v_mfma_f32_16x16x32_bf16 v[156:159], v[84:87], v[120:123], v[156:159]
    ds_read2_b32 v[28:29], v241 offset0:48 offset1:49
    s_waitcnt lgkmcnt(15)
    v_mfma_f32_16x16x32_bf16 v[152:155], v[88:91], v[112:115], v[152:155]
    ds_read2_b32 v[30:31], v241 offset0:50 offset1:51
    v_mfma_f32_16x16x32_bf16 v[156:159], v[88:91], v[116:119], v[156:159]
    ds_read2_b32 v[32:33], v242 offset0:176 offset1:177
    s_waitcnt lgkmcnt(15)
    v_mfma_f32_16x16x32_bf16 v[156:159], v[92:95], v[112:115], v[156:159]
    ds_read2_b32 v[34:35], v242 offset0:178 offset1:179
    s_waitcnt lgkmcnt(15)
    v_mfma_f32_16x16x32_bf16 v[160:163], v[96:99], v[128:131], v[160:163]
    ds_read_b128 v[64:67], v244 offset:10368
    s_waitcnt lgkmcnt(15)
    v_mfma_f32_16x16x32_bf16 v[164:167], v[96:99], v[132:135], v[164:167]
    ds_read_b128 v[68:71], v244 offset:10880
    s_waitcnt lgkmcnt(15)
    v_mfma_f32_16x16x32_bf16 v[168:171], v[96:99], v[136:139], v[168:171]
    ds_read_b128 v[72:75], v244 offset:11392
    s_waitcnt lgkmcnt(15)
    v_mfma_f32_16x16x32_bf16 v[172:175], v[96:99], v[140:143], v[172:175]
    ds_read_b128 v[76:79], v244 offset:11904
    s_waitcnt lgkmcnt(15)
    v_mfma_f32_16x16x32_bf16 v[164:167], v[100:103], v[128:131], v[164:167]
    ds_read2_b32 v[36:37], v242 offset0:48 offset1:49
    v_mfma_f32_16x16x32_bf16 v[168:171], v[100:103], v[132:135], v[168:171]
    ds_read2_b32 v[38:39], v242 offset0:50 offset1:51
    v_mfma_f32_16x16x32_bf16 v[172:175], v[100:103], v[136:139], v[172:175]
    ds_read2_b32 v[40:41], v243 offset0:176 offset1:177
    s_waitcnt lgkmcnt(15)
    v_mfma_f32_16x16x32_bf16 v[168:171], v[104:107], v[128:131], v[168:171]
    ds_read2_b32 v[42:43], v243 offset0:178 offset1:179
    v_mfma_f32_16x16x32_bf16 v[172:175], v[104:107], v[132:135], v[172:175]
    ds_read2_b32 v[44:45], v243 offset0:48 offset1:49
    s_waitcnt lgkmcnt(15)
    v_mfma_f32_16x16x32_bf16 v[172:175], v[108:111], v[128:131], v[172:175]
    ds_read2_b32 v[46:47], v243 offset0:50 offset1:51
    s_waitcnt lgkmcnt(15)
    v_mfma_f32_16x16x32_bf16 v[144:147], v[16:19], v[48:51], v[144:147]
    s_waitcnt lgkmcnt(15)
    v_mfma_f32_16x16x32_bf16 v[148:151], v[16:19], v[52:55], v[148:151]
    ds_read2_b32 v[80:81], v240 offset0:160 offset1:161
    ds_read2_b32 v[82:83], v240 offset0:162 offset1:163
    s_waitcnt lgkmcnt(15)
    v_mfma_f32_16x16x32_bf16 v[152:155], v[16:19], v[56:59], v[152:155]
    ds_read_b128 v[112:115], v244 offset:128
    ds_read_b128 v[116:119], v244 offset:640
    s_waitcnt lgkmcnt(15)
    v_mfma_f32_16x16x32_bf16 v[156:159], v[16:19], v[60:63], v[156:159]
    ds_read_b128 v[120:123], v244 offset:1152
    ds_read_b128 v[124:127], v244 offset:1664
    s_waitcnt lgkmcnt(15)
    v_mfma_f32_16x16x32_bf16 v[148:151], v[20:23], v[48:51], v[148:151]
    ds_read2_b32 v[84:85], v240 offset0:32 offset1:33
    ds_read2_b32 v[86:87], v240 offset0:34 offset1:35
    v_mfma_f32_16x16x32_bf16 v[152:155], v[20:23], v[52:55], v[152:155]
    ds_read2_b32 v[88:89], v241 offset0:160 offset1:161
    ds_read2_b32 v[90:91], v241 offset0:162 offset1:163
    v_mfma_f32_16x16x32_bf16 v[156:159], v[20:23], v[56:59], v[156:159]
    ds_read2_b32 v[92:93], v241 offset0:32 offset1:33
    s_waitcnt lgkmcnt(15)
    v_mfma_f32_16x16x32_bf16 v[152:155], v[24:27], v[48:51], v[152:155]
    ds_read2_b32 v[94:95], v241 offset0:34 offset1:35
    v_mfma_f32_16x16x32_bf16 v[156:159], v[24:27], v[52:55], v[156:159]
    ds_read2_b32 v[96:97], v242 offset0:160 offset1:161
    s_waitcnt lgkmcnt(15)
    v_mfma_f32_16x16x32_bf16 v[156:159], v[28:31], v[48:51], v[156:159]
    ds_read2_b32 v[98:99], v242 offset0:162 offset1:163
    s_waitcnt lgkmcnt(15)
    v_mfma_f32_16x16x32_bf16 v[160:163], v[32:35], v[64:67], v[160:163]
    ds_read_b128 v[128:131], v244 offset:10304
    s_waitcnt lgkmcnt(15)
    v_mfma_f32_16x16x32_bf16 v[164:167], v[32:35], v[68:71], v[164:167]
    ds_read_b128 v[132:135], v244 offset:10816
    s_waitcnt lgkmcnt(15)
    v_mfma_f32_16x16x32_bf16 v[168:171], v[32:35], v[72:75], v[168:171]
    ds_read_b128 v[136:139], v244 offset:11328
    s_waitcnt lgkmcnt(15)
    v_mfma_f32_16x16x32_bf16 v[172:175], v[32:35], v[76:79], v[172:175]
    ds_read_b128 v[140:143], v244 offset:11840
    s_waitcnt lgkmcnt(15)
    v_mfma_f32_16x16x32_bf16 v[164:167], v[36:39], v[64:67], v[164:167]
    ds_read2_b32 v[100:101], v242 offset0:32 offset1:33
    v_mfma_f32_16x16x32_bf16 v[168:171], v[36:39], v[68:71], v[168:171]
    ds_read2_b32 v[102:103], v242 offset0:34 offset1:35
    v_mfma_f32_16x16x32_bf16 v[172:175], v[36:39], v[72:75], v[172:175]
    ds_read2_b32 v[104:105], v243 offset0:160 offset1:161
    s_waitcnt lgkmcnt(15)
    v_mfma_f32_16x16x32_bf16 v[168:171], v[40:43], v[64:67], v[168:171]
    ds_read2_b32 v[106:107], v243 offset0:162 offset1:163
    v_mfma_f32_16x16x32_bf16 v[172:175], v[40:43], v[68:71], v[172:175]
    ds_read2_b32 v[108:109], v243 offset0:32 offset1:33
    s_waitcnt lgkmcnt(15)
    v_mfma_f32_16x16x32_bf16 v[172:175], v[44:47], v[64:67], v[172:175]
    ds_read2_b32 v[110:111], v243 offset0:34 offset1:35
    s_waitcnt lgkmcnt(15)
    v_mfma_f32_16x16x32_bf16 v[144:147], v[80:83], v[112:115], v[144:147]
    s_waitcnt lgkmcnt(15)
    v_mfma_f32_16x16x32_bf16 v[148:151], v[80:83], v[116:119], v[148:151]
    ds_read2_b32 v[16:17], v240 offset0:144 offset1:145
    ds_read2_b32 v[18:19], v240 offset0:146 offset1:147
    s_waitcnt lgkmcnt(15)
    v_mfma_f32_16x16x32_bf16 v[152:155], v[80:83], v[120:123], v[152:155]
    ds_read_b128 v[48:51], v244 offset:64
    ds_read_b128 v[52:55], v244 offset:576
    s_waitcnt lgkmcnt(15)
    v_mfma_f32_16x16x32_bf16 v[156:159], v[80:83], v[124:127], v[156:159]
    ds_read_b128 v[56:59], v244 offset:1088
    ds_read_b128 v[60:63], v244 offset:1600
    s_waitcnt lgkmcnt(15)
    v_mfma_f32_16x16x32_bf16 v[148:151], v[84:87], v[112:115], v[148:151]
    ds_read2_b32 v[20:21], v240 offset0:16 offset1:17
    ds_read2_b32 v[22:23], v240 offset0:18 offset1:19
    v_mfma_f32_16x16x32_bf16 v[152:155], v[84:87], v[116:119], v[152:155]
    ds_read2_b32 v[24:25], v241 offset0:144 offset1:145
    ds_read2_b32 v[26:27], v241 offset0:146 offset1:147
    v_mfma_f32_16x16x32_bf16 v[156:159], v[84:87], v[120:123], v[156:159]
    ds_read2_b32 v[28:29], v241 offset0:16 offset1:17
    s_waitcnt lgkmcnt(15)
    v_mfma_f32_16x16x32_bf16 v[152:155], v[88:91], v[112:115], v[152:155]
    ds_read2_b32 v[30:31], v241 offset0:18 offset1:19
    v_mfma_f32_16x16x32_bf16 v[156:159], v[88:91], v[116:119], v[156:159]
    ds_read2_b32 v[32:33], v242 offset0:144 offset1:145
    s_waitcnt lgkmcnt(15)
    v_mfma_f32_16x16x32_bf16 v[156:159], v[92:95], v[112:115], v[156:159]
    ds_read2_b32 v[34:35], v242 offset0:146 offset1:147
    s_waitcnt lgkmcnt(15)
    v_mfma_f32_16x16x32_bf16 v[160:163], v[96:99], v[128:131], v[160:163]
    ds_read_b128 v[64:67], v244 offset:10240
    s_waitcnt lgkmcnt(15)
    v_mfma_f32_16x16x32_bf16 v[164:167], v[96:99], v[132:135], v[164:167]
    ds_read_b128 v[68:71], v244 offset:10752
    s_waitcnt lgkmcnt(15)
    v_mfma_f32_16x16x32_bf16 v[168:171], v[96:99], v[136:139], v[168:171]
    ds_read_b128 v[72:75], v244 offset:11264
    s_waitcnt lgkmcnt(15)
    v_mfma_f32_16x16x32_bf16 v[172:175], v[96:99], v[140:143], v[172:175]
    ds_read_b128 v[76:79], v244 offset:11776
    s_waitcnt lgkmcnt(15)
    v_mfma_f32_16x16x32_bf16 v[164:167], v[100:103], v[128:131], v[164:167]
    ds_read2_b32 v[36:37], v242 offset0:16 offset1:17
    v_mfma_f32_16x16x32_bf16 v[168:171], v[100:103], v[132:135], v[168:171]
    ds_read2_b32 v[38:39], v242 offset0:18 offset1:19
    v_mfma_f32_16x16x32_bf16 v[172:175], v[100:103], v[136:139], v[172:175]
    ds_read2_b32 v[40:41], v243 offset0:144 offset1:145
    s_waitcnt lgkmcnt(15)
    v_mfma_f32_16x16x32_bf16 v[168:171], v[104:107], v[128:131], v[168:171]
    ds_read2_b32 v[42:43], v243 offset0:146 offset1:147
    v_mfma_f32_16x16x32_bf16 v[172:175], v[104:107], v[132:135], v[172:175]
    ds_read2_b32 v[44:45], v243 offset0:16 offset1:17
    s_waitcnt lgkmcnt(15)
    v_mfma_f32_16x16x32_bf16 v[172:175], v[108:111], v[128:131], v[172:175]
    ds_read2_b32 v[46:47], v243 offset0:18 offset1:19
    s_waitcnt lgkmcnt(15)
    v_mfma_f32_16x16x32_bf16 v[144:147], v[16:19], v[48:51], v[144:147]
    s_waitcnt lgkmcnt(15)
    v_mfma_f32_16x16x32_bf16 v[148:151], v[16:19], v[52:55], v[148:151]
    ds_read2_b32 v[80:81], v240 offset0:128 offset1:129
    ds_read2_b32 v[82:83], v240 offset0:130 offset1:131
    s_waitcnt lgkmcnt(15)
    v_mfma_f32_16x16x32_bf16 v[152:155], v[16:19], v[56:59], v[152:155]
    ds_read_b128 v[112:115], v244 offset:0
    ds_read_b128 v[116:119], v244 offset:512
    s_waitcnt lgkmcnt(15)
    v_mfma_f32_16x16x32_bf16 v[156:159], v[16:19], v[60:63], v[156:159]
    ds_read_b128 v[120:123], v244 offset:1024
    ds_read_b128 v[124:127], v244 offset:1536
    s_waitcnt lgkmcnt(15)
    v_mfma_f32_16x16x32_bf16 v[148:151], v[20:23], v[48:51], v[148:151]
    ds_read2_b32 v[84:85], v240 offset0:0 offset1:1
    ds_read2_b32 v[86:87], v240 offset0:2 offset1:3
    v_mfma_f32_16x16x32_bf16 v[152:155], v[20:23], v[52:55], v[152:155]
    ds_read2_b32 v[88:89], v241 offset0:128 offset1:129
    ds_read2_b32 v[90:91], v241 offset0:130 offset1:131
    v_mfma_f32_16x16x32_bf16 v[156:159], v[20:23], v[56:59], v[156:159]
    ds_read2_b32 v[92:93], v241 offset0:0 offset1:1
    s_waitcnt lgkmcnt(15)
    v_mfma_f32_16x16x32_bf16 v[152:155], v[24:27], v[48:51], v[152:155]
    ds_read2_b32 v[94:95], v241 offset0:2 offset1:3
    v_mfma_f32_16x16x32_bf16 v[156:159], v[24:27], v[52:55], v[156:159]
    ds_read2_b32 v[96:97], v242 offset0:128 offset1:129
    s_waitcnt lgkmcnt(15)
    v_mfma_f32_16x16x32_bf16 v[156:159], v[28:31], v[48:51], v[156:159]
    ds_read2_b32 v[98:99], v242 offset0:130 offset1:131
    s_waitcnt lgkmcnt(15)
    v_mfma_f32_16x16x32_bf16 v[160:163], v[32:35], v[64:67], v[160:163]
    ds_read_b128 v[128:131], v244 offset:10176
    s_waitcnt lgkmcnt(15)
    v_mfma_f32_16x16x32_bf16 v[164:167], v[32:35], v[68:71], v[164:167]
    ds_read_b128 v[132:135], v244 offset:10688
    s_waitcnt lgkmcnt(15)
    v_mfma_f32_16x16x32_bf16 v[168:171], v[32:35], v[72:75], v[168:171]
    ds_read_b128 v[136:139], v244 offset:11200
    s_waitcnt lgkmcnt(15)
    v_mfma_f32_16x16x32_bf16 v[172:175], v[32:35], v[76:79], v[172:175]
    ds_read_b128 v[140:143], v244 offset:11712
    s_waitcnt lgkmcnt(15)
    v_mfma_f32_16x16x32_bf16 v[164:167], v[36:39], v[64:67], v[164:167]
    ds_read2_b32 v[100:101], v242 offset0:0 offset1:1
    v_mfma_f32_16x16x32_bf16 v[168:171], v[36:39], v[68:71], v[168:171]
    ds_read2_b32 v[102:103], v242 offset0:2 offset1:3
    v_mfma_f32_16x16x32_bf16 v[172:175], v[36:39], v[72:75], v[172:175]
    ds_read2_b32 v[104:105], v243 offset0:128 offset1:129
    s_waitcnt lgkmcnt(15)
    v_mfma_f32_16x16x32_bf16 v[168:171], v[40:43], v[64:67], v[168:171]
    ds_read2_b32 v[106:107], v243 offset0:130 offset1:131
    v_mfma_f32_16x16x32_bf16 v[172:175], v[40:43], v[68:71], v[172:175]
    ds_read2_b32 v[108:109], v243 offset0:0 offset1:1
    s_waitcnt lgkmcnt(15)
    v_mfma_f32_16x16x32_bf16 v[172:175], v[44:47], v[64:67], v[172:175]
    ds_read2_b32 v[110:111], v243 offset0:2 offset1:3
    s_waitcnt lgkmcnt(15)
    v_mfma_f32_16x16x32_bf16 v[144:147], v[80:83], v[112:115], v[144:147]
    s_waitcnt lgkmcnt(15)
    v_mfma_f32_16x16x32_bf16 v[148:151], v[80:83], v[116:119], v[148:151]
    s_waitcnt lgkmcnt(15)
    v_mfma_f32_16x16x32_bf16 v[152:155], v[80:83], v[120:123], v[152:155]
    s_waitcnt lgkmcnt(15)
    v_mfma_f32_16x16x32_bf16 v[156:159], v[80:83], v[124:127], v[156:159]
    s_waitcnt lgkmcnt(15)
    v_mfma_f32_16x16x32_bf16 v[148:151], v[84:87], v[112:115], v[148:151]
    v_cvt_pk_bf16_f32 v16, v144, v145
    v_cvt_pk_bf16_f32 v17, v146, v147
    v_mfma_f32_16x16x32_bf16 v[152:155], v[84:87], v[116:119], v[152:155]
    ds_write_b64 v245, v[16:17] offset:0
    v_mfma_f32_16x16x32_bf16 v[156:159], v[84:87], v[120:123], v[156:159]
    s_waitcnt lgkmcnt(15)
    v_mfma_f32_16x16x32_bf16 v[152:155], v[88:91], v[112:115], v[152:155]
    v_mfma_f32_16x16x32_bf16 v[156:159], v[88:91], v[116:119], v[156:159]
    v_cvt_pk_bf16_f32 v18, v148, v149
    v_cvt_pk_bf16_f32 v19, v150, v151
    s_waitcnt lgkmcnt(13)
    v_mfma_f32_16x16x32_bf16 v[156:159], v[92:95], v[112:115], v[156:159]
    ds_write_b64 v245, v[18:19] offset:512
    s_waitcnt lgkmcnt(11)
    v_mfma_f32_16x16x32_bf16 v[160:163], v[96:99], v[128:131], v[160:163]
    s_waitcnt lgkmcnt(10)
    v_mfma_f32_16x16x32_bf16 v[164:167], v[96:99], v[132:135], v[164:167]
    v_cvt_pk_bf16_f32 v20, v152, v153
    v_cvt_pk_bf16_f32 v21, v154, v155
    s_waitcnt lgkmcnt(9)
    v_mfma_f32_16x16x32_bf16 v[168:171], v[96:99], v[136:139], v[168:171]
    ds_write_b64 v245, v[20:21] offset:1024
    s_waitcnt lgkmcnt(7)
    v_mfma_f32_16x16x32_bf16 v[164:167], v[100:103], v[128:131], v[164:167]
    v_cvt_pk_bf16_f32 v22, v156, v157
    v_cvt_pk_bf16_f32 v23, v158, v159
    v_mfma_f32_16x16x32_bf16 v[168:171], v[100:103], v[132:135], v[168:171]
    ds_write_b64 v245, v[22:23] offset:1536
    v_cvt_pk_bf16_f32 v24, v160, v161
    s_waitcnt lgkmcnt(6)
    v_mfma_f32_16x16x32_bf16 v[168:171], v[104:107], v[128:131], v[168:171]
    v_cvt_pk_bf16_f32 v25, v162, v163
    ds_write_b64 v245, v[24:25] offset:16896
    v_mfma_f32_16x16x32_bf16 v[172:175], v[96:99], v[140:143], v[172:175]
    v_mfma_f32_16x16x32_bf16 v[172:175], v[100:103], v[136:139], v[172:175]
    v_cvt_pk_bf16_f32 v26, v164, v165
    v_cvt_pk_bf16_f32 v27, v166, v167
    v_mfma_f32_16x16x32_bf16 v[172:175], v[104:107], v[132:135], v[172:175]
    ds_write_b64 v245, v[26:27] offset:17408
    s_waitcnt lgkmcnt(6)
    v_mfma_f32_16x16x32_bf16 v[172:175], v[108:111], v[128:131], v[172:175]
    v_cvt_pk_bf16_f32 v28, v168, v169
    v_cvt_pk_bf16_f32 v29, v170, v171
    ds_write_b64 v245, v[28:29] offset:17920
    s_nop 4
    v_cvt_pk_bf16_f32 v30, v172, v173
    s_nop 3
    v_cvt_pk_bf16_f32 v31, v174, v175
    ds_write_b64 v245, v[30:31] offset:18432
    v_mov_b32 v2, 163816
    v_mov_b32 v3, 1
    s_mov_b64 exec, 1
    ds_add_u32 v2, v3
    s_mov_b64 exec, -1
    s_mov_b32 s82, 0
Lsy_61:
    ds_read_b32 v3, v2
    s_add_u32 s82, s82, 1
    s_waitcnt lgkmcnt(0)
    v_readfirstlane_b32 s83, v3
    s_cmp_gt_u32 s82, 0x40000
    s_cbranch_scc1 Lsyd_62
    s_cmp_lt_u32 s83, 4
    s_cbranch_scc1 Lsy_61
Lsyd_62:
    ds_read_b64_tr_b16 v[32:33], v246 offset:0
    ds_read_b64_tr_b16 v[34:35], v246 offset:16896
    ds_read_b64_tr_b16 v[36:37], v246 offset:512
    ds_read_b64_tr_b16 v[38:39], v246 offset:17408
    ds_read_b64_tr_b16 v[40:41], v246 offset:1024
    ds_read_b64_tr_b16 v[42:43], v246 offset:17920
    ds_read_b64_tr_b16 v[44:45], v246 offset:1536
    ds_read_b64_tr_b16 v[46:47], v246 offset:18432
    s_mov_b32 s12, 0
    s_waitcnt lgkmcnt(6)
    buffer_store_dwordx4 v[32:35], v247, s[68:71], s12 offen
    s_mov_b32 s12, 655360
    s_waitcnt lgkmcnt(4)
    buffer_store_dwordx4 v[36:39], v247, s[68:71], s12 offen
    s_mov_b32 s12, 1310720
    s_waitcnt lgkmcnt(2)
    buffer_store_dwordx4 v[40:43], v247, s[68:71], s12 offen
    s_mov_b32 s12, 1966080
    s_waitcnt lgkmcnt(0)
    buffer_store_dwordx4 v[44:47], v247, s[68:71], s12 offen
    s_branch L_fin
L_idle:
    s_sub_u32 m0, s95, 1024
    s_nop 0
    buffer_load_dwordx4 v224, s[72:75], s93 offen lds
    s_add_u32 m0, s95, 0
    s_nop 0
    buffer_load_dwordx4 v225, s[72:75], s93 offen lds
    s_add_u32 m0, s95, 1024
    s_nop 0
    buffer_load_dwordx4 v226, s[72:75], s93 offen lds
    s_add_u32 m0, s95, 2048
    s_nop 0
    buffer_load_dwordx4 v227, s[72:75], s93 offen lds
    s_add_u32 m0, s95, 3072
    s_nop 0
    buffer_load_dwordx4 v228, s[72:75], s93 offen lds
    s_add_u32 m0, s95, 4096
    s_nop 0
    buffer_load_dwordx4 v224, s[72:75], s94 offen lds
    s_add_u32 m0, s95, 5120
    s_nop 0
    buffer_load_dwordx4 v225, s[72:75], s94 offen lds
    s_add_u32 m0, s95, 6144
    s_nop 0
    buffer_load_dwordx4 v226, s[72:75], s94 offen lds
    s_add_u32 m0, s95, 7168
    s_nop 0
    buffer_load_dwordx4 v227, s[72:75], s94 offen lds
    s_add_u32 m0, s95, 8192
    s_nop 0
    buffer_load_dwordx4 v228, s[72:75], s94 offen lds
    s_waitcnt vmcnt(0)
    v_mov_b32 v2, 163808
    v_mov_b32 v3, 1
    s_mov_b64 exec, 1
    ds_add_u32 v2, v3
    s_mov_b64 exec, -1
    s_branch L_fin
L_kpoll:
    s_mov_b32 s82, 0
L_kpoll1:
    buffer_load_dwordx4 v[216:219], v222, s[64:67], s99 offen sc1
    s_add_u32 s82, s82, 1
    s_cmp_gt_u32 s82, 20000
    s_waitcnt vmcnt(0)
    s_cbranch_scc1 L_kin0
    v_cmp_eq_u64 vcc, s[80:81], v[216:217]
    v_cmp_eq_u64 s[84:85], s[80:81], v[218:219]
    s_nop 0
    s_and_b64 vcc, vcc, s[84:85]
    s_cmp_eq_u64 vcc, -1
    s_cbranch_scc0 L_kpoll1
    s_branch L_kin0
L_slow:
    v_and_b32 v62, 31, v0
    v_lshlrev_b32 v62, 3, v62
    v_mov_b32 v60, 0xff800000
    v_mov_b32 v61, 0xff800000
    s_mov_b32 s8, 0
L_sl0:
    s_lshr_b32 s9, s8, 1
    s_mul_i32 s9, s9, 5248
    s_and_b32 s82, s8, 1
    s_lshl_b32 s12, s82, 10
    s_add_u32 s12, s12, s9
    buffer_load_dwordx4 v[124:127], v8, s[64:67], s12 offen sc1
    s_lshl_b32 s12, s82, 8
    s_add_u32 s12, s12, s9
    buffer_load_dwordx2 v[122:123], v62, s[64:67], s12 offen offset:2048 sc1
    s_waitcnt vmcnt(0)
    v_mfma_f32_32x32x4_2b_bf16 v[16:47], v[122:123], v[120:121], 0 cbsz:1 abid:0
    s_nop 15
    s_nop 1
    v_mfma_f32_32x32x16_bf16 v[16:31], v[124:127], v[112:115], v[16:31]
    v_mfma_f32_32x32x16_bf16 v[32:47], v[124:127], v[116:119], v[32:47]
    s_nop 13
    v_max3_f32 v60, v16, v17, v60
    v_max3_f32 v60, v18, v19, v60
    v_max3_f32 v60, v20, v21, v60
    v_max3_f32 v60, v22, v23, v60
    v_max3_f32 v60, v24, v25, v60
    v_max3_f32 v60, v26, v27, v60
    v_max3_f32 v60, v28, v29, v60
    v_max3_f32 v60, v30, v31, v60
    v_max3_f32 v61, v32, v33, v61
    v_max3_f32 v61, v34, v35, v61
    v_max3_f32 v61, v36, v37, v61
    v_max3_f32 v61, v38, v39, v61
    v_max3_f32 v61, v40, v41, v61
    v_max3_f32 v61, v42, v43, v61
    v_max3_f32 v61, v44, v45, v61
    v_max3_f32 v61, v46, v47, v61
    s_add_u32 s8, s8, 1
    s_cmp_lt_u32 s8, 64
    s_cbranch_scc1 L_sl0
    v_mov_b32 v63, v60
    v_mov_b32 v64, v61
    s_nop 1
    v_permlane32_swap_b32 v60, v63
    v_permlane32_swap_b32 v61, v64
    s_nop 1
    v_max_f32 v60, v60, v63
    v_max_f32 v61, v61, v64
    v_mov_b32 v80, 0
    v_mov_b32 v81, 0
    v_mov_b32 v82, 0
    v_mov_b32 v83, 0
    v_mov_b32 v84, 0
    v_mov_b32 v85, 0
    v_mov_b32 v86, 0
    v_mov_b32 v87, 0
    v_mov_b32 v88, 0
    v_mov_b32 v89, 0
    v_mov_b32 v90, 0
    v_mov_b32 v91, 0
    v_mov_b32 v92, 0
    v_mov_b32 v93, 0
    v_mov_b32 v94, 0
    v_mov_b32 v95, 0
    v_mov_b32 v96, 0
    v_mov_b32 v97, 0
    v_mov_b32 v98, 0
    v_mov_b32 v99, 0
    v_mov_b32 v100, 0
    v_mov_b32 v101, 0
    v_mov_b32 v102, 0
    v_mov_b32 v103, 0
    v_mov_b32 v104, 0
    v_mov_b32 v105, 0
    v_mov_b32 v106, 0
    v_mov_b32 v107, 0
    v_mov_b32 v108, 0
    v_mov_b32 v109, 0
    v_mov_b32 v110, 0
    v_mov_b32 v111, 0
    s_mov_b32 s8, 0
L_sl1:
    s_lshr_b32 s9, s8, 1
    s_mul_i32 s9, s9, 5248
    s_and_b32 s82, s8, 1
    s_lshl_b32 s12, s82, 10
    s_add_u32 s12, s12, s9
    buffer_load_dwordx4 v[124:127], v8, s[64:67], s12 offen sc1
    s_lshl_b32 s12, s82, 8
    s_add_u32 s12, s12, s9
    buffer_load_dwordx2 v[122:123], v62, s[64:67], s12 offen offset:2048 sc1
    s_mul_i32 s12, s82, 1344
    s_add_u32 s12, s12, s9
    buffer_load_dwordx4 v[128:131], v151, s[64:67], s12 offen sc1
    buffer_load_dwordx4 v[132:135], v151, s[64:67], s12 offen offset:672 sc1
    s_waitcnt vmcnt(0)
    v_mfma_f32_32x32x4_2b_bf16 v[16:47], v[122:123], v[120:121], 0 cbsz:1 abid:0
    s_nop 15
    s_nop 1
    v_mfma_f32_32x32x16_bf16 v[16:31], v[124:127], v[112:115], v[16:31]
    v_mfma_f32_32x32x16_bf16 v[32:47], v[124:127], v[116:119], v[32:47]
    s_nop 13
    v_sub_f32 v16, v16, v60
    v_sub_f32 v17, v17, v60
    v_sub_f32 v18, v18, v60
    v_sub_f32 v19, v19, v60
    v_sub_f32 v20, v20, v60
    v_sub_f32 v21, v21, v60
    v_sub_f32 v22, v22, v60
    v_sub_f32 v23, v23, v60
    v_sub_f32 v24, v24, v60
    v_sub_f32 v25, v25, v60
    v_sub_f32 v26, v26, v60
    v_sub_f32 v27, v27, v60
    v_sub_f32 v28, v28, v60
    v_sub_f32 v29, v29, v60
    v_sub_f32 v30, v30, v60
    v_sub_f32 v31, v31, v60
    v_sub_f32 v32, v32, v61
    v_sub_f32 v33, v33, v61
    v_sub_f32 v34, v34, v61
    v_sub_f32 v35, v35, v61
    v_sub_f32 v36, v36, v61
    v_sub_f32 v37, v37, v61
    v_sub_f32 v38, v38, v61
    v_sub_f32 v39, v39, v61
    v_sub_f32 v40, v40, v61
    v_sub_f32 v41, v41, v61
    v_sub_f32 v42, v42, v61
    v_sub_f32 v43, v43, v61
    v_sub_f32 v44, v44, v61
    v_sub_f32 v45, v45, v61
    v_sub_f32 v46, v46, v61
    v_sub_f32 v47, v47, v61
    v_exp_f32 v16, v16
    v_exp_f32 v17, v17
    v_exp_f32 v18, v18
    v_exp_f32 v19, v19
    v_exp_f32 v20, v20
    v_exp_f32 v21, v21
    v_exp_f32 v22, v22
    v_exp_f32 v23, v23
    v_exp_f32 v24, v24
    v_exp_f32 v25, v25
    v_exp_f32 v26, v26
    v_exp_f32 v27, v27
    v_exp_f32 v28, v28
    v_exp_f32 v29, v29
    v_exp_f32 v30, v30
    v_exp_f32 v31, v31
    v_exp_f32 v32, v32
    v_exp_f32 v33, v33
    v_exp_f32 v34, v34
    v_exp_f32 v35, v35
    v_exp_f32 v36, v36
    v_exp_f32 v37, v37
    v_exp_f32 v38, v38
    v_exp_f32 v39, v39
    v_exp_f32 v40, v40
    v_exp_f32 v41, v41
    v_exp_f32 v42, v42
    v_exp_f32 v43, v43
    v_exp_f32 v44, v44
    v_exp_f32 v45, v45
    v_exp_f32 v46, v46
    v_exp_f32 v47, v47
    s_nop 1
    v_smfmac_f32_32x32x32_bf16 v[80:95], v[128:131], v[16:23], v144
    v_smfmac_f32_32x32x32_bf16 v[80:95], v[132:135], v[24:31], v144
    v_smfmac_f32_32x32x32_bf16 v[96:111], v[128:131], v[32:39], v144
    v_smfmac_f32_32x32x32_bf16 v[96:111], v[132:135], v[40:47], v144
    s_nop 13
    s_add_u32 s8, s8, 1
    s_cmp_lt_u32 s8, 64
    s_cbranch_scc1 L_sl1
    v_mov_b64 v[16:17], 0
    v_mov_b64 v[18:19], 0
    v_mov_b64 v[20:21], 0
    v_mov_b64 v[22:23], 0
    v_mov_b64 v[24:25], 0
    v_mov_b64 v[26:27], 0
    v_mov_b64 v[28:29], 0
    v_mov_b64 v[30:31], 0
    v_mov_b64 v[32:33], 0
    v_mov_b64 v[34:35], 0
    v_mov_b64 v[36:37], 0
    v_mov_b64 v[38:39], 0
    s_mov_b32 s13, 1
    s_branch L_lext
L_fin:
    s_waitcnt lgkmcnt(0)
L_end:
    s_endpgm
L_codeend:
.p2align 7
.type L_tabA,@object
L_tabA:
.long 52224, 53504, 58624, 59904
.long 52232, 53512, 58632, 59912
.long 52240, 53520, 58640, 59920
.long 52248, 53528, 58648, 59928
.long 52384, 53664, 58784, 60064
.long 52392, 53672, 58792, 60072
.long 52400, 53680, 58800, 60080
.long 52408, 53688, 58808, 60088
.long 52544, 53824, 58944, 60224
.long 52552, 53832, 58952, 60232
.long 52560, 53840, 58960, 60240
.long 52568, 53848, 58968, 60248
.long 52704, 53984, 59104, 60384
.long 52712, 53992, 59112, 60392
.long 52720, 54000, 59120, 60400
.long 52728, 54008, 59128, 60408
.long 52864, 54144, 59264, 60544
.long 52872, 54152, 59272, 60552
.long 52880, 54160, 59280, 60560
.long 52888, 54168, 59288, 60568
.long 53024, 54304, 59424, 60704
.long 53032, 54312, 59432, 60712
.long 53040, 54320, 59440, 60720
.long 53048, 54328, 59448, 60728
.long 53184, 54464, 59584, 60864
.long 53192, 54472, 59592, 60872
.long 53200, 54480, 59600, 60880
.long 53208, 54488, 59608, 60888
.long 53344, 54624, 59744, 61024
.long 53352, 54632, 59752, 61032
.long 53360, 54640, 59760, 61040
.long 53368, 54648, 59768, 61048
.long 55424, 56704, 61824, 63104
.long 55432, 56712, 61832, 63112
.long 55440, 56720, 61840, 63120
.long 55448, 56728, 61848, 63128
.long 55584, 56864, 61984, 63264
.long 55592, 56872, 61992, 63272
.long 55600, 56880, 62000, 63280
.long 55608, 56888, 62008, 63288
.long 55744, 57024, 62144, 63424
.long 55752, 57032, 62152, 63432
.long 55760, 57040, 62160, 63440
.long 55768, 57048, 62168, 63448
.long 55904, 57184, 62304, 63584
.long 55912, 57192, 62312, 63592
.long 55920, 57200, 62320, 63600
.long 55928, 57208, 62328, 63608
.long 56064, 57344, 62464, 63744
.long 56072, 57352, 62472, 63752
.long 56080, 57360, 62480, 63760
.long 56088, 57368, 62488, 63768
.long 56224, 57504, 62624, 63904
.long 56232, 57512, 62632, 63912
.long 56240, 57520, 62640, 63920
.long 56248, 57528, 62648, 63928
.long 56384, 57664, 62784, 64064
.long 56392, 57672, 62792, 64072
.long 56400, 57680, 62800, 64080
.long 56408, 57688, 62808, 64088
.long 56544, 57824, 62944, 64224
.long 56552, 57832, 62952, 64232
.long 56560, 57840, 62960, 64240
.long 56568, 57848, 62968, 64248
.long 54784, 61184, 68224, 69504
.long 54792, 61192, 68232, 69512
.long 54800, 61200, 68240, 69520
.long 54808, 61208, 68248, 69528
.long 54944, 61344, 68384, 69664
.long 54952, 61352, 68392, 69672
.long 54960, 61360, 68400, 69680
.long 54968, 61368, 68408, 69688
.long 55104, 61504, 68544, 69824
.long 55112, 61512, 68552, 69832
.long 55120, 61520, 68560, 69840
.long 55128, 61528, 68568, 69848
.long 55264, 61664, 68704, 69984
.long 55272, 61672, 68712, 69992
.long 55280, 61680, 68720, 70000
.long 55288, 61688, 68728, 70008
.long 57984, 64384, 68864, 70144
.long 57992, 64392, 68872, 70152
.long 58000, 64400, 68880, 70160
.long 58008, 64408, 68888, 70168
.long 58144, 64544, 69024, 70304
.long 58152, 64552, 69032, 70312
.long 58160, 64560, 69040, 70320
.long 58168, 64568, 69048, 70328
.long 58304, 64704, 69184, 70464
.long 58312, 64712, 69192, 70472
.long 58320, 64720, 69200, 70480
.long 58328, 64728, 69208, 70488
.long 58464, 64864, 69344, 70624
.long 58472, 64872, 69352, 70632
.long 58480, 64880, 69360, 70640
.long 58488, 64888, 69368, 70648
.long 65024, 66304, 71424, 72704
.long 65032, 66312, 71432, 72712
.long 65040, 66320, 71440, 72720
.long 65048, 66328, 71448, 72728
.long 65184, 66464, 71584, 72864
.long 65192, 66472, 71592, 72872
.long 65200, 66480, 71600, 72880
.long 65208, 66488, 71608, 72888
.long 65344, 66624, 71744, 73024
.long 65352, 66632, 71752, 73032
.long 65360, 66640, 71760, 73040
.long 65368, 66648, 71768, 73048
.long 65504, 66784, 71904, 73184
.long 65512, 66792, 71912, 73192
.long 65520, 66800, 71920, 73200
.long 65528, 66808, 71928, 73208
.long 65664, 66944, 72064, 73344
.long 65672, 66952, 72072, 73352
.long 65680, 66960, 72080, 73360
.long 65688, 66968, 72088, 73368
.long 65824, 67104, 72224, 73504
.long 65832, 67112, 72232, 73512
.long 65840, 67120, 72240, 73520
.long 65848, 67128, 72248, 73528
.long 65984, 67264, 72384, 73664
.long 65992, 67272, 72392, 73672
.long 66000, 67280, 72400, 73680
.long 66008, 67288, 72408, 73688
.long 66144, 67424, 72544, 73824
.long 66152, 67432, 72552, 73832
.long 66160, 67440, 72560, 73840
.long 66168, 67448, 72568, 73848
.long 74624, 75904, 0, 0
.long 74632, 75912, 160, 8
.long 74640, 75920, 320, 16
.long 74648, 75928, 480, 24
.long 74784, 76064, 640, 32
.long 74792, 76072, 800, 40
.long 74800, 76080, 960, 48
.long 74808, 76088, 1120, 56
.long 74944, 76224, 1280, 64
.long 74952, 76232, 1440, 72
.long 74960, 76240, 1600, 80
.long 74968, 76248, 1760, 88
.long 75104, 76384, 1920, 96
.long 75112, 76392, 2080, 104
.long 75120, 76400, 2240, 112
.long 75128, 76408, 2400, 120
.long 75264, 76544, 8, 128
.long 75272, 76552, 168, 136
.long 75280, 76560, 328, 144
.long 75288, 76568, 488, 152
.long 75424, 76704, 648, 160
.long 75432, 76712, 808, 168
.long 75440, 76720, 968, 176
.long 75448, 76728, 1128, 184
.long 75584, 76864, 1288, 192
.long 75592, 76872, 1448, 200
.long 75600, 76880, 1608, 208
.long 75608, 76888, 1768, 216
.long 75744, 77024, 1928, 224
.long 75752, 77032, 2088, 232
.long 75760, 77040, 2248, 240
.long 75768, 77048, 2408, 248
.long 67584, 73984, 16, 0
.long 67592, 73992, 176, 8
.long 67600, 74000, 336, 16
.long 67608, 74008, 496, 24
.long 67744, 74144, 656, 32
.long 67752, 74152, 816, 40
.long 67760, 74160, 976, 48
.long 67768, 74168, 1136, 56
.long 67904, 74304, 1296, 64
.long 67912, 74312, 1456, 72
.long 67920, 74320, 1616, 80
.long 67928, 74328, 1776, 88
.long 68064, 74464, 1936, 96
.long 68072, 74472, 2096, 104
.long 68080, 74480, 2256, 112
.long 68088, 74488, 2416, 120
.long 70784, 77184, 24, 128
.long 70792, 77192, 184, 136
.long 70800, 77200, 344, 144
.long 70808, 77208, 504, 152
.long 70944, 77344, 664, 160
.long 70952, 77352, 824, 168
.long 70960, 77360, 984, 176
.long 70968, 77368, 1144, 184
.long 71104, 77504, 1304, 192
.long 71112, 77512, 1464, 200
.long 71120, 77520, 1624, 208
.long 71128, 77528, 1784, 216
.long 71264, 77664, 1944, 224
.long 71272, 77672, 2104, 232
.long 71280, 77680, 2264, 240
.long 71288, 77688, 2424, 248
.long 2048, 0, 0, 2560
.long 2056, 16, 16, 2576
.long 2064, 32, 32, 2592
.long 2072, 48, 48, 2608
.long 2080, 64, 64, 2624
.long 2088, 80, 80, 2640
.long 2096, 96, 96, 2656
.long 2104, 112, 112, 2672
.long 2112, 128, 128, 2688
.long 2120, 144, 144, 2704
.long 2128, 160, 160, 2720
.long 2136, 176, 176, 2736
.long 2144, 192, 192, 2752
.long 2152, 208, 208, 2768
.long 2160, 224, 224, 2784
.long 2168, 240, 240, 2800
.long 2176, 20480, 20480, 2816
.long 2184, 20496, 20496, 2832
.long 2192, 20512, 20512, 2848
.long 2200, 20528, 20528, 2864
.long 2208, 20544, 20544, 2880
.long 2216, 20560, 20560, 196608
.long 2224, 20576, 20576, 196608
.long 2232, 20592, 20592, 196608
.long 2240, 20608, 20608, 196608
.long 2248, 20624, 20624, 196608
.long 2256, 20640, 20640, 196608
.long 2264, 20656, 20656, 196608
.long 2272, 20672, 20672, 196608
.long 2280, 20688, 20688, 196608
.long 2288, 20704, 20704, 196608
.long 2296, 20720, 20720, 196608
.long 2304, 256, 40960, 2896
.long 2312, 272, 40976, 2912
.long 2320, 288, 40992, 2928
.long 2328, 304, 41008, 2944
.long 2336, 320, 41024, 2960
.long 2344, 336, 41040, 2976
.long 2352, 352, 41056, 2992
.long 2360, 368, 41072, 3008
.long 2368, 384, 41088, 3024
.long 2376, 400, 41104, 3040
.long 2384, 416, 41120, 3056
.long 2392, 432, 41136, 3072
.long 2400, 448, 41152, 3088
.long 2408, 464, 41168, 3104
.long 2416, 480, 41184, 3120
.long 2424, 496, 41200, 3136
.long 2432, 20736, 61440, 3152
.long 2440, 20752, 61456, 3168
.long 2448, 20768, 61472, 3184
.long 2456, 20784, 61488, 3200
.long 2464, 20800, 61504, 3216
.long 2472, 20816, 61520, 196608
.long 2480, 20832, 61536, 196608
.long 2488, 20848, 61552, 196608
.long 2496, 20864, 61568, 196608
.long 2504, 20880, 61584, 196608
.long 2512, 20896, 61600, 196608
.long 2520, 20912, 61616, 196608
.long 2528, 20928, 61632, 196608
.long 2536, 20944, 61648, 196608
.long 2544, 20960, 61664, 196608
.long 2552, 20976, 61680, 196608
.long 0, 15424, 30848, 10240
.long 16, 15440, 30864, 12800
.long 32, 15456, 33280, 0
.long 48, 15472, 33296, 2560
.long 64, 15488, 33312, 10752
.long 80, 15504, 33328, 13312
.long 96, 17920, 33344, 512
.long 112, 17936, 33360, 3072
.long 128, 17952, 33376, 11264
.long 144, 17968, 33392, 13824
.long 2560, 17984, 33408, 1024
.long 2576, 18000, 33424, 3584
.long 2592, 18016, 35840, 11776
.long 2608, 18032, 35856, 14336
.long 2624, 18048, 35872, 1536
.long 2640, 18064, 35888, 4096
.long 2656, 20480, 35904, 12288
.long 2672, 20496, 35920, 14848
.long 2688, 20512, 35936, 2048
.long 2704, 20528, 35952, 4608
.long 5120, 20544, 35968, 12544
.long 5136, 20560, 35984, 15104
.long 5152, 20576, 38400, 2304
.long 5168, 20592, 38416, 4864
.long 5184, 20608, 38432, 12288
.long 5200, 20624, 38448, 14848
.long 5216, 23040, 38464, 2048
.long 5232, 23056, 38480, 4608
.long 5248, 23072, 38496, 12544
.long 5264, 23088, 38512, 15104
.long 7680, 23104, 38528, 2304
.long 7696, 23120, 38544, 4864
.long 7712, 23136, 2147483648, 10240
.long 7728, 23152, 2147483648, 12800
.long 7744, 23168, 2147483648, 0
.long 7760, 23184, 2147483648, 2560
.long 7776, 25600, 2147483648, 10752
.long 7792, 25616, 2147483648, 13312
.long 7808, 25632, 2147483648, 512
.long 7824, 25648, 2147483648, 3072
.long 10240, 25664, 2147483648, 11264
.long 10256, 25680, 2147483648, 13824
.long 10272, 25696, 2147483648, 1024
.long 10288, 25712, 2147483648, 3584
.long 10304, 25728, 2147483648, 11776
.long 10320, 25744, 2147483648, 14336
.long 10336, 28160, 2147483648, 1536
.long 10352, 28176, 2147483648, 4096
.long 10368, 28192, 2147483648, 12288
.long 10384, 28208, 2147483648, 14848
.long 12800, 28224, 2147483648, 2048
.long 12816, 28240, 2147483648, 4608
.long 12832, 28256, 2147483648, 12544
.long 12848, 28272, 2147483648, 15104
.long 12864, 28288, 2147483648, 2304
.long 12880, 28304, 2147483648, 4864
.long 12896, 30720, 2147483648, 12288
.long 12912, 30736, 2147483648, 14848
.long 12928, 30752, 2147483648, 2048
.long 12944, 30768, 2147483648, 4608
.long 15360, 30784, 2147483648, 12544
.long 15376, 30800, 2147483648, 15104
.long 15392, 30816, 2147483648, 2304
.long 15408, 30832, 2147483648, 4864
.long 0, 7744, 15488, 24352
.long 16, 7760, 15504, 24368
.long 32, 7776, 16640, 24384
.long 48, 7792, 16656, 24400
.long 64, 7808, 16672, 24416
.long 80, 7824, 16688, 24432
.long 96, 8960, 16704, 24448
.long 112, 8976, 16720, 24464
.long 128, 8992, 16736, 25600
.long 144, 9008, 16752, 25616
.long 1280, 9024, 16768, 25632
.long 1296, 9040, 16784, 25648
.long 1312, 9056, 17920, 25664
.long 1328, 9072, 17936, 25680
.long 1344, 9088, 17952, 25696
.long 1360, 9104, 17968, 25712
.long 1376, 10240, 17984, 25728
.long 1392, 10256, 18000, 25744
.long 1408, 10272, 18016, 26880
.long 1424, 10288, 18032, 26896
.long 2560, 10304, 18048, 26912
.long 2576, 10320, 18064, 26928
.long 2592, 10336, 19200, 26944
.long 2608, 10352, 19216, 26960
.long 2624, 10368, 19232, 26976
.long 2640, 10384, 19248, 26992
.long 2656, 11520, 19264, 27008
.long 2672, 11536, 19280, 27024
.long 2688, 11552, 19296, 28160
.long 2704, 11568, 19312, 28176
.long 3840, 11584, 19328, 28192
.long 3856, 11600, 19344, 28208
.long 3872, 11616, 20480, 28224
.long 3888, 11632, 20496, 28240
.long 3904, 11648, 20512, 28256
.long 3920, 11664, 20528, 28272
.long 3936, 12800, 20544, 28288
.long 3952, 12816, 20560, 28304
.long 3968, 12832, 20576, 29440
.long 3984, 12848, 20592, 29456
.long 5120, 12864, 20608, 29472
.long 5136, 12880, 20624, 29488
.long 5152, 12896, 21760, 29504
.long 5168, 12912, 21776, 29520
.long 5184, 12928, 21792, 29536
.long 5200, 12944, 21808, 29552
.long 5216, 14080, 21824, 29568
.long 5232, 14096, 21840, 29584
.long 5248, 14112, 21856, 30720
.long 5264, 14128, 21872, 30736
.long 6400, 14144, 21888, 30752
.long 6416, 14160, 21904, 30768
.long 6432, 14176, 23040, 30784
.long 6448, 14192, 23056, 30800
.long 6464, 14208, 23072, 30816
.long 6480, 14224, 23088, 30832
.long 6496, 15360, 23104, 30848
.long 6512, 15376, 23120, 30864
.long 6528, 15392, 23136, 32000
.long 6544, 15408, 23152, 32016
.long 7680, 15424, 23168, 32032
.long 7696, 15440, 23184, 32048
.long 7712, 15456, 24320, 32064
.long 7728, 15472, 24336, 32080
.long 32096, 0, 0, 0
.long 32112, 0, 0, 0
.long 32128, 0, 0, 0
.long 32144, 0, 0, 0
.long 33280, 0, 0, 0
.long 33296, 0, 0, 0
.long 33312, 0, 0, 0
.long 33328, 0, 0, 0
.long 33344, 0, 0, 0
.long 33360, 0, 0, 0
.long 33376, 0, 0, 0
.long 33392, 0, 0, 0
.long 33408, 0, 0, 0
.long 33424, 0, 0, 0
.long 34560, 0, 0, 0
.long 34576, 0, 0, 0
.long 34592, 0, 0, 0
.long 34608, 0, 0, 0
.long 34624, 0, 0, 0
.long 34640, 0, 0, 0
.long 34656, 0, 0, 0
.long 34672, 0, 0, 0
.long 34688, 0, 0, 0
.long 34704, 0, 0, 0
.long 35840, 0, 0, 0
.long 35856, 0, 0, 0
.long 35872, 0, 0, 0
.long 35888, 0, 0, 0
.long 35904, 0, 0, 0
.long 35920, 0, 0, 0
.long 35936, 0, 0, 0
.long 35952, 0, 0, 0
.long 35968, 0, 0, 0
.long 35984, 0, 0, 0
.long 37120, 0, 0, 0
.long 37136, 0, 0, 0
.long 37152, 0, 0, 0
.long 37168, 0, 0, 0
.long 37184, 0, 0, 0
.long 37200, 0, 0, 0
.long 37216, 0, 0, 0
.long 37232, 0, 0, 0
.long 37248, 0, 0, 0
.long 37264, 0, 0, 0
.long 38400, 0, 0, 0
.long 38416, 0, 0, 0
.long 38432, 0, 0, 0
.long 38448, 0, 0, 0
.long 38464, 0, 0, 0
.long 38480, 0, 0, 0
.long 38496, 0, 0, 0
.long 38512, 0, 0, 0
.long 38528, 0, 0, 0
.long 38544, 0, 0, 0
.long 39680, 0, 0, 0
.long 39696, 0, 0, 0
.long 39712, 0, 0, 0
.long 39728, 0, 0, 0
.long 39744, 0, 0, 0
.long 39760, 0, 0, 0
.long 39776, 0, 0, 0
.long 39792, 0, 0, 0
.long 39808, 0, 0, 0
.long 39824, 0, 0, 0
.section .rodata,"a"
.p2align 6
.amdhsa_kernel concat_heads__grouped_kv_mqa__ssm_conv_s4__prompt_kernel
  .amdhsa_next_free_vgpr 256
  .amdhsa_next_free_sgpr 102
  .amdhsa_accum_offset 256
  .amdhsa_group_segment_fixed_size 0
  .amdhsa_kernarg_size 136
  .amdhsa_user_sgpr_count 2
  .amdhsa_user_sgpr_kernarg_segment_ptr 1
  .amdhsa_system_sgpr_workgroup_id_x 1
.end_amdhsa_kernel
```
